```python
import torch

def _softmax(x, axis=-1):
    return torch.softmax(x, dim=axis)
def _gelu(x):
    return torch.nn.functional.gelu(x, approximate="tanh")
def _silu(x):
    return torch.nn.functional.silu(x)
def _sigmoid(x):
    return torch.sigmoid(x)
def _layernorm(x, axis=-1, eps=1e-5):
    m = x.mean(dim=axis, keepdim=True)
    v = x.var(dim=axis, keepdim=True, unbiased=False)
    return (x - m) / torch.sqrt(v + eps)
def _scatter_add(tgt, idx, src, axis=0):
    return tgt.clone().index_add_(axis, idx, src)
def _segment_sum(src, seg, n):
    out = torch.zeros((n,) + src.shape[1:], dtype=src.dtype)
    return out.index_add_(0, seg, src)
def _pad(x, pw):
    flat = tuple(v for pair in reversed(pw) for v in pair)
    return torch.nn.functional.pad(x, flat)

kernel_name = 'recurrent_scan__linear_attn_block__dense_activation_mish__prompt'

def setup_inputs():

    _w = (lambda a: (lambda t: t.to(torch.bfloat16) if t.is_floating_point() else t)(torch.as_tensor(a)))
    def _A_setup():
        B, S, D = 1, 2048, 448
        return {
            "x": _w((lambda *s: torch.randn(*s, dtype=torch.bfloat16) * 0.05)(B, S, D)),
            "wqkv": _w((lambda *s: torch.randn(*s, dtype=torch.bfloat16) * 0.2)(D, 3 * D)),
            "wo": _w((lambda *s: torch.randn(*s, dtype=torch.bfloat16) * 0.2)(D, D)),
        }
    _A_in = _A_setup()

    def _B_setup():
        B, S, D, F = 1, 2048, 448, 1792
        return {
            "x": _w((lambda *s: torch.randn(*s, dtype=torch.bfloat16) * 0.05)(B, S, D)),
            "w1": _w((lambda *s: torch.randn(*s, dtype=torch.bfloat16) * 0.8)(D, F) * (D ** -0.5)),
            "b1": _w((lambda *s: torch.randn(*s, dtype=torch.bfloat16) * 0.2)(F)),
            "w2": _w((lambda *s: torch.randn(*s, dtype=torch.bfloat16) * 0.1)(F, D) * (F ** -0.5)),
        }
    _B_in = _B_setup()

    return {
        "A_x": _A_in["x"],
        "A_wqkv": _A_in["wqkv"],
        "A_wo": _A_in["wo"],
        "B_x": _B_in["x"],
        "B_w1": _B_in["w1"],
        "B_b1": _B_in["b1"],
        "B_w2": _B_in["w2"],
    }

def reference(A_x, A_wqkv, A_wo, B_x, B_w1, B_b1, B_w2):
    def _A_ref(x, wqkv, wo):
        B, S, D = x.shape
        H = 16; Dh = D // H
        qkv = (lambda x, *d: x.permute(*d))((x @ wqkv).reshape(B, S, 3, H, Dh), 2, 0, 3, 1, 4)
        q, k, v = qkv[0], qkv[1], qkv[2]
        phi = lambda t: torch.where(t > 0, t + 1, torch.exp(t)) + 1e-6
        pq, pk = phi(q), phi(k)
        kv = torch.einsum("bhsd,bhse->bhde", pk, v)
        z = torch.einsum("bhsd->bhd", pk)
        num = torch.einsum("bhqd,bhde->bhqe", pq, kv)
        den = torch.einsum("bhqd,bhd->bhq", pq, z)[..., None] + 1e-6
        o = num / den
        return (lambda x, *d: x.permute(*d))(o, 0, 2, 1, 3).reshape(B, S, D) @ wo

    def _B_ref(x, w1, b1, w2):
        h = torch.einsum("bsd,df->bsf", x, w1) + b1
        sp = torch.log1p(torch.exp(-torch.abs(h))) + torch.where(h > 0, h, torch.zeros_like(h))
        act = h * torch.tanh(sp)
        return torch.einsum("bsf,fd->bsd", act, w2)

    x = A_x
    xn = _layernorm(x, axis=-1)
    s = _A_ref(xn, A_wqkv, A_wo)
    g = _silu(_B_ref(xn, B_w1, B_b1, B_w2))
    return x + s * g
```

```asm
; @launch grid=(256,1,1) block=(512,1,1) lds=163840
.amdgcn_target "amdgcn-amd-amdhsa--gfx950"
.text
.globl recurrent_scan__linear_attn_block__dense_activation_mish__prompt_kernel
.p2align 8
.type recurrent_scan__linear_attn_block__dense_activation_mish__prompt_kernel,@function
recurrent_scan__linear_attn_block__dense_activation_mish__prompt_kernel:
    s_cmp_ge_u32 s2, 256
    s_cbranch_scc1 K_END
    s_load_dwordx16 s[40:55], s[0:1], 0
    s_load_dwordx4 s[56:59], s[0:1], 64
    v_lshrrev_b32 v1, 6, v0
    v_and_b32 v241, 63, v0
    v_readfirstlane_b32 s22, v1
    s_bfe_u32 s20, s2, 0x20001
    s_lshl_b32 s20, s20, 2
    s_lshr_b32 s28, s2, 6
    s_add_u32 s20, s20, s28
    s_bfe_u32 s21, s2, 0x30003
    s_lshl_b32 s21, s21, 1
    s_and_b32 s28, s2, 1
    s_add_u32 s21, s21, s28
    s_and_b32 s23, s22, 3
    s_lshl_b32 s77, s23, 12
    s_cmp_lt_u32 s22, 4
    s_cbranch_scc1 K1_A
    s_add_u32 s24, s20, s21
    s_and_b32 s24, s24, 3
    s_mul_i32 s24, s24, 2
    v_lshrrev_b32 v224, 3, v241
    v_mul_u32_u24 v224, 896, v224
    v_and_b32 v225, 7, v241
    v_lshrrev_b32 v226, 4, v241
    v_xor_b32 v225, v225, v226
    v_lshl_add_u32 v184, v225, 4, v224
    v_xor_b32 v185, 64, v184
    s_lshl_b32 s26, s20, 2
    s_add_u32 s26, s26, s23
    s_mul_i32 s80, s26, 28672
    s_lshl_b32 s28, s24, 7
    s_add_u32 s60, s80, s28
    v_lshlrev_b32 v240, 4, v241
    v_cmp_gt_u32 vcc, 56, v241
    v_mov_b32 v228, 0x40000000
    s_lshl_b32 s26, s20, 4
    s_add_u32 s26, s26, s21
    s_lshl_b32 s26, s26, 2
    s_add_u32 s26, s26, s23
    s_mul_i32 s82, s26, 1792
    v_cndmask_b32 v228, v228, v240, vcc
    v_bfe_u32 v225, v241, 2, 2
    v_xor_b32 v225, v225, v226
    v_and_b32 v227, 3, v241
    s_cmp_ge_u32 s21, 8
    s_cbranch_scc1 K1_B_ADDRQ
    s_movk_i32 s25, 3584
    v_mul_u32_u24 v224, 3584, v226
    v_lshl_add_u32 v224, v227, 4, v224
    s_and_b32 s27, s21, 1
    s_lshl_b32 s28, s27, 6
    v_lshl_add_u32 v186, v225, 6, v224
    v_add_u32 v186, s28, v186
    s_mul_i32 s29, s21, 448
    v_mov_b32 v187, v186
    s_waitcnt lgkmcnt(0)
    s_mov_b32 s8, s48
    s_mov_b32 s9, s49
    s_branch K1_B_ADDRD
K1_B_ADDRQ:
    s_movk_i32 s25, 2688
    v_mul_u32_u24 v224, 2688, v226
    v_lshl_add_u32 v225, v225, 2, v227
    v_and_b32 v227, 7, v225
    v_min_u32 v227, 6, v227
    v_lshl_add_u32 v187, v227, 4, v224
    v_lshrrev_b32 v225, 3, v225
    v_mul_u32_u24 v225, 896, v225
    v_add_u32 v186, v187, v225
    v_add_u32 v186, 896, v186
    s_mul_i32 s29, s21, 112
    s_sub_u32 s29, s29, 896
    s_waitcnt lgkmcnt(0)
    s_mov_b32 s8, s42
    s_mov_b32 s9, s43
K1_B_ADDRD:
    s_mov_b32 s4, s40
    s_mov_b32 s5, s41
    s_mov_b32 s6, 1835008
    s_mov_b32 s7, 0x20000
    buffer_load_dwordx4 v[112:115], v228, s[4:7], s82 offen
    buffer_load_dwordx4 v[116:119], v228, s[4:7], s82 offen offset:896
    s_add_u32 m0, s77, 0
    s_nop 0
    buffer_load_dwordx4 v184, s[4:7], s60 offen lds
    s_add_u32 m0, s77, 1024
    s_add_u32 s26, s60, 7168
    buffer_load_dwordx4 v185, s[4:7], s26 offen lds
    s_add_u32 m0, s77, 2048
    s_add_u32 s26, s60, 14336
    buffer_load_dwordx4 v184, s[4:7], s26 offen lds
    s_add_u32 m0, s77, 3072
    s_add_u32 s26, s60, 21504
    buffer_load_dwordx4 v185, s[4:7], s26 offen lds
    s_lshl_b32 s27, s23, 4
    s_mul_i32 s27, s27, s25
    s_add_u32 s81, s27, s29
    s_lshl_b32 s29, s25, 6
    s_mul_i32 s28, s24, s29
    s_add_u32 s67, s81, s28
    s_lshl_b32 s74, s25, 2
    s_mul_i32 s10, s25, 448
    s_mov_b32 s11, 0x20000
    s_add_u32 m0, s77, 16384
    s_nop 0
    buffer_load_dwordx4 v186, s[8:11], s67 offen lds
    s_add_u32 m0, s77, 17408
    s_add_u32 s75, s67, s74
    buffer_load_dwordx4 v186, s[8:11], s75 offen lds
    s_add_u32 m0, s77, 18432
    s_add_u32 s75, s75, s74
    buffer_load_dwordx4 v186, s[8:11], s75 offen lds
    s_add_u32 m0, s77, 19456
    s_add_u32 s75, s75, s74
    buffer_load_dwordx4 v186, s[8:11], s75 offen lds
    s_mov_b32 s76, s24
    s_add_u32 s76, s76, 1
    s_cmp_eq_u32 s76, 7
    s_cselect_b32 s76, 0, s76
    s_lshl_b32 s28, s76, 7
    s_add_u32 s61, s80, s28
    s_mul_i32 s28, s76, s29
    s_add_u32 s68, s81, s28
    s_add_u32 m0, s77, 32768
    s_nop 0
    buffer_load_dwordx4 v184, s[4:7], s61 offen lds
    s_add_u32 m0, s77, 33792
    s_add_u32 s26, s61, 7168
    buffer_load_dwordx4 v185, s[4:7], s26 offen lds
    s_add_u32 m0, s77, 34816
    s_add_u32 s26, s61, 14336
    buffer_load_dwordx4 v184, s[4:7], s26 offen lds
    s_add_u32 m0, s77, 35840
    s_add_u32 s26, s61, 21504
    buffer_load_dwordx4 v185, s[4:7], s26 offen lds
    s_add_u32 m0, s77, 49152
    s_nop 0
    buffer_load_dwordx4 v186, s[8:11], s68 offen lds
    s_add_u32 m0, s77, 50176
    s_add_u32 s75, s68, s74
    buffer_load_dwordx4 v186, s[8:11], s75 offen lds
    s_add_u32 m0, s77, 51200
    s_add_u32 s75, s75, s74
    buffer_load_dwordx4 v186, s[8:11], s75 offen lds
    s_add_u32 m0, s77, 52224
    s_add_u32 s75, s75, s74
    buffer_load_dwordx4 v186, s[8:11], s75 offen lds
    s_add_u32 s76, s76, 1
    s_cmp_eq_u32 s76, 7
    s_cselect_b32 s76, 0, s76
    s_lshl_b32 s28, s76, 7
    s_add_u32 s62, s80, s28
    s_mul_i32 s28, s76, s29
    s_add_u32 s69, s81, s28
    s_add_u32 s76, s76, 1
    s_cmp_eq_u32 s76, 7
    s_cselect_b32 s76, 0, s76
    s_lshl_b32 s28, s76, 7
    s_add_u32 s63, s80, s28
    s_mul_i32 s28, s76, s29
    s_add_u32 s70, s81, s28
    s_add_u32 s76, s76, 1
    s_cmp_eq_u32 s76, 7
    s_cselect_b32 s76, 0, s76
    s_lshl_b32 s28, s76, 7
    s_add_u32 s64, s80, s28
    s_mul_i32 s28, s76, s29
    s_add_u32 s71, s81, s28
    s_add_u32 s76, s76, 1
    s_cmp_eq_u32 s76, 7
    s_cselect_b32 s76, 0, s76
    s_lshl_b32 s28, s76, 7
    s_add_u32 s65, s80, s28
    s_mul_i32 s28, s76, s29
    s_add_u32 s72, s81, s28
    s_add_u32 s76, s76, 1
    s_cmp_eq_u32 s76, 7
    s_cselect_b32 s76, 0, s76
    s_lshl_b32 s28, s76, 7
    s_add_u32 s66, s80, s28
    s_mul_i32 s28, s76, s29
    s_add_u32 s73, s81, s28
    v_lshlrev_b32 v240, 4, v241
    v_and_b32 v243, 31, v241
    s_mov_b32 s34, 0
    s_mov_b32 s35, -1
    s_mov_b32 s36, 0x3f3504f3
    s_mov_b32 s37, 0x3f317218
    s_mov_b32 s38, 0x35c1a2a0
    v_bfe_u32 v224, v241, 4, 1
    v_and_b32 v225, 15, v241
    v_cmp_eq_u32 vcc, v224, v225
    v_mov_b32 v224, 0x3f803f80
    v_mov_b32 v247, 0
    v_cndmask_b32 v216, 0, v224, vcc
    v_mov_b32 v217, v216
    v_mov_b32 v218, v216
    v_mov_b32 v219, v216
    v_mov_b32 v220, 0
    v_mov_b32 v212, 0
    v_mov_b32 v221, 0
    v_mov_b32 v213, 0
    v_mov_b32 v222, 0
    v_mov_b32 v214, 0
    v_mov_b32 v223, 0
    v_mov_b32 v215, 0
    v_mov_b32 v245, s38
    s_lshl_b32 s87, s20, 2
    s_add_u32 s87, s87, s23
    s_mov_b32 s12, s58
    s_mov_b32 s13, s59
    s_mov_b32 s14, 268435456
    s_mov_b32 s15, 0x20000
    s_mov_b32 s16, s50
    s_mov_b32 s17, s51
    s_mov_b32 s18, 3584
    s_mov_b32 s19, 0x20000
    s_cmp_ge_u32 s21, 8
    s_cbranch_scc1 K1_B_SETQ
    v_lshrrev_b32 v226, 4, v241
    v_bfe_u32 v225, v241, 2, 2
    v_xor_b32 v225, v225, v226
    v_and_b32 v227, 3, v241
    v_mul_u32_u24 v224, 3584, v226
    v_lshl_add_u32 v224, v227, 4, v224
    v_min_u32 v225, 2, v225
    v_lshl_add_u32 v187, v225, 6, v224
    v_add_u32 v187, 256, v187
    s_and_b32 s27, s21, 1
    s_lshl_b32 s28, s27, 8
    v_mov_b32 v228, s28
    v_cmp_eq_u32 vcc, 0, v225
    s_nop 1
    v_cndmask_b32 v228, 0, v228, vcc
    v_sub_u32 v187, v187, v228
    v_bfe_u32 v224, v241, 4, 1
    v_lshlrev_b32 v224, 5, v224
    v_and_b32 v227, 3, v241
    v_lshl_add_u32 v224, v227, 3, v224
    v_bfe_u32 v225, v241, 2, 2
    v_lshrrev_b32 v226, 5, v241
    v_lshl_add_u32 v226, v226, 3, v225
    v_lshlrev_b32 v226, 8, v226
    s_cmp_eq_u32 s23, 3
    s_cselect_b32 s28, 0, s23
    s_add_u32 s28, s28, 0
    s_cmp_ge_u32 s28, 3
    s_cselect_b32 s29, 3, 0
    s_sub_u32 s28, s28, s29
    s_lshl_b32 s28, s28, 6
    v_add_u32 v227, s28, v224
    v_lshrrev_b32 v228, 6, v227
    v_xor_b32 v228, v228, v225
    v_lshlrev_b32 v228, 6, v228
    v_and_b32 v227, 63, v227
    v_add3_u32 v192, v228, v227, v226
    s_cmp_eq_u32 s23, 3
    s_cselect_b32 s28, 0, s23
    s_add_u32 s28, s28, 1
    s_cmp_ge_u32 s28, 3
    s_cselect_b32 s29, 3, 0
    s_sub_u32 s28, s28, s29
    s_lshl_b32 s28, s28, 6
    v_add_u32 v227, s28, v224
    v_lshrrev_b32 v228, 6, v227
    v_xor_b32 v228, v228, v225
    v_lshlrev_b32 v228, 6, v228
    v_and_b32 v227, 63, v227
    v_add3_u32 v193, v228, v227, v226
    s_cmp_eq_u32 s23, 3
    s_cselect_b32 s28, 0, s23
    s_add_u32 s28, s28, 2
    s_cmp_ge_u32 s28, 3
    s_cselect_b32 s29, 3, 0
    s_sub_u32 s28, s28, s29
    s_lshl_b32 s28, s28, 6
    v_add_u32 v227, s28, v224
    v_lshrrev_b32 v228, 6, v227
    v_xor_b32 v228, v228, v225
    v_lshlrev_b32 v228, 6, v228
    v_and_b32 v227, 63, v227
    v_add3_u32 v194, v228, v227, v226
    s_mul_i32 s26, s21, 7
    s_and_b32 s27, s21, 1
    s_cmp_eq_u32 s23, 3
    s_cselect_b32 s28, 0, s23
    s_add_u32 s28, s28, 0
    s_cmp_ge_u32 s28, 3
    s_cselect_b32 s29, 3, 0
    s_sub_u32 s28, s28, s29
    s_add_u32 s29, s28, 4
    s_or_b32 s28, s28, 0
    s_cselect_b32 s28, 0, s27
    s_lshl_b32 s28, s28, 2
    s_sub_u32 s29, s29, s28
    s_add_u32 s84, s29, s26
    s_cmp_eq_u32 s23, 3
    s_cselect_b32 s28, 0, s23
    s_add_u32 s28, s28, 1
    s_cmp_ge_u32 s28, 3
    s_cselect_b32 s29, 3, 0
    s_sub_u32 s28, s28, s29
    s_add_u32 s29, s28, 4
    s_or_b32 s28, s28, 0
    s_cselect_b32 s28, 0, s27
    s_lshl_b32 s28, s28, 2
    s_sub_u32 s29, s29, s28
    s_add_u32 s85, s29, s26
    s_cmp_eq_u32 s23, 3
    s_cselect_b32 s28, 0, s23
    s_add_u32 s28, s28, 2
    s_cmp_ge_u32 s28, 3
    s_cselect_b32 s29, 3, 0
    s_sub_u32 s28, s28, s29
    s_add_u32 s29, s28, 4
    s_or_b32 s28, s28, 0
    s_cselect_b32 s28, 0, s27
    s_lshl_b32 s28, s28, 2
    s_sub_u32 s29, s29, s28
    s_add_u32 s86, s29, s26
    s_lshr_b32 s26, s87, 1
    s_lshl_b32 s26, s26, 2
    s_lshr_b32 s27, s21, 1
    s_add_u32 s26, s26, s27
    s_lshl_b32 s26, s26, 7
    s_and_b32 s27, s87, 1
    s_lshl_b32 s27, s27, 1
    s_add_u32 s26, s26, s27
    s_and_b32 s27, s21, 1
    s_add_u32 s26, s26, s27
    s_lshl_b32 s26, s26, 2
    s_add_u32 s51, s26, 11599872
    s_add_u32 s51, s51, 16
    s_branch K1_B_SETD
K1_B_SETQ:
    v_bfe_u32 v224, v241, 4, 1
    v_lshlrev_b32 v224, 5, v224
    v_and_b32 v227, 3, v241
    v_lshl_add_u32 v224, v227, 3, v224
    v_bfe_u32 v225, v241, 2, 2
    v_lshrrev_b32 v226, 5, v241
    v_lshl_add_u32 v226, v226, 3, v225
    v_lshlrev_b32 v226, 8, v226
    s_mov_b32 s28, 0
    v_add_u32 v227, s28, v224
    v_lshrrev_b32 v228, 6, v227
    v_xor_b32 v228, v228, v225
    v_lshlrev_b32 v228, 6, v228
    v_and_b32 v227, 63, v227
    v_add3_u32 v192, v228, v227, v226
    s_mov_b32 s28, 56
    v_add_u32 v227, s28, v224
    v_lshrrev_b32 v228, 6, v227
    v_xor_b32 v228, v228, v225
    v_lshlrev_b32 v228, 6, v228
    v_and_b32 v227, 63, v227
    v_add3_u32 v193, v228, v227, v226
    v_mov_b32 v194, v192
    s_sub_u32 s86, s21, 8
    s_lshl_b32 s84, s86, 1
    s_add_u32 s85, s84, 1
    s_lshr_b32 s26, s87, 1
    s_lshl_b32 s26, s26, 2
    s_lshr_b32 s27, s86, 1
    s_add_u32 s26, s26, s27
    s_lshl_b32 s26, s26, 7
    s_and_b32 s27, s87, 1
    s_lshl_b32 s27, s27, 1
    s_add_u32 s26, s26, s27
    s_and_b32 s27, s86, 1
    s_add_u32 s26, s26, s27
    s_lshl_b32 s26, s26, 2
    s_add_u32 s51, s26, 11599872
    s_add_u32 s51, s51, 48
K1_B_SETD:
    s_lshl_b32 s26, s84, 6
    v_lshlrev_b32 v230, 1, v243
    buffer_load_ushort v198, v230, s[16:19], s26 offen
    s_lshl_b32 s26, s85, 6
    v_lshlrev_b32 v230, 1, v243
    buffer_load_ushort v199, v230, s[16:19], s26 offen
    s_lshl_b32 s26, s86, 6
    v_lshlrev_b32 v230, 1, v243
    buffer_load_ushort v196, v230, s[16:19], s26 offen
    s_lshl_b32 s26, s23, 5
    v_add_u32 v227, s26, v243
    v_bfe_u32 v228, v227, 1, 3
    v_lshrrev_b32 v229, 5, v241
    v_xor_b32 v228, v228, v229
    v_lshlrev_b32 v228, 4, v228
    v_lshl_add_u32 v188, v227, 7, v228
    v_xor_b32 v189, 32, v188
    v_xor_b32 v190, 64, v188
    v_xor_b32 v191, 96, v188
    s_lshl_b32 s46, s23, 14
    s_add_u32 s46, s46, 81920
    v_lshrrev_b32 v224, 3, v241
    v_mul_u32_u24 v225, 896, v224
    v_bfe_u32 v226, v241, 4, 1
    v_lshlrev_b32 v226, 2, v226
    v_and_b32 v227, 7, v241
    v_xor_b32 v226, v226, v227
    v_lshl_add_u32 v204, v226, 4, v225
    v_lshl_add_u32 v210, v227, 4, v225
    v_lshlrev_b32 v227, 1, v227
    v_xor_b32 v227, v227, v224
    v_lshlrev_b32 v227, 4, v227
    v_lshl_add_u32 v197, v224, 8, v227
    s_lshl_b32 s26, s23, 11
    v_add_u32 v197, s26, v197
    v_bfe_u32 v224, v241, 2, 2
    v_lshrrev_b32 v225, 5, v241
    v_lshl_add_u32 v225, v225, 2, v224
    v_lshlrev_b32 v225, 7, v225
    v_bfe_u32 v226, v241, 4, 1
    v_lshl_add_u32 v225, v226, 5, v225
    v_and_b32 v226, 3, v241
    v_lshl_add_u32 v225, v226, 3, v225
    v_add_u32 v225, s46, v225
    v_bfe_u32 v226, v241, 3, 1
    v_lshl_add_u32 v206, v226, 6, v225
    v_xor_b32 v207, 64, v206
    v_lshrrev_b32 v224, 5, v241
    v_and_b32 v225, 7, v241
    v_xor_b32 v224, v224, v225
    v_lshlrev_b32 v224, 4, v224
    v_lshl_add_u32 v224, v243, 8, v224
    v_add_u32 v205, s46, v224
    s_lshl_b32 s26, s23, 2
    s_add_u32 s26, s26, 161312
    v_mov_b32 v224, s26
    ds_write_b32 v224, v247
    v_mov_b32 v225, 161328
    ds_write_b32 v225, v247
    global_load_dword v246, v247, s[56:57] sc1
    s_waitcnt lgkmcnt(0)
    s_waitcnt vmcnt(20)
    s_mov_b32 s28, 0x3f803f80
    v_mov_b32 v120, 0
    v_mov_b32 v121, 0
    v_mov_b32 v122, 0
    v_mov_b32 v123, 0
    v_dot2_f32_bf16 v120, v112, s28, v120
    v_dot2_f32_bf16 v121, v112, v112, v121
    v_dot2_f32_bf16 v122, v116, s28, v122
    v_dot2_f32_bf16 v123, v116, v116, v123
    v_dot2_f32_bf16 v120, v113, s28, v120
    v_dot2_f32_bf16 v121, v113, v113, v121
    v_dot2_f32_bf16 v122, v117, s28, v122
    v_dot2_f32_bf16 v123, v117, v117, v123
    v_dot2_f32_bf16 v120, v114, s28, v120
    v_dot2_f32_bf16 v121, v114, v114, v121
    v_dot2_f32_bf16 v122, v118, s28, v122
    v_dot2_f32_bf16 v123, v118, v118, v123
    v_dot2_f32_bf16 v120, v115, s28, v120
    v_dot2_f32_bf16 v121, v115, v115, v121
    v_dot2_f32_bf16 v122, v119, s28, v122
    v_dot2_f32_bf16 v123, v119, v119, v123
    s_nop 2
    v_add_f32_dpp v120, v120, v120 row_shr:1 row_mask:0xf bank_mask:0xf
    v_add_f32_dpp v121, v121, v121 row_shr:1 row_mask:0xf bank_mask:0xf
    v_add_f32_dpp v122, v122, v122 row_shr:1 row_mask:0xf bank_mask:0xf
    v_add_f32_dpp v123, v123, v123 row_shr:1 row_mask:0xf bank_mask:0xf
    v_add_f32_dpp v120, v120, v120 row_shr:2 row_mask:0xf bank_mask:0xf
    v_add_f32_dpp v121, v121, v121 row_shr:2 row_mask:0xf bank_mask:0xf
    v_add_f32_dpp v122, v122, v122 row_shr:2 row_mask:0xf bank_mask:0xf
    v_add_f32_dpp v123, v123, v123 row_shr:2 row_mask:0xf bank_mask:0xf
    v_add_f32_dpp v120, v120, v120 row_shr:4 row_mask:0xf bank_mask:0xf
    v_add_f32_dpp v121, v121, v121 row_shr:4 row_mask:0xf bank_mask:0xf
    v_add_f32_dpp v122, v122, v122 row_shr:4 row_mask:0xf bank_mask:0xf
    v_add_f32_dpp v123, v123, v123 row_shr:4 row_mask:0xf bank_mask:0xf
    v_add_f32_dpp v120, v120, v120 row_shr:8 row_mask:0xf bank_mask:0xf
    v_add_f32_dpp v121, v121, v121 row_shr:8 row_mask:0xf bank_mask:0xf
    v_add_f32_dpp v122, v122, v122 row_shr:8 row_mask:0xf bank_mask:0xf
    v_add_f32_dpp v123, v123, v123 row_shr:8 row_mask:0xf bank_mask:0xf
    v_add_f32_dpp v120, v120, v120 row_bcast:15 row_mask:0xa bank_mask:0xf
    v_add_f32_dpp v121, v121, v121 row_bcast:15 row_mask:0xa bank_mask:0xf
    v_add_f32_dpp v122, v122, v122 row_bcast:15 row_mask:0xa bank_mask:0xf
    v_add_f32_dpp v123, v123, v123 row_bcast:15 row_mask:0xa bank_mask:0xf
    v_add_f32_dpp v120, v120, v120 row_bcast:31 row_mask:0xc bank_mask:0xf
    v_add_f32_dpp v121, v121, v121 row_bcast:31 row_mask:0xc bank_mask:0xf
    v_add_f32_dpp v122, v122, v122 row_bcast:31 row_mask:0xc bank_mask:0xf
    v_add_f32_dpp v123, v123, v123 row_bcast:31 row_mask:0xc bank_mask:0xf
    v_mul_f32 v112, 0xbb124925, v120
    v_mul_f32 v113, 0x3b124925, v121
    v_mul_f32 v116, 0xbb124925, v122
    v_mul_f32 v117, 0x3b124925, v123
    v_fma_f32 v113, -v112, v112, v113
    v_max_f32 v113, 0, v113
    v_add_f32 v113, 0x3727c5ac, v113
    v_fma_f32 v117, -v116, v116, v117
    v_max_f32 v117, 0, v117
    v_add_f32 v117, 0x3727c5ac, v117
    v_rsq_f32 v114, v113
    v_rsq_f32 v118, v117
    s_nop 0
    v_mul_f32 v113, v113, v114
    v_mul_f32 v117, v117, v118
    s_waitcnt vmcnt(12)
    s_barrier
    ds_read_b128 v[0:3], v188 offset:0
    ds_read_b128 v[4:7], v189 offset:0
    ds_read_b128 v[8:11], v190 offset:0
    ds_read_b128 v[12:15], v191 offset:0
    s_add_u32 m0, s77, 65536
    s_nop 0
    buffer_load_dwordx4 v184, s[4:7], s62 offen lds
    s_add_u32 m0, s77, 66560
    s_add_u32 s26, s62, 7168
    buffer_load_dwordx4 v185, s[4:7], s26 offen lds
    s_add_u32 m0, s77, 67584
    s_add_u32 s26, s62, 14336
    buffer_load_dwordx4 v184, s[4:7], s26 offen lds
    s_add_u32 m0, s77, 68608
    s_add_u32 s26, s62, 21504
    buffer_load_dwordx4 v185, s[4:7], s26 offen lds
    s_add_u32 m0, s77, 81920
    s_nop 0
    buffer_load_dwordx4 v186, s[8:11], s69 offen lds
    s_add_u32 m0, s77, 82944
    s_add_u32 s75, s69, s74
    buffer_load_dwordx4 v186, s[8:11], s75 offen lds
    s_add_u32 m0, s77, 83968
    s_add_u32 s75, s75, s74
    buffer_load_dwordx4 v186, s[8:11], s75 offen lds
    s_add_u32 m0, s77, 84992
    s_add_u32 s75, s75, s74
    buffer_load_dwordx4 v186, s[8:11], s75 offen lds
    s_add_u32 m0, s77, 98304
    s_nop 0
    buffer_load_dwordx4 v184, s[4:7], s63 offen lds
    s_add_u32 m0, s77, 99328
    s_add_u32 s26, s63, 7168
    buffer_load_dwordx4 v185, s[4:7], s26 offen lds
    s_add_u32 m0, s77, 100352
    s_add_u32 s26, s63, 14336
    buffer_load_dwordx4 v184, s[4:7], s26 offen lds
    s_add_u32 m0, s77, 101376
    s_add_u32 s26, s63, 21504
    buffer_load_dwordx4 v185, s[4:7], s26 offen lds
    s_waitcnt lgkmcnt(0)
    s_waitcnt vmcnt(12)
    s_mov_b32 s27, 0
NON_1:
    v_readfirstlane_b32 s79, v246
    s_nop 0
    s_cmp_lg_u32 s79, 0
    s_cbranch_scc1 NOK_2
    s_add_u32 s27, s27, 1
    s_cmp_gt_u32 s27, 131072
    s_cbranch_scc1 NOK_2
    global_load_dword v246, v247, s[56:57] sc1
    s_waitcnt vmcnt(0)
    s_branch NON_1
NOK_2:
    v_mov_b32 v115, s79
    v_mov_b32 v119, s79
    s_lshl_b32 s26, s20, 4
    s_add_u32 s26, s26, s21
    s_lshl_b32 s26, s26, 2
    s_add_u32 s26, s26, s23
    s_lshl_b32 s26, s26, 5
    s_add_u32 s26, s26, 11698176
    s_mov_b32 exec_lo, 0
    s_mov_b32 exec_hi, 0x80000000
    buffer_store_dwordx4 v[112:115], off, s[12:15], s26 sc1
    buffer_store_dwordx4 v[116:119], off, s[12:15], s26 offset:16 sc1
    s_mov_b64 exec, -1
    s_waitcnt vmcnt(18)
    s_barrier
    ds_read_b128 v[16:19], v188 offset:32768
    ds_read_b128 v[20:23], v189 offset:32768
    ds_read_b128 v[24:27], v190 offset:32768
    ds_read_b128 v[28:31], v191 offset:32768
    s_add_u32 m0, s77, 114688
    s_nop 0
    buffer_load_dwordx4 v186, s[8:11], s70 offen lds
    s_add_u32 m0, s77, 115712
    s_add_u32 s75, s70, s74
    buffer_load_dwordx4 v186, s[8:11], s75 offen lds
    s_add_u32 m0, s77, 116736
    s_add_u32 s75, s75, s74
    buffer_load_dwordx4 v186, s[8:11], s75 offen lds
    s_add_u32 m0, s77, 117760
    s_add_u32 s75, s75, s74
    buffer_load_dwordx4 v186, s[8:11], s75 offen lds
    s_add_u32 m0, s77, 131072
    s_nop 0
    buffer_load_dwordx4 v184, s[4:7], s64 offen lds
    s_add_u32 m0, s77, 132096
    s_add_u32 s26, s64, 7168
    buffer_load_dwordx4 v185, s[4:7], s26 offen lds
    s_add_u32 m0, s77, 133120
    s_add_u32 s26, s64, 14336
    buffer_load_dwordx4 v184, s[4:7], s26 offen lds
    s_add_u32 m0, s77, 134144
    s_add_u32 s26, s64, 21504
    buffer_load_dwordx4 v185, s[4:7], s26 offen lds
    s_waitcnt lgkmcnt(0)
    v_mov_b32 v224, 161296
    ds_read_b32 v225, v224
    s_waitcnt lgkmcnt(0)
    v_readfirstlane_b32 s0, v225
    s_nop 0
    s_lshr_b32 s27, s0, 3
    s_mul_i32 s28, s27, 37
    s_lshr_b32 s28, s28, 8
    s_mul_i32 s26, s28, 7
    s_sub_u32 s25, s27, s26
    s_and_b32 s26, s0, 7
    s_lshl_b32 s24, s26, 2
    s_add_u32 s24, s24, s28
    s_lshl_b32 s26, s24, 3
    s_add_u32 s26, s26, s23
    s_mul_i32 s50, s26, 7168
    s_lshl_b32 s43, s25, 7
    s_add_u32 s50, s50, s43
    s_lshl_b32 s49, s24, 2
    s_add_u32 s49, s49, s23
    s_lshl_b32 s49, s49, 3
    s_add_u32 s49, s49, s25
    s_lshl_b32 s49, s49, 6
    s_add_u32 s49, s49, 11599872
    s_mul_i32 s26, s23, 401408
    s_add_u32 s48, s43, s26
    s_mul_i32 s26, s23, 100352
    s_add_u32 s43, s43, s26
    s_lshr_b32 s26, s24, 1
    s_lshl_b32 s26, s26, 2
    s_add_u32 s26, s26, s25
    s_and_b32 s26, s26, 7
    s_mul_i32 s26, s26, 0x11111111
    s_xor_b32 s26, s26, 0x76543210
    s_and_b32 s27, s26, 0x44444444
    s_lshl_b32 s27, s27, 1
    s_and_b32 s26, s26, 0x33333333
    s_and_b32 s28, s24, 1
    s_mul_i32 s28, s28, 0x44444444
    s_add_u32 s26, s26, s28
    s_add_u32 s26, s26, 0x22222222
    s_and_b32 s3, s26, 0x77777777
    s_or_b32 s3, s3, s27
    s_xor_b32 s1, s3, 0x44444444
    s_lshl_b32 s42, s24, 5
    s_lshl_b32 s26, s23, 2
    s_add_u32 s42, s42, s26
    s_lshl_b32 s42, s42, 11
    s_add_u32 s42, s42, 7340032
    s_lshl_b32 s47, s24, 3
    s_add_u32 s47, s47, s25
    s_lshl_b32 s47, s47, 2
    s_add_u32 s47, s47, s23
    s_lshl_b32 s47, s47, 5
    s_add_u32 s47, s47, 11665408
    s_waitcnt vmcnt(14)
    s_barrier
    v_add_u32 v200, 65536, v188
    v_add_u32 v201, 65536, v189
    v_add_u32 v202, 65536, v190
    v_add_u32 v203, 65536, v191
    ds_read_b128 v[32:35], v200 offset:0
    ds_read_b128 v[36:39], v201 offset:0
    ds_read_b128 v[40:43], v202 offset:0
    ds_read_b128 v[44:47], v203 offset:0
    s_add_u32 m0, s77, 0
    s_nop 0
    buffer_load_dwordx4 v186, s[8:11], s71 offen lds
    s_add_u32 m0, s77, 1024
    s_add_u32 s75, s71, s74
    buffer_load_dwordx4 v186, s[8:11], s75 offen lds
    s_add_u32 m0, s77, 2048
    s_add_u32 s75, s75, s74
    buffer_load_dwordx4 v186, s[8:11], s75 offen lds
    s_add_u32 m0, s77, 3072
    s_add_u32 s75, s75, s74
    buffer_load_dwordx4 v186, s[8:11], s75 offen lds
    s_add_u32 m0, s77, 16384
    s_nop 0
    buffer_load_dwordx4 v184, s[4:7], s65 offen lds
    s_add_u32 m0, s77, 17408
    s_add_u32 s26, s65, 7168
    buffer_load_dwordx4 v185, s[4:7], s26 offen lds
    s_add_u32 m0, s77, 18432
    s_add_u32 s26, s65, 14336
    buffer_load_dwordx4 v184, s[4:7], s26 offen lds
    s_add_u32 m0, s77, 19456
    s_add_u32 s26, s65, 21504
    buffer_load_dwordx4 v185, s[4:7], s26 offen lds
    s_waitcnt lgkmcnt(0)
    s_waitcnt vmcnt(12)
    s_barrier
    v_add_u32 v200, 98304, v188
    v_add_u32 v201, 98304, v189
    v_add_u32 v202, 98304, v190
    v_add_u32 v203, 98304, v191
    ds_read_b128 v[48:51], v200 offset:0
    ds_read_b128 v[52:55], v201 offset:0
    ds_read_b128 v[56:59], v202 offset:0
    ds_read_b128 v[60:63], v203 offset:0
    s_add_u32 m0, s77, 32768
    s_nop 0
    buffer_load_dwordx4 v186, s[8:11], s72 offen lds
    s_add_u32 m0, s77, 33792
    s_add_u32 s75, s72, s74
    buffer_load_dwordx4 v186, s[8:11], s75 offen lds
    s_add_u32 m0, s77, 34816
    s_add_u32 s75, s75, s74
    buffer_load_dwordx4 v186, s[8:11], s75 offen lds
    s_add_u32 m0, s77, 35840
    s_add_u32 s75, s75, s74
    buffer_load_dwordx4 v186, s[8:11], s75 offen lds
    s_add_u32 m0, s77, 49152
    s_nop 0
    buffer_load_dwordx4 v184, s[4:7], s66 offen lds
    s_add_u32 m0, s77, 50176
    s_add_u32 s26, s66, 7168
    buffer_load_dwordx4 v185, s[4:7], s26 offen lds
    s_add_u32 m0, s77, 51200
    s_add_u32 s26, s66, 14336
    buffer_load_dwordx4 v184, s[4:7], s26 offen lds
    s_add_u32 m0, s77, 52224
    s_add_u32 s26, s66, 21504
    buffer_load_dwordx4 v185, s[4:7], s26 offen lds
    s_waitcnt lgkmcnt(0)
    s_waitcnt vmcnt(12)
    s_barrier
    v_add_u32 v200, 131072, v188
    v_add_u32 v201, 131072, v189
    v_add_u32 v202, 131072, v190
    v_add_u32 v203, 131072, v191
    ds_read_b128 v[64:67], v200 offset:0
    ds_read_b128 v[68:71], v201 offset:0
    ds_read_b128 v[72:75], v202 offset:0
    ds_read_b128 v[76:79], v203 offset:0
    s_add_u32 m0, s77, 65536
    s_nop 0
    buffer_load_dwordx4 v186, s[8:11], s73 offen lds
    s_add_u32 m0, s77, 66560
    s_add_u32 s75, s73, s74
    buffer_load_dwordx4 v186, s[8:11], s75 offen lds
    s_add_u32 m0, s77, 67584
    s_add_u32 s75, s75, s74
    buffer_load_dwordx4 v186, s[8:11], s75 offen lds
    s_add_u32 m0, s77, 68608
    s_add_u32 s75, s75, s74
    buffer_load_dwordx4 v186, s[8:11], s75 offen lds
    s_add_u32 m0, s77, 81920
    s_nop 0
    buffer_load_dwordx4 v187, s[8:11], s69 offen lds
    s_add_u32 m0, s77, 82944
    s_add_u32 s75, s69, s74
    buffer_load_dwordx4 v187, s[8:11], s75 offen lds
    s_add_u32 m0, s77, 83968
    s_add_u32 s75, s75, s74
    buffer_load_dwordx4 v187, s[8:11], s75 offen lds
    s_add_u32 m0, s77, 84992
    s_add_u32 s75, s75, s74
    buffer_load_dwordx4 v187, s[8:11], s75 offen lds
    s_waitcnt lgkmcnt(0)
    s_waitcnt vmcnt(12)
    s_barrier
    ds_read_b128 v[80:83], v188 offset:16384
    ds_read_b128 v[84:87], v189 offset:16384
    ds_read_b128 v[88:91], v190 offset:16384
    ds_read_b128 v[92:95], v191 offset:16384
    s_add_u32 m0, s77, 98304
    s_nop 0
    buffer_load_dwordx4 v187, s[8:11], s70 offen lds
    s_add_u32 m0, s77, 99328
    s_add_u32 s75, s70, s74
    buffer_load_dwordx4 v187, s[8:11], s75 offen lds
    s_add_u32 m0, s77, 100352
    s_add_u32 s75, s75, s74
    buffer_load_dwordx4 v187, s[8:11], s75 offen lds
    s_add_u32 m0, s77, 101376
    s_add_u32 s75, s75, s74
    buffer_load_dwordx4 v187, s[8:11], s75 offen lds
    s_add_u32 m0, s77, 114688
    s_nop 0
    buffer_load_dwordx4 v187, s[8:11], s71 offen lds
    s_add_u32 m0, s77, 115712
    s_add_u32 s75, s71, s74
    buffer_load_dwordx4 v187, s[8:11], s75 offen lds
    s_add_u32 m0, s77, 116736
    s_add_u32 s75, s75, s74
    buffer_load_dwordx4 v187, s[8:11], s75 offen lds
    s_add_u32 m0, s77, 117760
    s_add_u32 s75, s75, s74
    buffer_load_dwordx4 v187, s[8:11], s75 offen lds
    s_waitcnt lgkmcnt(0)
    s_waitcnt vmcnt(12)
    s_barrier
    ds_read_b128 v[96:99], v188 offset:49152
    ds_read_b128 v[100:103], v189 offset:49152
    ds_read_b128 v[104:107], v190 offset:49152
    ds_read_b128 v[108:111], v191 offset:49152
    s_add_u32 m0, s77, 131072
    s_nop 0
    buffer_load_dwordx4 v187, s[8:11], s72 offen lds
    s_add_u32 m0, s77, 132096
    s_add_u32 s75, s72, s74
    buffer_load_dwordx4 v187, s[8:11], s75 offen lds
    s_add_u32 m0, s77, 133120
    s_add_u32 s75, s75, s74
    buffer_load_dwordx4 v187, s[8:11], s75 offen lds
    s_add_u32 m0, s77, 134144
    s_add_u32 s75, s75, s74
    buffer_load_dwordx4 v187, s[8:11], s75 offen lds
    s_add_u32 m0, s77, 0
    s_nop 0
    buffer_load_dwordx4 v187, s[8:11], s73 offen lds
    s_add_u32 m0, s77, 1024
    s_add_u32 s75, s73, s74
    buffer_load_dwordx4 v187, s[8:11], s75 offen lds
    s_add_u32 m0, s77, 2048
    s_add_u32 s75, s75, s74
    buffer_load_dwordx4 v187, s[8:11], s75 offen lds
    s_add_u32 m0, s77, 3072
    s_add_u32 s75, s75, s74
    buffer_load_dwordx4 v187, s[8:11], s75 offen lds
    s_waitcnt lgkmcnt(0)
    s_cmp_ge_u32 s21, 8
    s_cbranch_scc1 K1_B_BETAQ
    v_add_u32 v200, 81920, v192
    v_add_u32 v201, 81920, v193
    v_add_u32 v202, 81920, v194
    s_mov_b32 s16, s52
    s_mov_b32 s17, s53
    s_mov_b32 s18, 1605632
    s_mov_b32 s19, 0x20000
    s_waitcnt vmcnt(8)
    s_barrier
    ds_read_b64_tr_b16 v[160:161], v200 offset:0
    ds_read_b64_tr_b16 v[162:163], v200 offset:1024
    ds_read_b64_tr_b16 v[164:165], v201 offset:0
    ds_read_b64_tr_b16 v[166:167], v201 offset:1024
    ds_read_b64_tr_b16 v[168:169], v202 offset:0
    ds_read_b64_tr_b16 v[170:171], v202 offset:1024
    s_waitcnt lgkmcnt(4)
    v_mfma_f32_32x32x16_bf16 v[112:127], v[160:163], v[32:35], 0
    v_mfma_f32_16x16x32_bf16 v[220:223], v[160:163], v[216:219], v[220:223]
    ds_read_b64_tr_b16 v[172:173], v200 offset:4096
    ds_read_b64_tr_b16 v[174:175], v200 offset:5120
    s_add_u32 m0, s77, 16384
    s_nop 0
    s_waitcnt lgkmcnt(4)
    v_mfma_f32_32x32x16_bf16 v[128:143], v[164:167], v[32:35], 0
    ds_read_b64_tr_b16 v[176:177], v201 offset:4096
    ds_read_b64_tr_b16 v[178:179], v201 offset:5120
    buffer_load_dwordx4 v187, s[8:11], s67 offen lds
    s_add_u32 m0, s77, 17408
    s_waitcnt lgkmcnt(4)
    v_mfma_f32_32x32x16_bf16 v[144:159], v[168:171], v[32:35], 0
    ds_read_b64_tr_b16 v[180:181], v202 offset:4096
    ds_read_b64_tr_b16 v[182:183], v202 offset:5120
    s_add_u32 s75, s67, s74
    buffer_load_dwordx4 v187, s[8:11], s75 offen lds
    s_waitcnt lgkmcnt(4)
    v_mfma_f32_32x32x16_bf16 v[112:127], v[172:175], v[36:39], v[112:127]
    v_mfma_f32_16x16x32_bf16 v[220:223], v[172:175], v[216:219], v[220:223]
    ds_read_b64_tr_b16 v[160:161], v200 offset:8192
    ds_read_b64_tr_b16 v[162:163], v200 offset:9216
    s_add_u32 m0, s77, 18432
    s_add_u32 s75, s75, s74
    s_waitcnt lgkmcnt(4)
    v_mfma_f32_32x32x16_bf16 v[128:143], v[176:179], v[36:39], v[128:143]
    ds_read_b64_tr_b16 v[164:165], v201 offset:8192
    ds_read_b64_tr_b16 v[166:167], v201 offset:9216
    buffer_load_dwordx4 v187, s[8:11], s75 offen lds
    s_add_u32 m0, s77, 19456
    s_waitcnt lgkmcnt(4)
    v_mfma_f32_32x32x16_bf16 v[144:159], v[180:183], v[36:39], v[144:159]
    ds_read_b64_tr_b16 v[168:169], v202 offset:8192
    ds_read_b64_tr_b16 v[170:171], v202 offset:9216
    s_add_u32 s75, s75, s74
    buffer_load_dwordx4 v187, s[8:11], s75 offen lds
    s_waitcnt lgkmcnt(4)
    v_mfma_f32_32x32x16_bf16 v[112:127], v[160:163], v[40:43], v[112:127]
    v_mfma_f32_16x16x32_bf16 v[220:223], v[160:163], v[216:219], v[220:223]
    ds_read_b64_tr_b16 v[172:173], v200 offset:12288
    ds_read_b64_tr_b16 v[174:175], v200 offset:13312
    s_add_u32 m0, s77, 32768
    s_nop 0
    s_waitcnt lgkmcnt(4)
    v_mfma_f32_32x32x16_bf16 v[128:143], v[164:167], v[40:43], v[128:143]
    ds_read_b64_tr_b16 v[176:177], v201 offset:12288
    ds_read_b64_tr_b16 v[178:179], v201 offset:13312
    buffer_load_dwordx4 v187, s[8:11], s68 offen lds
    s_add_u32 m0, s77, 33792
    s_waitcnt lgkmcnt(4)
    v_mfma_f32_32x32x16_bf16 v[144:159], v[168:171], v[40:43], v[144:159]
    ds_read_b64_tr_b16 v[180:181], v202 offset:12288
    ds_read_b64_tr_b16 v[182:183], v202 offset:13312
    s_add_u32 s75, s68, s74
    buffer_load_dwordx4 v187, s[8:11], s75 offen lds
    v_add_u32 v200, 98304, v192
    v_add_u32 v201, 98304, v193
    v_add_u32 v202, 98304, v194
    s_waitcnt lgkmcnt(4)
    v_mfma_f32_32x32x16_bf16 v[112:127], v[172:175], v[44:47], v[112:127]
    v_mfma_f32_16x16x32_bf16 v[220:223], v[172:175], v[216:219], v[220:223]
    ds_read_b64_tr_b16 v[160:161], v200 offset:0
    ds_read_b64_tr_b16 v[162:163], v200 offset:1024
    s_add_u32 m0, s77, 34816
    s_add_u32 s75, s75, s74
    s_waitcnt lgkmcnt(4)
    v_mfma_f32_32x32x16_bf16 v[128:143], v[176:179], v[44:47], v[128:143]
    ds_read_b64_tr_b16 v[164:165], v201 offset:0
    ds_read_b64_tr_b16 v[166:167], v201 offset:1024
    buffer_load_dwordx4 v187, s[8:11], s75 offen lds
    s_add_u32 m0, s77, 35840
    s_waitcnt lgkmcnt(4)
    v_mfma_f32_32x32x16_bf16 v[144:159], v[180:183], v[44:47], v[144:159]
    ds_read_b64_tr_b16 v[168:169], v202 offset:0
    ds_read_b64_tr_b16 v[170:171], v202 offset:1024
    s_add_u32 s75, s75, s74
    buffer_load_dwordx4 v187, s[8:11], s75 offen lds
    s_waitcnt lgkmcnt(4)
    v_mfma_f32_32x32x16_bf16 v[112:127], v[160:163], v[48:51], v[112:127]
    v_mfma_f32_16x16x32_bf16 v[220:223], v[160:163], v[216:219], v[220:223]
    ds_read_b64_tr_b16 v[172:173], v200 offset:4096
    ds_read_b64_tr_b16 v[174:175], v200 offset:5120
    s_bfe_u32 s76, s3, 0x40000
    s_and_b32 s29, s76, 8
    s_add_u32 s76, s76, s29
    s_waitcnt lgkmcnt(4)
    v_mfma_f32_32x32x16_bf16 v[128:143], v[164:167], v[48:51], v[128:143]
    ds_read_b64_tr_b16 v[176:177], v201 offset:4096
    ds_read_b64_tr_b16 v[178:179], v201 offset:5120
    s_lshl_b32 s76, s76, 10
    s_mul_i32 s76, s76, 14
    s_add_u32 s76, s76, s48
    s_waitcnt lgkmcnt(4)
    v_mfma_f32_32x32x16_bf16 v[144:159], v[168:171], v[48:51], v[144:159]
    ds_read_b64_tr_b16 v[180:181], v202 offset:4096
    ds_read_b64_tr_b16 v[182:183], v202 offset:5120
    s_add_u32 s78, s76, 7168
    buffer_load_dwordx4 v[32:35], v204, s[16:19], s76 offen
    buffer_load_dwordx4 v[36:39], v204, s[16:19], s78 offen
    s_waitcnt lgkmcnt(4)
    v_mfma_f32_32x32x16_bf16 v[112:127], v[172:175], v[52:55], v[112:127]
    v_mfma_f32_16x16x32_bf16 v[220:223], v[172:175], v[216:219], v[220:223]
    ds_read_b64_tr_b16 v[160:161], v200 offset:8192
    ds_read_b64_tr_b16 v[162:163], v200 offset:9216
    s_bfe_u32 s76, s3, 0x40004
    s_and_b32 s29, s76, 8
    s_add_u32 s76, s76, s29
    s_waitcnt lgkmcnt(4)
    v_mfma_f32_32x32x16_bf16 v[128:143], v[176:179], v[52:55], v[128:143]
    ds_read_b64_tr_b16 v[164:165], v201 offset:8192
    ds_read_b64_tr_b16 v[166:167], v201 offset:9216
    s_lshl_b32 s76, s76, 10
    s_mul_i32 s76, s76, 14
    s_add_u32 s76, s76, s48
    s_waitcnt lgkmcnt(4)
    v_mfma_f32_32x32x16_bf16 v[144:159], v[180:183], v[52:55], v[144:159]
    ds_read_b64_tr_b16 v[168:169], v202 offset:8192
    ds_read_b64_tr_b16 v[170:171], v202 offset:9216
    s_add_u32 s78, s76, 7168
    buffer_load_dwordx4 v[40:43], v204, s[16:19], s76 offen
    s_waitcnt lgkmcnt(4)
    v_mfma_f32_32x32x16_bf16 v[112:127], v[160:163], v[56:59], v[112:127]
    v_mfma_f32_16x16x32_bf16 v[220:223], v[160:163], v[216:219], v[220:223]
    ds_read_b64_tr_b16 v[172:173], v200 offset:12288
    ds_read_b64_tr_b16 v[174:175], v200 offset:13312
    buffer_load_dwordx4 v[44:47], v204, s[16:19], s78 offen
    s_waitcnt lgkmcnt(4)
    v_mfma_f32_32x32x16_bf16 v[128:143], v[164:167], v[56:59], v[128:143]
    ds_read_b64_tr_b16 v[176:177], v201 offset:12288
    ds_read_b64_tr_b16 v[178:179], v201 offset:13312
    s_waitcnt lgkmcnt(4)
    v_mfma_f32_32x32x16_bf16 v[144:159], v[168:171], v[56:59], v[144:159]
    ds_read_b64_tr_b16 v[180:181], v202 offset:12288
    ds_read_b64_tr_b16 v[182:183], v202 offset:13312
    v_add_u32 v200, 114688, v192
    v_add_u32 v201, 114688, v193
    v_add_u32 v202, 114688, v194
    s_waitcnt lgkmcnt(4)
    v_mfma_f32_32x32x16_bf16 v[112:127], v[172:175], v[60:63], v[112:127]
    v_mfma_f32_16x16x32_bf16 v[220:223], v[172:175], v[216:219], v[220:223]
    ds_read_b64_tr_b16 v[160:161], v200 offset:0
    ds_read_b64_tr_b16 v[162:163], v200 offset:1024
    s_bfe_u32 s76, s3, 0x40008
    s_and_b32 s29, s76, 8
    s_add_u32 s76, s76, s29
    s_waitcnt lgkmcnt(4)
    v_mfma_f32_32x32x16_bf16 v[128:143], v[176:179], v[60:63], v[128:143]
    ds_read_b64_tr_b16 v[164:165], v201 offset:0
    ds_read_b64_tr_b16 v[166:167], v201 offset:1024
    s_lshl_b32 s76, s76, 10
    s_mul_i32 s76, s76, 14
    s_add_u32 s76, s76, s48
    s_waitcnt lgkmcnt(4)
    v_mfma_f32_32x32x16_bf16 v[144:159], v[180:183], v[60:63], v[144:159]
    ds_read_b64_tr_b16 v[168:169], v202 offset:0
    ds_read_b64_tr_b16 v[170:171], v202 offset:1024
    s_add_u32 s78, s76, 7168
    buffer_load_dwordx4 v[48:51], v204, s[16:19], s76 offen
    s_waitcnt lgkmcnt(4)
    v_mfma_f32_32x32x16_bf16 v[112:127], v[160:163], v[64:67], v[112:127]
    v_mfma_f32_16x16x32_bf16 v[220:223], v[160:163], v[216:219], v[220:223]
    ds_read_b64_tr_b16 v[172:173], v200 offset:4096
    ds_read_b64_tr_b16 v[174:175], v200 offset:5120
    buffer_load_dwordx4 v[52:55], v204, s[16:19], s78 offen
    s_waitcnt lgkmcnt(4)
    v_mfma_f32_32x32x16_bf16 v[128:143], v[164:167], v[64:67], v[128:143]
    ds_read_b64_tr_b16 v[176:177], v201 offset:4096
    ds_read_b64_tr_b16 v[178:179], v201 offset:5120
    s_waitcnt lgkmcnt(4)
    v_mfma_f32_32x32x16_bf16 v[144:159], v[168:171], v[64:67], v[144:159]
    ds_read_b64_tr_b16 v[180:181], v202 offset:4096
    ds_read_b64_tr_b16 v[182:183], v202 offset:5120
    s_waitcnt lgkmcnt(4)
    v_mfma_f32_32x32x16_bf16 v[112:127], v[172:175], v[68:71], v[112:127]
    v_mfma_f32_16x16x32_bf16 v[220:223], v[172:175], v[216:219], v[220:223]
    ds_read_b64_tr_b16 v[160:161], v200 offset:8192
    ds_read_b64_tr_b16 v[162:163], v200 offset:9216
    s_bfe_u32 s76, s3, 0x4000c
    s_and_b32 s29, s76, 8
    s_add_u32 s76, s76, s29
    s_lshl_b32 s76, s76, 10
    s_waitcnt lgkmcnt(4)
    v_mfma_f32_32x32x16_bf16 v[128:143], v[176:179], v[68:71], v[128:143]
    ds_read_b64_tr_b16 v[164:165], v201 offset:8192
    ds_read_b64_tr_b16 v[166:167], v201 offset:9216
    s_mul_i32 s76, s76, 14
    s_add_u32 s76, s76, s48
    s_add_u32 s78, s76, 7168
    buffer_load_dwordx4 v[56:59], v204, s[16:19], s76 offen
    s_waitcnt lgkmcnt(4)
    v_mfma_f32_32x32x16_bf16 v[144:159], v[180:183], v[68:71], v[144:159]
    ds_read_b64_tr_b16 v[168:169], v202 offset:8192
    ds_read_b64_tr_b16 v[170:171], v202 offset:9216
    s_mov_b32 s8, s44
    s_mov_b32 s9, s45
    s_mov_b32 s10, 401408
    s_mov_b32 s11, 0x20000
    s_waitcnt lgkmcnt(4)
    v_mfma_f32_32x32x16_bf16 v[112:127], v[160:163], v[72:75], v[112:127]
    v_mfma_f32_16x16x32_bf16 v[220:223], v[160:163], v[216:219], v[220:223]
    ds_read_b64_tr_b16 v[172:173], v200 offset:12288
    ds_read_b64_tr_b16 v[174:175], v200 offset:13312
    buffer_load_dwordx4 v[60:63], v204, s[16:19], s78 offen
    s_waitcnt lgkmcnt(4)
    v_mfma_f32_32x32x16_bf16 v[128:143], v[164:167], v[72:75], v[128:143]
    ds_read_b64_tr_b16 v[176:177], v201 offset:12288
    ds_read_b64_tr_b16 v[178:179], v201 offset:13312
    s_waitcnt lgkmcnt(4)
    v_mfma_f32_32x32x16_bf16 v[144:159], v[168:171], v[72:75], v[144:159]
    ds_read_b64_tr_b16 v[180:181], v202 offset:12288
    ds_read_b64_tr_b16 v[182:183], v202 offset:13312
    s_waitcnt vmcnt(8)
    s_barrier
    v_add_u32 v200, 131072, v192
    v_add_u32 v201, 131072, v193
    v_add_u32 v202, 131072, v194
    s_waitcnt lgkmcnt(4)
    v_mfma_f32_32x32x16_bf16 v[112:127], v[172:175], v[76:79], v[112:127]
    v_mfma_f32_16x16x32_bf16 v[220:223], v[172:175], v[216:219], v[220:223]
    ds_read_b64_tr_b16 v[160:161], v200 offset:0
    ds_read_b64_tr_b16 v[162:163], v200 offset:1024
    s_bfe_u32 s76, s3, 0x40010
    s_and_b32 s29, s76, 8
    s_add_u32 s76, s76, s29
    s_waitcnt lgkmcnt(4)
    v_mfma_f32_32x32x16_bf16 v[128:143], v[176:179], v[76:79], v[128:143]
    ds_read_b64_tr_b16 v[164:165], v201 offset:0
    ds_read_b64_tr_b16 v[166:167], v201 offset:1024
    s_lshl_b32 s76, s76, 10
    s_mul_i32 s76, s76, 14
    s_add_u32 s76, s76, s48
    s_waitcnt lgkmcnt(4)
    v_mfma_f32_32x32x16_bf16 v[144:159], v[180:183], v[76:79], v[144:159]
    ds_read_b64_tr_b16 v[168:169], v202 offset:0
    ds_read_b64_tr_b16 v[170:171], v202 offset:1024
    s_add_u32 s78, s76, 7168
    buffer_load_dwordx4 v[64:67], v204, s[16:19], s76 offen
    s_waitcnt lgkmcnt(4)
    v_mfma_f32_32x32x16_bf16 v[112:127], v[160:163], v[80:83], v[112:127]
    v_mfma_f32_16x16x32_bf16 v[220:223], v[160:163], v[216:219], v[220:223]
    ds_read_b64_tr_b16 v[172:173], v200 offset:4096
    ds_read_b64_tr_b16 v[174:175], v200 offset:5120
    buffer_load_dwordx4 v[68:71], v204, s[16:19], s78 offen
    s_waitcnt lgkmcnt(4)
    v_mfma_f32_32x32x16_bf16 v[128:143], v[164:167], v[80:83], v[128:143]
    ds_read_b64_tr_b16 v[176:177], v201 offset:4096
    ds_read_b64_tr_b16 v[178:179], v201 offset:5120
    s_waitcnt lgkmcnt(4)
    v_mfma_f32_32x32x16_bf16 v[144:159], v[168:171], v[80:83], v[144:159]
    ds_read_b64_tr_b16 v[180:181], v202 offset:4096
    ds_read_b64_tr_b16 v[182:183], v202 offset:5120
    s_waitcnt lgkmcnt(4)
    v_mfma_f32_32x32x16_bf16 v[112:127], v[172:175], v[84:87], v[112:127]
    v_mfma_f32_16x16x32_bf16 v[220:223], v[172:175], v[216:219], v[220:223]
    ds_read_b64_tr_b16 v[160:161], v200 offset:8192
    ds_read_b64_tr_b16 v[162:163], v200 offset:9216
    s_bfe_u32 s76, s3, 0x40014
    s_and_b32 s29, s76, 8
    s_add_u32 s76, s76, s29
    s_waitcnt lgkmcnt(4)
    v_mfma_f32_32x32x16_bf16 v[128:143], v[176:179], v[84:87], v[128:143]
    ds_read_b64_tr_b16 v[164:165], v201 offset:8192
    ds_read_b64_tr_b16 v[166:167], v201 offset:9216
    s_lshl_b32 s76, s76, 10
    s_mul_i32 s76, s76, 14
    s_add_u32 s76, s76, s48
    s_waitcnt lgkmcnt(4)
    v_mfma_f32_32x32x16_bf16 v[144:159], v[180:183], v[84:87], v[144:159]
    ds_read_b64_tr_b16 v[168:169], v202 offset:8192
    ds_read_b64_tr_b16 v[170:171], v202 offset:9216
    s_add_u32 s78, s76, 7168
    buffer_load_dwordx4 v[72:75], v204, s[16:19], s76 offen
    s_waitcnt lgkmcnt(4)
    v_mfma_f32_32x32x16_bf16 v[112:127], v[160:163], v[88:91], v[112:127]
    v_mfma_f32_16x16x32_bf16 v[220:223], v[160:163], v[216:219], v[220:223]
    ds_read_b64_tr_b16 v[172:173], v200 offset:12288
    ds_read_b64_tr_b16 v[174:175], v200 offset:13312
    buffer_load_dwordx4 v[76:79], v204, s[16:19], s78 offen
    s_waitcnt lgkmcnt(4)
    v_mfma_f32_32x32x16_bf16 v[128:143], v[164:167], v[88:91], v[128:143]
    ds_read_b64_tr_b16 v[176:177], v201 offset:12288
    ds_read_b64_tr_b16 v[178:179], v201 offset:13312
    s_waitcnt lgkmcnt(4)
    v_mfma_f32_32x32x16_bf16 v[144:159], v[168:171], v[88:91], v[144:159]
    ds_read_b64_tr_b16 v[180:181], v202 offset:12288
    ds_read_b64_tr_b16 v[182:183], v202 offset:13312
    v_add_u32 v200, 0, v192
    v_add_u32 v201, 0, v193
    v_add_u32 v202, 0, v194
    s_waitcnt lgkmcnt(4)
    v_mfma_f32_32x32x16_bf16 v[112:127], v[172:175], v[92:95], v[112:127]
    v_mfma_f32_16x16x32_bf16 v[220:223], v[172:175], v[216:219], v[220:223]
    ds_read_b64_tr_b16 v[160:161], v200 offset:0
    ds_read_b64_tr_b16 v[162:163], v200 offset:1024
    s_bfe_u32 s76, s3, 0x40018
    s_and_b32 s29, s76, 8
    s_add_u32 s76, s76, s29
    s_waitcnt lgkmcnt(4)
    v_mfma_f32_32x32x16_bf16 v[128:143], v[176:179], v[92:95], v[128:143]
    ds_read_b64_tr_b16 v[164:165], v201 offset:0
    ds_read_b64_tr_b16 v[166:167], v201 offset:1024
    s_lshl_b32 s76, s76, 10
    s_mul_i32 s76, s76, 14
    s_add_u32 s76, s76, s48
    s_waitcnt lgkmcnt(4)
    v_mfma_f32_32x32x16_bf16 v[144:159], v[180:183], v[92:95], v[144:159]
    ds_read_b64_tr_b16 v[168:169], v202 offset:0
    ds_read_b64_tr_b16 v[170:171], v202 offset:1024
    s_add_u32 s78, s76, 7168
    buffer_load_dwordx4 v[80:83], v204, s[16:19], s76 offen
    s_waitcnt lgkmcnt(4)
    v_mfma_f32_32x32x16_bf16 v[112:127], v[160:163], v[96:99], v[112:127]
    v_mfma_f32_16x16x32_bf16 v[220:223], v[160:163], v[216:219], v[220:223]
    ds_read_b64_tr_b16 v[172:173], v200 offset:4096
    ds_read_b64_tr_b16 v[174:175], v200 offset:5120
    buffer_load_dwordx4 v[84:87], v204, s[16:19], s78 offen
    s_waitcnt lgkmcnt(4)
    v_mfma_f32_32x32x16_bf16 v[128:143], v[164:167], v[96:99], v[128:143]
    ds_read_b64_tr_b16 v[176:177], v201 offset:4096
    ds_read_b64_tr_b16 v[178:179], v201 offset:5120
    s_waitcnt lgkmcnt(4)
    v_mfma_f32_32x32x16_bf16 v[144:159], v[168:171], v[96:99], v[144:159]
    ds_read_b64_tr_b16 v[180:181], v202 offset:4096
    ds_read_b64_tr_b16 v[182:183], v202 offset:5120
    s_waitcnt lgkmcnt(4)
    v_mfma_f32_32x32x16_bf16 v[112:127], v[172:175], v[100:103], v[112:127]
    v_mfma_f32_16x16x32_bf16 v[220:223], v[172:175], v[216:219], v[220:223]
    ds_read_b64_tr_b16 v[160:161], v200 offset:8192
    ds_read_b64_tr_b16 v[162:163], v200 offset:9216
    s_bfe_u32 s76, s3, 0x4001c
    s_and_b32 s29, s76, 8
    s_add_u32 s76, s76, s29
    s_waitcnt lgkmcnt(4)
    v_mfma_f32_32x32x16_bf16 v[128:143], v[176:179], v[100:103], v[128:143]
    ds_read_b64_tr_b16 v[164:165], v201 offset:8192
    ds_read_b64_tr_b16 v[166:167], v201 offset:9216
    s_lshl_b32 s76, s76, 10
    s_mul_i32 s76, s76, 14
    s_add_u32 s76, s76, s48
    s_waitcnt lgkmcnt(4)
    v_mfma_f32_32x32x16_bf16 v[144:159], v[180:183], v[100:103], v[144:159]
    ds_read_b64_tr_b16 v[168:169], v202 offset:8192
    ds_read_b64_tr_b16 v[170:171], v202 offset:9216
    s_add_u32 s78, s76, 7168
    buffer_load_dwordx4 v[88:91], v204, s[16:19], s76 offen
    s_waitcnt lgkmcnt(4)
    v_mfma_f32_32x32x16_bf16 v[112:127], v[160:163], v[104:107], v[112:127]
    v_mfma_f32_16x16x32_bf16 v[220:223], v[160:163], v[216:219], v[220:223]
    ds_read_b64_tr_b16 v[172:173], v200 offset:12288
    ds_read_b64_tr_b16 v[174:175], v200 offset:13312
    buffer_load_dwordx4 v[92:95], v204, s[16:19], s78 offen
    s_waitcnt lgkmcnt(4)
    v_mfma_f32_32x32x16_bf16 v[128:143], v[164:167], v[104:107], v[128:143]
    ds_read_b64_tr_b16 v[176:177], v201 offset:12288
    ds_read_b64_tr_b16 v[178:179], v201 offset:13312
    s_waitcnt lgkmcnt(4)
    v_mfma_f32_32x32x16_bf16 v[144:159], v[168:171], v[104:107], v[144:159]
    ds_read_b64_tr_b16 v[180:181], v202 offset:12288
    ds_read_b64_tr_b16 v[182:183], v202 offset:13312
    s_waitcnt vmcnt(16)
    s_barrier
    v_add_u32 v200, 16384, v192
    v_add_u32 v201, 16384, v193
    v_add_u32 v202, 16384, v194
    s_waitcnt lgkmcnt(4)
    v_mfma_f32_32x32x16_bf16 v[112:127], v[172:175], v[108:111], v[112:127]
    v_mfma_f32_16x16x32_bf16 v[220:223], v[172:175], v[216:219], v[220:223]
    ds_read_b64_tr_b16 v[160:161], v200 offset:0
    ds_read_b64_tr_b16 v[162:163], v200 offset:1024
    s_bfe_u32 s76, s1, 0x40000
    s_and_b32 s29, s76, 8
    s_add_u32 s76, s76, s29
    s_lshl_b32 s76, s76, 10
    s_mul_i32 s76, s76, 14
    s_waitcnt lgkmcnt(4)
    v_mfma_f32_32x32x16_bf16 v[128:143], v[176:179], v[108:111], v[128:143]
    ds_read_b64_tr_b16 v[164:165], v201 offset:0
    ds_read_b64_tr_b16 v[166:167], v201 offset:1024
    s_add_u32 s76, s76, s48
    s_add_u32 s78, s76, 7168
    buffer_load_dwordx4 v[96:99], v204, s[16:19], s76 offen
    s_add_u32 m0, s46, 0
    s_add_u32 s26, s43, 0
    s_waitcnt lgkmcnt(4)
    v_mfma_f32_32x32x16_bf16 v[144:159], v[180:183], v[108:111], v[144:159]
    ds_read_b64_tr_b16 v[168:169], v202 offset:0
    ds_read_b64_tr_b16 v[170:171], v202 offset:1024
    buffer_load_dwordx4 v204, s[8:11], s26 offen lds
    s_add_u32 s26, s26, 6144
    buffer_load_dwordx4 v204, s[8:11], s26 offen offset:1024 lds
    s_waitcnt lgkmcnt(4)
    v_mfma_f32_32x32x16_bf16 v[112:127], v[160:163], v[0:3], v[112:127]
    v_mfma_f32_16x16x32_bf16 v[220:223], v[160:163], v[216:219], v[220:223]
    ds_read_b64_tr_b16 v[172:173], v200 offset:4096
    ds_read_b64_tr_b16 v[174:175], v200 offset:5120
    buffer_load_dwordx4 v[100:103], v204, s[16:19], s78 offen
    s_add_u32 m0, s46, 2048
    s_waitcnt lgkmcnt(4)
    v_mfma_f32_32x32x16_bf16 v[128:143], v[164:167], v[0:3], v[128:143]
    ds_read_b64_tr_b16 v[176:177], v201 offset:4096
    ds_read_b64_tr_b16 v[178:179], v201 offset:5120
    s_add_u32 s26, s43, 14336
    buffer_load_dwordx4 v204, s[8:11], s26 offen lds
    s_waitcnt lgkmcnt(4)
    v_mfma_f32_32x32x16_bf16 v[144:159], v[168:171], v[0:3], v[144:159]
    ds_read_b64_tr_b16 v[180:181], v202 offset:4096
    ds_read_b64_tr_b16 v[182:183], v202 offset:5120
    s_add_u32 s26, s26, 6144
    buffer_load_dwordx4 v204, s[8:11], s26 offen offset:1024 lds
    s_waitcnt lgkmcnt(4)
    v_mfma_f32_32x32x16_bf16 v[112:127], v[172:175], v[4:7], v[112:127]
    v_mfma_f32_16x16x32_bf16 v[220:223], v[172:175], v[216:219], v[220:223]
    ds_read_b64_tr_b16 v[160:161], v200 offset:8192
    ds_read_b64_tr_b16 v[162:163], v200 offset:9216
    s_bfe_u32 s76, s1, 0x40004
    s_and_b32 s29, s76, 8
    s_add_u32 s76, s76, s29
    s_lshl_b32 s76, s76, 10
    s_mul_i32 s76, s76, 14
    s_waitcnt lgkmcnt(4)
    v_mfma_f32_32x32x16_bf16 v[128:143], v[176:179], v[4:7], v[128:143]
    ds_read_b64_tr_b16 v[164:165], v201 offset:8192
    ds_read_b64_tr_b16 v[166:167], v201 offset:9216
    s_add_u32 s76, s76, s48
    s_add_u32 s78, s76, 7168
    buffer_load_dwordx4 v[104:107], v204, s[16:19], s76 offen
    s_add_u32 m0, s46, 4096
    s_add_u32 s26, s43, 25088
    s_waitcnt lgkmcnt(4)
    v_mfma_f32_32x32x16_bf16 v[144:159], v[180:183], v[4:7], v[144:159]
    ds_read_b64_tr_b16 v[168:169], v202 offset:8192
    ds_read_b64_tr_b16 v[170:171], v202 offset:9216
    buffer_load_dwordx4 v204, s[8:11], s26 offen lds
    s_add_u32 s26, s26, 6144
    buffer_load_dwordx4 v204, s[8:11], s26 offen offset:1024 lds
    s_waitcnt lgkmcnt(4)
    v_mfma_f32_32x32x16_bf16 v[112:127], v[160:163], v[8:11], v[112:127]
    v_mfma_f32_16x16x32_bf16 v[220:223], v[160:163], v[216:219], v[220:223]
    ds_read_b64_tr_b16 v[172:173], v200 offset:12288
    ds_read_b64_tr_b16 v[174:175], v200 offset:13312
    buffer_load_dwordx4 v[108:111], v204, s[16:19], s78 offen
    s_add_u32 m0, s46, 6144
    s_waitcnt lgkmcnt(4)
    v_mfma_f32_32x32x16_bf16 v[128:143], v[164:167], v[8:11], v[128:143]
    ds_read_b64_tr_b16 v[176:177], v201 offset:12288
    ds_read_b64_tr_b16 v[178:179], v201 offset:13312
    s_add_u32 s26, s43, 39424
    buffer_load_dwordx4 v204, s[8:11], s26 offen lds
    s_waitcnt lgkmcnt(4)
    v_mfma_f32_32x32x16_bf16 v[144:159], v[168:171], v[8:11], v[144:159]
    ds_read_b64_tr_b16 v[180:181], v202 offset:12288
    ds_read_b64_tr_b16 v[182:183], v202 offset:13312
    s_add_u32 s26, s26, 6144
    buffer_load_dwordx4 v204, s[8:11], s26 offen offset:1024 lds
    v_add_u32 v200, 32768, v192
    v_add_u32 v201, 32768, v193
    v_add_u32 v202, 32768, v194
    s_waitcnt lgkmcnt(4)
    v_mfma_f32_32x32x16_bf16 v[112:127], v[172:175], v[12:15], v[112:127]
    v_mfma_f32_16x16x32_bf16 v[220:223], v[172:175], v[216:219], v[220:223]
    ds_read_b64_tr_b16 v[160:161], v200 offset:0
    ds_read_b64_tr_b16 v[162:163], v200 offset:1024
    s_add_u32 m0, s46, 8192
    s_add_u32 s26, s43, 50176
    s_waitcnt lgkmcnt(4)
    v_mfma_f32_32x32x16_bf16 v[128:143], v[176:179], v[12:15], v[128:143]
    ds_read_b64_tr_b16 v[164:165], v201 offset:0
    ds_read_b64_tr_b16 v[166:167], v201 offset:1024
    buffer_load_dwordx4 v204, s[8:11], s26 offen lds
    s_add_u32 s26, s26, 6144
    s_waitcnt lgkmcnt(4)
    v_mfma_f32_32x32x16_bf16 v[144:159], v[180:183], v[12:15], v[144:159]
    ds_read_b64_tr_b16 v[168:169], v202 offset:0
    ds_read_b64_tr_b16 v[170:171], v202 offset:1024
    buffer_load_dwordx4 v204, s[8:11], s26 offen offset:1024 lds
    s_waitcnt lgkmcnt(4)
    v_mfma_f32_32x32x16_bf16 v[112:127], v[160:163], v[16:19], v[112:127]
    v_mfma_f32_16x16x32_bf16 v[220:223], v[160:163], v[216:219], v[220:223]
    ds_read_b64_tr_b16 v[172:173], v200 offset:4096
    ds_read_b64_tr_b16 v[174:175], v200 offset:5120
    s_add_u32 m0, s46, 10240
    s_add_u32 s26, s43, 64512
    s_waitcnt lgkmcnt(4)
    v_mfma_f32_32x32x16_bf16 v[128:143], v[164:167], v[16:19], v[128:143]
    ds_read_b64_tr_b16 v[176:177], v201 offset:4096
    ds_read_b64_tr_b16 v[178:179], v201 offset:5120
    buffer_load_dwordx4 v204, s[8:11], s26 offen lds
    s_add_u32 s26, s26, 6144
    s_waitcnt lgkmcnt(4)
    v_mfma_f32_32x32x16_bf16 v[144:159], v[168:171], v[16:19], v[144:159]
    ds_read_b64_tr_b16 v[180:181], v202 offset:4096
    ds_read_b64_tr_b16 v[182:183], v202 offset:5120
    buffer_load_dwordx4 v204, s[8:11], s26 offen offset:1024 lds
    s_waitcnt lgkmcnt(4)
    v_mfma_f32_32x32x16_bf16 v[112:127], v[172:175], v[20:23], v[112:127]
    v_mfma_f32_16x16x32_bf16 v[220:223], v[172:175], v[216:219], v[220:223]
    ds_read_b64_tr_b16 v[160:161], v200 offset:8192
    ds_read_b64_tr_b16 v[162:163], v200 offset:9216
    s_add_u32 m0, s46, 12288
    s_add_u32 s26, s43, 75264
    s_waitcnt lgkmcnt(4)
    v_mfma_f32_32x32x16_bf16 v[128:143], v[176:179], v[20:23], v[128:143]
    ds_read_b64_tr_b16 v[164:165], v201 offset:8192
    ds_read_b64_tr_b16 v[166:167], v201 offset:9216
    buffer_load_dwordx4 v204, s[8:11], s26 offen lds
    s_add_u32 s26, s26, 6144
    s_waitcnt lgkmcnt(4)
    v_mfma_f32_32x32x16_bf16 v[144:159], v[180:183], v[20:23], v[144:159]
    ds_read_b64_tr_b16 v[168:169], v202 offset:8192
    ds_read_b64_tr_b16 v[170:171], v202 offset:9216
    buffer_load_dwordx4 v204, s[8:11], s26 offen offset:1024 lds
    s_waitcnt lgkmcnt(4)
    v_mfma_f32_32x32x16_bf16 v[112:127], v[160:163], v[24:27], v[112:127]
    v_mfma_f32_16x16x32_bf16 v[220:223], v[160:163], v[216:219], v[220:223]
    ds_read_b64_tr_b16 v[172:173], v200 offset:12288
    ds_read_b64_tr_b16 v[174:175], v200 offset:13312
    s_add_u32 m0, s46, 14336
    s_add_u32 s26, s43, 89600
    s_waitcnt lgkmcnt(4)
    v_mfma_f32_32x32x16_bf16 v[128:143], v[164:167], v[24:27], v[128:143]
    ds_read_b64_tr_b16 v[176:177], v201 offset:12288
    ds_read_b64_tr_b16 v[178:179], v201 offset:13312
    buffer_load_dwordx4 v204, s[8:11], s26 offen lds
    s_add_u32 s26, s26, 6144
    s_waitcnt lgkmcnt(4)
    v_mfma_f32_32x32x16_bf16 v[144:159], v[168:171], v[24:27], v[144:159]
    ds_read_b64_tr_b16 v[180:181], v202 offset:12288
    ds_read_b64_tr_b16 v[182:183], v202 offset:13312
    buffer_load_dwordx4 v204, s[8:11], s26 offen offset:1024 lds
    s_waitcnt lgkmcnt(4)
    v_mfma_f32_32x32x16_bf16 v[112:127], v[172:175], v[28:31], v[112:127]
    v_mfma_f32_16x16x32_bf16 v[220:223], v[172:175], v[216:219], v[220:223]
    s_waitcnt lgkmcnt(2)
    v_mfma_f32_32x32x16_bf16 v[128:143], v[176:179], v[28:31], v[128:143]
    s_waitcnt lgkmcnt(0)
    v_mfma_f32_32x32x16_bf16 v[144:159], v[180:183], v[28:31], v[144:159]
    s_lshl_b32 s26, s23, 10
    s_add_u32 s26, s26, 156672
    v_add_u32 v225, s26, v240
    s_lshl_b32 s26, s23, 7
    s_add_u32 s26, s26, 160768
    v_lshl_add_u32 v226, v243, 2, s26
    ds_read_b128 v[248:251], v225
    ds_read_b32 v242, v226
    s_cmp_eq_u32 s23, 3
    s_cselect_b32 s28, 0, s23
    s_add_u32 s28, s28, 0
    s_cmp_ge_u32 s28, 3
    s_cselect_b32 s29, 3, 0
    s_sub_u32 s28, s28, s29
    s_add_u32 s28, s28, 4
    s_lshl_b32 s28, s28, 7
    s_add_u32 s28, s28, 155648
    v_and_b32 v230, 15, v241
    v_lshrrev_b32 v231, 4, v241
    v_lshlrev_b32 v230, 6, v230
    v_lshl_add_u32 v230, v231, 4, v230
    v_add_u32 v227, s28, v230
    s_mov_b32 exec_lo, 0x00030003
    s_mov_b32 exec_hi, 0x00030003
    ds_write_b128 v227, v[220:223] offset:0
    s_mov_b64 exec, -1
    s_cmp_eq_u32 s23, 3
    s_cselect_b32 s28, 0, s23
    s_add_u32 s28, s28, 0
    s_cmp_ge_u32 s28, 3
    s_cselect_b32 s29, 3, 0
    s_sub_u32 s28, s28, s29
    s_add_u32 s28, s28, 4
    s_lshl_b32 s26, s28, 7
    s_add_u32 s26, s26, 155648
    v_lshl_add_u32 v225, v243, 2, s26
    s_cmp_eq_u32 s23, 3
    s_cselect_b32 s28, 0, s23
    s_add_u32 s28, s28, 1
    s_cmp_ge_u32 s28, 3
    s_cselect_b32 s29, 3, 0
    s_sub_u32 s28, s28, s29
    s_add_u32 s28, s28, 4
    s_lshl_b32 s26, s28, 7
    s_add_u32 s26, s26, 155648
    v_lshl_add_u32 v226, v243, 2, s26
    s_cmp_eq_u32 s23, 3
    s_cselect_b32 s28, 0, s23
    s_add_u32 s28, s28, 2
    s_cmp_ge_u32 s28, 3
    s_cselect_b32 s29, 3, 0
    s_sub_u32 s28, s28, s29
    s_add_u32 s28, s28, 4
    s_lshl_b32 s26, s28, 7
    s_add_u32 s26, s26, 155648
    v_lshl_add_u32 v227, v243, 2, s26
    v_lshlrev_b32 v198, 16, v198
    v_lshlrev_b32 v199, 16, v199
    v_lshlrev_b32 v196, 16, v196
    s_mul_i32 s26, s23, 20480
    v_add_u32 v224, s26, v240
    s_waitcnt lgkmcnt(0)
    s_barrier
    s_cmp_ge_u32 s0, 224
    s_cbranch_scc1 K1_B_NOFh
    s_waitcnt vmcnt(10)
    ds_write_b128 v224, v[32:35] offset:0
    ds_write_b128 v224, v[36:39] offset:1024
    ds_write_b128 v224, v[40:43] offset:2048
    ds_write_b128 v224, v[44:47] offset:3072
    ds_write_b128 v224, v[48:51] offset:4096
    ds_write_b128 v224, v[52:55] offset:5120
    ds_write_b128 v224, v[56:59] offset:6144
    ds_write_b128 v224, v[60:63] offset:7168
    ds_write_b128 v224, v[64:67] offset:8192
    ds_write_b128 v224, v[68:71] offset:9216
    ds_write_b128 v224, v[72:75] offset:10240
    ds_write_b128 v224, v[76:79] offset:11264
    ds_write_b128 v224, v[80:83] offset:12288
    ds_write_b128 v224, v[84:87] offset:13312
    ds_write_b128 v224, v[88:91] offset:14336
    ds_write_b128 v224, v[92:95] offset:15360
    ds_write_b128 v224, v[96:99] offset:16384
    ds_write_b128 v224, v[100:103] offset:17408
    ds_write_b128 v224, v[104:107] offset:18432
    ds_write_b128 v224, v[108:111] offset:19456
    s_waitcnt lgkmcnt(0)
    s_barrier
K1_B_NOFh:
    ds_read_b32 v208, v225
    ds_read_b32 v209, v226
    ds_read_b32 v195, v227
    v_mul_f32 v244, 0x3fb8aa3b, v242
    s_waitcnt lgkmcnt(0)
    v_cvt_pk_bf16_f32 v231, v208, v208
    v_and_b32 v231, 0xffff0000, v231
    v_sub_f32 v231, v208, v231
    v_cvt_pk_bf16_f32 v252, v208, v231
    v_cvt_pk_bf16_f32 v253, v208, v198
    v_cvt_pk_bf16_f32 v254, v198, 0
    v_mov_b32 v255, 0
    s_nop 1
    v_mfma_f32_32x32x16_bf16 v[112:127], v[252:255], v[248:251], v[112:127]
    v_cvt_pk_bf16_f32 v231, v209, v209
    v_and_b32 v231, 0xffff0000, v231
    v_sub_f32 v231, v209, v231
    v_cvt_pk_bf16_f32 v252, v209, v231
    v_cvt_pk_bf16_f32 v253, v209, v199
    v_cvt_pk_bf16_f32 v254, v199, 0
    v_mov_b32 v255, 0
    s_nop 1
    v_mfma_f32_32x32x16_bf16 v[128:143], v[252:255], v[248:251], v[128:143]
    v_cvt_pk_bf16_f32 v231, v195, v195
    v_and_b32 v231, 0xffff0000, v231
    v_sub_f32 v231, v195, v231
    v_cvt_pk_bf16_f32 v252, v195, v231
    v_cvt_pk_bf16_f32 v253, v195, v196
    v_cvt_pk_bf16_f32 v254, v196, 0
    v_mov_b32 v255, 0
    s_nop 1
    v_mfma_f32_32x32x16_bf16 v[144:159], v[252:255], v[248:251], v[144:159]
    s_mul_i32 s26, s87, 56
    s_add_u32 s26, s26, s84
    s_lshl_b32 s39, s26, 11
    v_pk_mul_f32 v[112:113], v[112:113], v[244:245] op_sel_hi:[1,0]
    v_pk_mul_f32 v[114:115], v[114:115], v[244:245] op_sel_hi:[1,0]
    v_pk_mul_f32 v[116:117], v[116:117], v[244:245] op_sel_hi:[1,0]
    v_pk_mul_f32 v[118:119], v[118:119], v[244:245] op_sel_hi:[1,0]
    v_pk_mul_f32 v[120:121], v[120:121], v[244:245] op_sel_hi:[1,0]
    v_pk_mul_f32 v[122:123], v[122:123], v[244:245] op_sel_hi:[1,0]
    v_pk_mul_f32 v[124:125], v[124:125], v[244:245] op_sel_hi:[1,0]
    v_pk_mul_f32 v[126:127], v[126:127], v[244:245] op_sel_hi:[1,0]
    v_exp_f32 v16, v112
    v_exp_f32 v17, v113
    v_exp_f32 v18, v114
    v_exp_f32 v19, v115
    v_exp_f32 v20, v116
    v_exp_f32 v21, v117
    v_exp_f32 v22, v118
    v_exp_f32 v23, v119
    v_exp_f32 v24, v120
    v_exp_f32 v25, v121
    v_exp_f32 v26, v122
    v_exp_f32 v27, v123
    v_exp_f32 v28, v124
    v_exp_f32 v29, v125
    v_exp_f32 v30, v126
    v_exp_f32 v31, v127
    v_pk_fma_f32 v[16:17], v[16:17], s[36:37], s[36:37] op_sel_hi:[1,0,0]
    v_pk_fma_f32 v[18:19], v[18:19], s[36:37], s[36:37] op_sel_hi:[1,0,0]
    v_pk_fma_f32 v[20:21], v[20:21], s[36:37], s[36:37] op_sel_hi:[1,0,0]
    v_pk_fma_f32 v[22:23], v[22:23], s[36:37], s[36:37] op_sel_hi:[1,0,0]
    v_pk_fma_f32 v[24:25], v[24:25], s[36:37], s[36:37] op_sel_hi:[1,0,0]
    v_pk_fma_f32 v[26:27], v[26:27], s[36:37], s[36:37] op_sel_hi:[1,0,0]
    v_pk_fma_f32 v[28:29], v[28:29], s[36:37], s[36:37] op_sel_hi:[1,0,0]
    v_pk_fma_f32 v[30:31], v[30:31], s[36:37], s[36:37] op_sel_hi:[1,0,0]
    v_pk_fma_f32 v[16:17], v[16:17], v[16:17], 0.5 op_sel_hi:[1,1,0]
    v_pk_fma_f32 v[18:19], v[18:19], v[18:19], 0.5 op_sel_hi:[1,1,0]
    v_pk_fma_f32 v[20:21], v[20:21], v[20:21], 0.5 op_sel_hi:[1,1,0]
    v_pk_fma_f32 v[22:23], v[22:23], v[22:23], 0.5 op_sel_hi:[1,1,0]
    v_pk_fma_f32 v[24:25], v[24:25], v[24:25], 0.5 op_sel_hi:[1,1,0]
    v_pk_fma_f32 v[26:27], v[26:27], v[26:27], 0.5 op_sel_hi:[1,1,0]
    v_pk_fma_f32 v[28:29], v[28:29], v[28:29], 0.5 op_sel_hi:[1,1,0]
    v_pk_fma_f32 v[30:31], v[30:31], v[30:31], 0.5 op_sel_hi:[1,1,0]
    v_rcp_f32 v16, v16
    v_rcp_f32 v17, v17
    v_rcp_f32 v18, v18
    v_rcp_f32 v19, v19
    v_rcp_f32 v20, v20
    v_rcp_f32 v21, v21
    v_rcp_f32 v22, v22
    v_rcp_f32 v23, v23
    v_rcp_f32 v24, v24
    v_rcp_f32 v25, v25
    v_rcp_f32 v26, v26
    v_rcp_f32 v27, v27
    v_rcp_f32 v28, v28
    v_rcp_f32 v29, v29
    v_rcp_f32 v30, v30
    v_rcp_f32 v31, v31
    v_pk_fma_f32 v[16:17], v[112:113], v[16:17], v[112:113] neg_lo:[1,0,0] neg_hi:[1,0,0]
    v_pk_fma_f32 v[18:19], v[114:115], v[18:19], v[114:115] neg_lo:[1,0,0] neg_hi:[1,0,0]
    v_pk_fma_f32 v[20:21], v[116:117], v[20:21], v[116:117] neg_lo:[1,0,0] neg_hi:[1,0,0]
    v_pk_fma_f32 v[22:23], v[118:119], v[22:23], v[118:119] neg_lo:[1,0,0] neg_hi:[1,0,0]
    v_pk_fma_f32 v[24:25], v[120:121], v[24:25], v[120:121] neg_lo:[1,0,0] neg_hi:[1,0,0]
    v_pk_fma_f32 v[26:27], v[122:123], v[26:27], v[122:123] neg_lo:[1,0,0] neg_hi:[1,0,0]
    v_pk_fma_f32 v[28:29], v[124:125], v[28:29], v[124:125] neg_lo:[1,0,0] neg_hi:[1,0,0]
    v_pk_fma_f32 v[30:31], v[126:127], v[30:31], v[126:127] neg_lo:[1,0,0] neg_hi:[1,0,0]
    v_cvt_pk_bf16_f32 v232, v16, v17
    v_cvt_pk_bf16_f32 v233, v18, v19
    v_cvt_pk_bf16_f32 v234, v20, v21
    v_cvt_pk_bf16_f32 v235, v22, v23
    v_cvt_pk_bf16_f32 v236, v24, v25
    v_cvt_pk_bf16_f32 v237, v26, v27
    v_cvt_pk_bf16_f32 v238, v28, v29
    v_cvt_pk_bf16_f32 v239, v30, v31
    s_setprio 3
    buffer_store_dwordx4 v[232:235], v240, s[12:15], s39 offen sc1
    buffer_store_dwordx4 v[236:239], v240, s[12:15], s39 offen offset:1024 sc1
    s_setprio 0
    s_lshl_b32 s26, s23, 2
    s_add_u32 s26, s26, 161312
    v_mov_b32 v222, s26
    s_mov_b32 s76, 0
    s_load_dwordx16 s[60:75], s[58:59], s49 offset:0 glc
    s_mul_i32 s26, s87, 56
    s_add_u32 s26, s26, s85
    s_lshl_b32 s39, s26, 11
    v_pk_mul_f32 v[128:129], v[128:129], v[244:245] op_sel_hi:[1,0]
    v_pk_mul_f32 v[130:131], v[130:131], v[244:245] op_sel_hi:[1,0]
    v_pk_mul_f32 v[132:133], v[132:133], v[244:245] op_sel_hi:[1,0]
    v_pk_mul_f32 v[134:135], v[134:135], v[244:245] op_sel_hi:[1,0]
    v_pk_mul_f32 v[136:137], v[136:137], v[244:245] op_sel_hi:[1,0]
    v_pk_mul_f32 v[138:139], v[138:139], v[244:245] op_sel_hi:[1,0]
    v_pk_mul_f32 v[140:141], v[140:141], v[244:245] op_sel_hi:[1,0]
    v_pk_mul_f32 v[142:143], v[142:143], v[244:245] op_sel_hi:[1,0]
    v_exp_f32 v16, v128
    v_exp_f32 v17, v129
    v_exp_f32 v18, v130
    v_exp_f32 v19, v131
    v_exp_f32 v20, v132
    v_exp_f32 v21, v133
    v_exp_f32 v22, v134
    v_exp_f32 v23, v135
    v_exp_f32 v24, v136
    v_exp_f32 v25, v137
    v_exp_f32 v26, v138
    v_exp_f32 v27, v139
    v_exp_f32 v28, v140
    v_exp_f32 v29, v141
    v_exp_f32 v30, v142
    v_exp_f32 v31, v143
    v_pk_fma_f32 v[16:17], v[16:17], s[36:37], s[36:37] op_sel_hi:[1,0,0]
    v_pk_fma_f32 v[18:19], v[18:19], s[36:37], s[36:37] op_sel_hi:[1,0,0]
    v_pk_fma_f32 v[20:21], v[20:21], s[36:37], s[36:37] op_sel_hi:[1,0,0]
    v_pk_fma_f32 v[22:23], v[22:23], s[36:37], s[36:37] op_sel_hi:[1,0,0]
    v_pk_fma_f32 v[24:25], v[24:25], s[36:37], s[36:37] op_sel_hi:[1,0,0]
    v_pk_fma_f32 v[26:27], v[26:27], s[36:37], s[36:37] op_sel_hi:[1,0,0]
    v_pk_fma_f32 v[28:29], v[28:29], s[36:37], s[36:37] op_sel_hi:[1,0,0]
    v_pk_fma_f32 v[30:31], v[30:31], s[36:37], s[36:37] op_sel_hi:[1,0,0]
    v_pk_fma_f32 v[16:17], v[16:17], v[16:17], 0.5 op_sel_hi:[1,1,0]
    v_pk_fma_f32 v[18:19], v[18:19], v[18:19], 0.5 op_sel_hi:[1,1,0]
    v_pk_fma_f32 v[20:21], v[20:21], v[20:21], 0.5 op_sel_hi:[1,1,0]
    v_pk_fma_f32 v[22:23], v[22:23], v[22:23], 0.5 op_sel_hi:[1,1,0]
    v_pk_fma_f32 v[24:25], v[24:25], v[24:25], 0.5 op_sel_hi:[1,1,0]
    v_pk_fma_f32 v[26:27], v[26:27], v[26:27], 0.5 op_sel_hi:[1,1,0]
    v_pk_fma_f32 v[28:29], v[28:29], v[28:29], 0.5 op_sel_hi:[1,1,0]
    v_pk_fma_f32 v[30:31], v[30:31], v[30:31], 0.5 op_sel_hi:[1,1,0]
    v_rcp_f32 v16, v16
    v_rcp_f32 v17, v17
    v_rcp_f32 v18, v18
    v_rcp_f32 v19, v19
    v_rcp_f32 v20, v20
    v_rcp_f32 v21, v21
    v_rcp_f32 v22, v22
    v_rcp_f32 v23, v23
    v_rcp_f32 v24, v24
    v_rcp_f32 v25, v25
    v_rcp_f32 v26, v26
    v_rcp_f32 v27, v27
    v_rcp_f32 v28, v28
    v_rcp_f32 v29, v29
    v_rcp_f32 v30, v30
    v_rcp_f32 v31, v31
    v_pk_fma_f32 v[16:17], v[128:129], v[16:17], v[128:129] neg_lo:[1,0,0] neg_hi:[1,0,0]
    v_pk_fma_f32 v[18:19], v[130:131], v[18:19], v[130:131] neg_lo:[1,0,0] neg_hi:[1,0,0]
    v_pk_fma_f32 v[20:21], v[132:133], v[20:21], v[132:133] neg_lo:[1,0,0] neg_hi:[1,0,0]
    v_pk_fma_f32 v[22:23], v[134:135], v[22:23], v[134:135] neg_lo:[1,0,0] neg_hi:[1,0,0]
    v_pk_fma_f32 v[24:25], v[136:137], v[24:25], v[136:137] neg_lo:[1,0,0] neg_hi:[1,0,0]
    v_pk_fma_f32 v[26:27], v[138:139], v[26:27], v[138:139] neg_lo:[1,0,0] neg_hi:[1,0,0]
    v_pk_fma_f32 v[28:29], v[140:141], v[28:29], v[140:141] neg_lo:[1,0,0] neg_hi:[1,0,0]
    v_pk_fma_f32 v[30:31], v[142:143], v[30:31], v[142:143] neg_lo:[1,0,0] neg_hi:[1,0,0]
    v_cvt_pk_bf16_f32 v232, v16, v17
    v_cvt_pk_bf16_f32 v233, v18, v19
    v_cvt_pk_bf16_f32 v234, v20, v21
    v_cvt_pk_bf16_f32 v235, v22, v23
    v_cvt_pk_bf16_f32 v236, v24, v25
    v_cvt_pk_bf16_f32 v237, v26, v27
    v_cvt_pk_bf16_f32 v238, v28, v29
    v_cvt_pk_bf16_f32 v239, v30, v31
    s_setprio 3
    buffer_store_dwordx4 v[232:235], v240, s[12:15], s39 offen sc1
    buffer_store_dwordx4 v[236:239], v240, s[12:15], s39 offen offset:1024 sc1
    s_setprio 0
    s_waitcnt lgkmcnt(0)
    s_mov_b32 s78, s76
    s_xor_b32 s68, s68, s79
    s_xor_b32 s69, s69, s79
    s_xor_b32 s70, s70, s79
    s_xor_b32 s71, s71, s79
    s_or_b64 s[68:69], s[68:69], s[70:71]
    s_or_b32 s68, s68, s69
    s_cselect_b32 s26, 0, 1
    s_or_b32 s78, s78, s26
    s_load_dwordx16 s[60:75], s[58:59], s49 offset:0 glc
    v_mov_b32 v223, s78
    ds_write_b32 v222, v223
    s_mov_b32 s76, s78
    s_mul_i32 s26, s87, 56
    s_add_u32 s26, s26, s86
    s_lshl_b32 s39, s26, 11
    v_pk_mul_f32 v[144:145], v[144:145], v[244:245] op_sel_hi:[1,0]
    v_pk_mul_f32 v[146:147], v[146:147], v[244:245] op_sel_hi:[1,0]
    v_pk_mul_f32 v[148:149], v[148:149], v[244:245] op_sel_hi:[1,0]
    v_pk_mul_f32 v[150:151], v[150:151], v[244:245] op_sel_hi:[1,0]
    v_pk_mul_f32 v[152:153], v[152:153], v[244:245] op_sel_hi:[1,0]
    v_pk_mul_f32 v[154:155], v[154:155], v[244:245] op_sel_hi:[1,0]
    v_pk_mul_f32 v[156:157], v[156:157], v[244:245] op_sel_hi:[1,0]
    v_pk_mul_f32 v[158:159], v[158:159], v[244:245] op_sel_hi:[1,0]
    v_exp_f32 v16, v144
    v_exp_f32 v17, v145
    v_exp_f32 v18, v146
    v_exp_f32 v19, v147
    v_exp_f32 v20, v148
    v_exp_f32 v21, v149
    v_exp_f32 v22, v150
    v_exp_f32 v23, v151
    v_exp_f32 v24, v152
    v_exp_f32 v25, v153
    v_exp_f32 v26, v154
    v_exp_f32 v27, v155
    v_exp_f32 v28, v156
    v_exp_f32 v29, v157
    v_exp_f32 v30, v158
    v_exp_f32 v31, v159
    v_pk_fma_f32 v[16:17], v[16:17], s[36:37], s[36:37] op_sel_hi:[1,0,0]
    v_pk_fma_f32 v[18:19], v[18:19], s[36:37], s[36:37] op_sel_hi:[1,0,0]
    v_pk_fma_f32 v[20:21], v[20:21], s[36:37], s[36:37] op_sel_hi:[1,0,0]
    v_pk_fma_f32 v[22:23], v[22:23], s[36:37], s[36:37] op_sel_hi:[1,0,0]
    v_pk_fma_f32 v[24:25], v[24:25], s[36:37], s[36:37] op_sel_hi:[1,0,0]
    v_pk_fma_f32 v[26:27], v[26:27], s[36:37], s[36:37] op_sel_hi:[1,0,0]
    v_pk_fma_f32 v[28:29], v[28:29], s[36:37], s[36:37] op_sel_hi:[1,0,0]
    v_pk_fma_f32 v[30:31], v[30:31], s[36:37], s[36:37] op_sel_hi:[1,0,0]
    v_pk_fma_f32 v[16:17], v[16:17], v[16:17], 0.5 op_sel_hi:[1,1,0]
    v_pk_fma_f32 v[18:19], v[18:19], v[18:19], 0.5 op_sel_hi:[1,1,0]
    v_pk_fma_f32 v[20:21], v[20:21], v[20:21], 0.5 op_sel_hi:[1,1,0]
    v_pk_fma_f32 v[22:23], v[22:23], v[22:23], 0.5 op_sel_hi:[1,1,0]
    v_pk_fma_f32 v[24:25], v[24:25], v[24:25], 0.5 op_sel_hi:[1,1,0]
    v_pk_fma_f32 v[26:27], v[26:27], v[26:27], 0.5 op_sel_hi:[1,1,0]
    v_pk_fma_f32 v[28:29], v[28:29], v[28:29], 0.5 op_sel_hi:[1,1,0]
    v_pk_fma_f32 v[30:31], v[30:31], v[30:31], 0.5 op_sel_hi:[1,1,0]
    v_rcp_f32 v16, v16
    v_rcp_f32 v17, v17
    v_rcp_f32 v18, v18
    v_rcp_f32 v19, v19
    v_rcp_f32 v20, v20
    v_rcp_f32 v21, v21
    v_rcp_f32 v22, v22
    v_rcp_f32 v23, v23
    v_rcp_f32 v24, v24
    v_rcp_f32 v25, v25
    v_rcp_f32 v26, v26
    v_rcp_f32 v27, v27
    v_rcp_f32 v28, v28
    v_rcp_f32 v29, v29
    v_rcp_f32 v30, v30
    v_rcp_f32 v31, v31
    v_pk_fma_f32 v[16:17], v[144:145], v[16:17], v[144:145] neg_lo:[1,0,0] neg_hi:[1,0,0]
    v_pk_fma_f32 v[18:19], v[146:147], v[18:19], v[146:147] neg_lo:[1,0,0] neg_hi:[1,0,0]
    v_pk_fma_f32 v[20:21], v[148:149], v[20:21], v[148:149] neg_lo:[1,0,0] neg_hi:[1,0,0]
    v_pk_fma_f32 v[22:23], v[150:151], v[22:23], v[150:151] neg_lo:[1,0,0] neg_hi:[1,0,0]
    v_pk_fma_f32 v[24:25], v[152:153], v[24:25], v[152:153] neg_lo:[1,0,0] neg_hi:[1,0,0]
    v_pk_fma_f32 v[26:27], v[154:155], v[26:27], v[154:155] neg_lo:[1,0,0] neg_hi:[1,0,0]
    v_pk_fma_f32 v[28:29], v[156:157], v[28:29], v[156:157] neg_lo:[1,0,0] neg_hi:[1,0,0]
    v_pk_fma_f32 v[30:31], v[158:159], v[30:31], v[158:159] neg_lo:[1,0,0] neg_hi:[1,0,0]
    v_cvt_pk_bf16_f32 v232, v16, v17
    v_cvt_pk_bf16_f32 v233, v18, v19
    v_cvt_pk_bf16_f32 v234, v20, v21
    v_cvt_pk_bf16_f32 v235, v22, v23
    v_cvt_pk_bf16_f32 v236, v24, v25
    v_cvt_pk_bf16_f32 v237, v26, v27
    v_cvt_pk_bf16_f32 v238, v28, v29
    v_cvt_pk_bf16_f32 v239, v30, v31
    s_setprio 3
    buffer_store_dwordx4 v[232:235], v240, s[12:15], s39 offen sc1
    buffer_store_dwordx4 v[236:239], v240, s[12:15], s39 offen offset:1024 sc1
    s_waitcnt lgkmcnt(0)
    s_mov_b32 s78, s76
    s_xor_b32 s68, s68, s79
    s_xor_b32 s69, s69, s79
    s_xor_b32 s70, s70, s79
    s_xor_b32 s71, s71, s79
    s_or_b64 s[68:69], s[68:69], s[70:71]
    s_or_b32 s68, s68, s69
    s_cselect_b32 s26, 0, 1
    s_or_b32 s78, s78, s26
    s_load_dwordx16 s[60:75], s[58:59], s49 offset:0 glc
    v_mov_b32 v223, s78
    ds_write_b32 v222, v223
    s_mov_b32 s76, s78
    s_cmp_ge_u32 s0, 224
    s_cbranch_scc0 P2_ATTh
    s_waitcnt vmcnt(0)
    v_lshlrev_b32 v231, 2, v240
    s_mov_b64 exec, 0x7f
    buffer_store_dword v246, v231, s[12:15], s51 offen offset:0 sc1
    s_mov_b64 exec, -1
    s_endpgm
W_BETAQ:
    s_setpc_b64 s[30:31]
K1_B_BETAQ:
    v_add_u32 v200, 81920, v192
    v_add_u32 v201, 81920, v193
    s_mov_b32 s16, s52
    s_mov_b32 s17, s53
    s_mov_b32 s18, 1605632
    s_mov_b32 s19, 0x20000
    s_waitcnt vmcnt(12)
    s_barrier
    ds_read_b64_tr_b16 v[160:161], v200 offset:0
    ds_read_b64_tr_b16 v[162:163], v200 offset:1024
    ds_read_b64_tr_b16 v[164:165], v201 offset:0
    ds_read_b64_tr_b16 v[166:167], v201 offset:1024
    s_waitcnt lgkmcnt(2)
    v_mfma_f32_32x32x16_bf16 v[112:127], v[160:163], v[32:35], 0
    v_mfma_f32_16x16x32_bf16 v[220:223], v[160:163], v[216:219], v[220:223]
    ds_read_b64_tr_b16 v[172:173], v200 offset:4096
    ds_read_b64_tr_b16 v[174:175], v200 offset:5120
    s_add_u32 m0, s77, 16384
    s_nop 0
    buffer_load_dwordx4 v187, s[8:11], s67 offen lds
    s_waitcnt lgkmcnt(2)
    v_mfma_f32_32x32x16_bf16 v[128:143], v[164:167], v[32:35], 0
    v_mfma_f32_16x16x32_bf16 v[212:215], v[164:167], v[216:219], v[212:215]
    ds_read_b64_tr_b16 v[176:177], v201 offset:4096
    ds_read_b64_tr_b16 v[178:179], v201 offset:5120
    s_add_u32 m0, s77, 17408
    s_add_u32 s75, s67, s74
    buffer_load_dwordx4 v187, s[8:11], s75 offen lds
    s_waitcnt lgkmcnt(2)
    v_mfma_f32_32x32x16_bf16 v[112:127], v[172:175], v[36:39], v[112:127]
    v_mfma_f32_16x16x32_bf16 v[220:223], v[172:175], v[216:219], v[220:223]
    ds_read_b64_tr_b16 v[160:161], v200 offset:8192
    ds_read_b64_tr_b16 v[162:163], v200 offset:9216
    s_add_u32 m0, s77, 18432
    s_add_u32 s75, s75, s74
    buffer_load_dwordx4 v187, s[8:11], s75 offen lds
    s_waitcnt lgkmcnt(2)
    v_mfma_f32_32x32x16_bf16 v[128:143], v[176:179], v[36:39], v[128:143]
    v_mfma_f32_16x16x32_bf16 v[212:215], v[176:179], v[216:219], v[212:215]
    ds_read_b64_tr_b16 v[164:165], v201 offset:8192
    ds_read_b64_tr_b16 v[166:167], v201 offset:9216
    s_add_u32 m0, s77, 19456
    s_add_u32 s75, s75, s74
    buffer_load_dwordx4 v187, s[8:11], s75 offen lds
    s_waitcnt lgkmcnt(2)
    v_mfma_f32_32x32x16_bf16 v[112:127], v[160:163], v[40:43], v[112:127]
    v_mfma_f32_16x16x32_bf16 v[220:223], v[160:163], v[216:219], v[220:223]
    ds_read_b64_tr_b16 v[172:173], v200 offset:12288
    ds_read_b64_tr_b16 v[174:175], v200 offset:13312
    s_add_u32 m0, s77, 32768
    s_nop 0
    buffer_load_dwordx4 v187, s[8:11], s68 offen lds
    s_waitcnt lgkmcnt(2)
    v_mfma_f32_32x32x16_bf16 v[128:143], v[164:167], v[40:43], v[128:143]
    v_mfma_f32_16x16x32_bf16 v[212:215], v[164:167], v[216:219], v[212:215]
    ds_read_b64_tr_b16 v[176:177], v201 offset:12288
    ds_read_b64_tr_b16 v[178:179], v201 offset:13312
    s_add_u32 m0, s77, 33792
    s_add_u32 s75, s68, s74
    buffer_load_dwordx4 v187, s[8:11], s75 offen lds
    v_add_u32 v200, 98304, v192
    v_add_u32 v201, 98304, v193
    s_waitcnt lgkmcnt(2)
    v_mfma_f32_32x32x16_bf16 v[112:127], v[172:175], v[44:47], v[112:127]
    v_mfma_f32_16x16x32_bf16 v[220:223], v[172:175], v[216:219], v[220:223]
    ds_read_b64_tr_b16 v[160:161], v200 offset:0
    ds_read_b64_tr_b16 v[162:163], v200 offset:1024
    s_add_u32 m0, s77, 34816
    s_add_u32 s75, s75, s74
    buffer_load_dwordx4 v187, s[8:11], s75 offen lds
    s_waitcnt lgkmcnt(2)
    v_mfma_f32_32x32x16_bf16 v[128:143], v[176:179], v[44:47], v[128:143]
    v_mfma_f32_16x16x32_bf16 v[212:215], v[176:179], v[216:219], v[212:215]
    ds_read_b64_tr_b16 v[164:165], v201 offset:0
    ds_read_b64_tr_b16 v[166:167], v201 offset:1024
    s_add_u32 m0, s77, 35840
    s_add_u32 s75, s75, s74
    buffer_load_dwordx4 v187, s[8:11], s75 offen lds
    s_waitcnt lgkmcnt(2)
    v_mfma_f32_32x32x16_bf16 v[112:127], v[160:163], v[48:51], v[112:127]
    v_mfma_f32_16x16x32_bf16 v[220:223], v[160:163], v[216:219], v[220:223]
    ds_read_b64_tr_b16 v[172:173], v200 offset:4096
    ds_read_b64_tr_b16 v[174:175], v200 offset:5120
    s_bfe_u32 s76, s3, 0x40000
    s_and_b32 s29, s76, 8
    s_add_u32 s76, s76, s29
    s_lshl_b32 s76, s76, 10
    s_mul_i32 s76, s76, 14
    s_waitcnt lgkmcnt(2)
    v_mfma_f32_32x32x16_bf16 v[128:143], v[164:167], v[48:51], v[128:143]
    v_mfma_f32_16x16x32_bf16 v[212:215], v[164:167], v[216:219], v[212:215]
    ds_read_b64_tr_b16 v[176:177], v201 offset:4096
    ds_read_b64_tr_b16 v[178:179], v201 offset:5120
    s_add_u32 s76, s76, s48
    s_add_u32 s78, s76, 7168
    buffer_load_dwordx4 v[32:35], v204, s[16:19], s76 offen
    buffer_load_dwordx4 v[36:39], v204, s[16:19], s78 offen
    s_waitcnt lgkmcnt(2)
    v_mfma_f32_32x32x16_bf16 v[112:127], v[172:175], v[52:55], v[112:127]
    v_mfma_f32_16x16x32_bf16 v[220:223], v[172:175], v[216:219], v[220:223]
    ds_read_b64_tr_b16 v[160:161], v200 offset:8192
    ds_read_b64_tr_b16 v[162:163], v200 offset:9216
    s_bfe_u32 s76, s3, 0x40004
    s_and_b32 s29, s76, 8
    s_add_u32 s76, s76, s29
    s_lshl_b32 s76, s76, 10
    s_mul_i32 s76, s76, 14
    s_waitcnt lgkmcnt(2)
    v_mfma_f32_32x32x16_bf16 v[128:143], v[176:179], v[52:55], v[128:143]
    v_mfma_f32_16x16x32_bf16 v[212:215], v[176:179], v[216:219], v[212:215]
    ds_read_b64_tr_b16 v[164:165], v201 offset:8192
    ds_read_b64_tr_b16 v[166:167], v201 offset:9216
    s_add_u32 s76, s76, s48
    s_add_u32 s78, s76, 7168
    buffer_load_dwordx4 v[40:43], v204, s[16:19], s76 offen
    buffer_load_dwordx4 v[44:47], v204, s[16:19], s78 offen
    s_waitcnt lgkmcnt(2)
    v_mfma_f32_32x32x16_bf16 v[112:127], v[160:163], v[56:59], v[112:127]
    v_mfma_f32_16x16x32_bf16 v[220:223], v[160:163], v[216:219], v[220:223]
    ds_read_b64_tr_b16 v[172:173], v200 offset:12288
    ds_read_b64_tr_b16 v[174:175], v200 offset:13312
    s_bfe_u32 s76, s3, 0x40008
    s_and_b32 s29, s76, 8
    s_add_u32 s76, s76, s29
    s_lshl_b32 s76, s76, 10
    s_mul_i32 s76, s76, 14
    s_waitcnt lgkmcnt(2)
    v_mfma_f32_32x32x16_bf16 v[128:143], v[164:167], v[56:59], v[128:143]
    v_mfma_f32_16x16x32_bf16 v[212:215], v[164:167], v[216:219], v[212:215]
    ds_read_b64_tr_b16 v[176:177], v201 offset:12288
    ds_read_b64_tr_b16 v[178:179], v201 offset:13312
    s_add_u32 s76, s76, s48
    s_add_u32 s78, s76, 7168
    buffer_load_dwordx4 v[48:51], v204, s[16:19], s76 offen
    buffer_load_dwordx4 v[52:55], v204, s[16:19], s78 offen
    s_waitcnt vmcnt(14)
    s_barrier
    v_add_u32 v200, 114688, v192
    v_add_u32 v201, 114688, v193
    s_waitcnt lgkmcnt(2)
    v_mfma_f32_32x32x16_bf16 v[112:127], v[172:175], v[60:63], v[112:127]
    v_mfma_f32_16x16x32_bf16 v[220:223], v[172:175], v[216:219], v[220:223]
    ds_read_b64_tr_b16 v[160:161], v200 offset:0
    ds_read_b64_tr_b16 v[162:163], v200 offset:1024
    s_bfe_u32 s76, s3, 0x4000c
    s_and_b32 s29, s76, 8
    s_add_u32 s76, s76, s29
    s_lshl_b32 s76, s76, 10
    s_waitcnt lgkmcnt(2)
    v_mfma_f32_32x32x16_bf16 v[128:143], v[176:179], v[60:63], v[128:143]
    v_mfma_f32_16x16x32_bf16 v[212:215], v[176:179], v[216:219], v[212:215]
    ds_read_b64_tr_b16 v[164:165], v201 offset:0
    ds_read_b64_tr_b16 v[166:167], v201 offset:1024
    s_mul_i32 s76, s76, 14
    s_add_u32 s76, s76, s48
    s_add_u32 s78, s76, 7168
    buffer_load_dwordx4 v[56:59], v204, s[16:19], s76 offen
    s_waitcnt lgkmcnt(2)
    v_mfma_f32_32x32x16_bf16 v[112:127], v[160:163], v[64:67], v[112:127]
    v_mfma_f32_16x16x32_bf16 v[220:223], v[160:163], v[216:219], v[220:223]
    ds_read_b64_tr_b16 v[172:173], v200 offset:4096
    ds_read_b64_tr_b16 v[174:175], v200 offset:5120
    buffer_load_dwordx4 v[60:63], v204, s[16:19], s78 offen
    s_waitcnt lgkmcnt(2)
    v_mfma_f32_32x32x16_bf16 v[128:143], v[164:167], v[64:67], v[128:143]
    v_mfma_f32_16x16x32_bf16 v[212:215], v[164:167], v[216:219], v[212:215]
    ds_read_b64_tr_b16 v[176:177], v201 offset:4096
    ds_read_b64_tr_b16 v[178:179], v201 offset:5120
    s_waitcnt lgkmcnt(2)
    v_mfma_f32_32x32x16_bf16 v[112:127], v[172:175], v[68:71], v[112:127]
    v_mfma_f32_16x16x32_bf16 v[220:223], v[172:175], v[216:219], v[220:223]
    ds_read_b64_tr_b16 v[160:161], v200 offset:8192
    ds_read_b64_tr_b16 v[162:163], v200 offset:9216
    s_bfe_u32 s76, s3, 0x40010
    s_and_b32 s29, s76, 8
    s_add_u32 s76, s76, s29
    s_lshl_b32 s76, s76, 10
    s_mul_i32 s76, s76, 14
    s_add_u32 s76, s76, s48
    s_waitcnt lgkmcnt(2)
    v_mfma_f32_32x32x16_bf16 v[128:143], v[176:179], v[68:71], v[128:143]
    v_mfma_f32_16x16x32_bf16 v[212:215], v[176:179], v[216:219], v[212:215]
    ds_read_b64_tr_b16 v[164:165], v201 offset:8192
    ds_read_b64_tr_b16 v[166:167], v201 offset:9216
    s_add_u32 s78, s76, 7168
    buffer_load_dwordx4 v[64:67], v204, s[16:19], s76 offen
    s_mov_b32 s8, s44
    s_mov_b32 s9, s45
    s_mov_b32 s10, 401408
    s_mov_b32 s11, 0x20000
    s_waitcnt lgkmcnt(2)
    v_mfma_f32_32x32x16_bf16 v[112:127], v[160:163], v[72:75], v[112:127]
    v_mfma_f32_16x16x32_bf16 v[220:223], v[160:163], v[216:219], v[220:223]
    ds_read_b64_tr_b16 v[172:173], v200 offset:12288
    ds_read_b64_tr_b16 v[174:175], v200 offset:13312
    buffer_load_dwordx4 v[68:71], v204, s[16:19], s78 offen
    s_waitcnt lgkmcnt(2)
    v_mfma_f32_32x32x16_bf16 v[128:143], v[164:167], v[72:75], v[128:143]
    v_mfma_f32_16x16x32_bf16 v[212:215], v[164:167], v[216:219], v[212:215]
    ds_read_b64_tr_b16 v[176:177], v201 offset:12288
    ds_read_b64_tr_b16 v[178:179], v201 offset:13312
    v_add_u32 v200, 131072, v192
    v_add_u32 v201, 131072, v193
    s_waitcnt lgkmcnt(2)
    v_mfma_f32_32x32x16_bf16 v[112:127], v[172:175], v[76:79], v[112:127]
    v_mfma_f32_16x16x32_bf16 v[220:223], v[172:175], v[216:219], v[220:223]
    ds_read_b64_tr_b16 v[160:161], v200 offset:0
    ds_read_b64_tr_b16 v[162:163], v200 offset:1024
    s_bfe_u32 s76, s3, 0x40014
    s_and_b32 s29, s76, 8
    s_add_u32 s76, s76, s29
    s_lshl_b32 s76, s76, 10
    s_waitcnt lgkmcnt(2)
    v_mfma_f32_32x32x16_bf16 v[128:143], v[176:179], v[76:79], v[128:143]
    v_mfma_f32_16x16x32_bf16 v[212:215], v[176:179], v[216:219], v[212:215]
    ds_read_b64_tr_b16 v[164:165], v201 offset:0
    ds_read_b64_tr_b16 v[166:167], v201 offset:1024
    s_mul_i32 s76, s76, 14
    s_add_u32 s76, s76, s48
    s_add_u32 s78, s76, 7168
    buffer_load_dwordx4 v[72:75], v204, s[16:19], s76 offen
    s_waitcnt lgkmcnt(2)
    v_mfma_f32_32x32x16_bf16 v[112:127], v[160:163], v[80:83], v[112:127]
    v_mfma_f32_16x16x32_bf16 v[220:223], v[160:163], v[216:219], v[220:223]
    ds_read_b64_tr_b16 v[172:173], v200 offset:4096
    ds_read_b64_tr_b16 v[174:175], v200 offset:5120
    buffer_load_dwordx4 v[76:79], v204, s[16:19], s78 offen
    s_waitcnt lgkmcnt(2)
    v_mfma_f32_32x32x16_bf16 v[128:143], v[164:167], v[80:83], v[128:143]
    v_mfma_f32_16x16x32_bf16 v[212:215], v[164:167], v[216:219], v[212:215]
    ds_read_b64_tr_b16 v[176:177], v201 offset:4096
    ds_read_b64_tr_b16 v[178:179], v201 offset:5120
    s_waitcnt lgkmcnt(2)
    v_mfma_f32_32x32x16_bf16 v[112:127], v[172:175], v[84:87], v[112:127]
    v_mfma_f32_16x16x32_bf16 v[220:223], v[172:175], v[216:219], v[220:223]
    ds_read_b64_tr_b16 v[160:161], v200 offset:8192
    ds_read_b64_tr_b16 v[162:163], v200 offset:9216
    s_bfe_u32 s76, s3, 0x40018
    s_and_b32 s29, s76, 8
    s_add_u32 s76, s76, s29
    s_lshl_b32 s76, s76, 10
    s_waitcnt lgkmcnt(2)
    v_mfma_f32_32x32x16_bf16 v[128:143], v[176:179], v[84:87], v[128:143]
    v_mfma_f32_16x16x32_bf16 v[212:215], v[176:179], v[216:219], v[212:215]
    ds_read_b64_tr_b16 v[164:165], v201 offset:8192
    ds_read_b64_tr_b16 v[166:167], v201 offset:9216
    s_mul_i32 s76, s76, 14
    s_add_u32 s76, s76, s48
    s_add_u32 s78, s76, 7168
    buffer_load_dwordx4 v[80:83], v204, s[16:19], s76 offen
    s_waitcnt lgkmcnt(2)
    v_mfma_f32_32x32x16_bf16 v[112:127], v[160:163], v[88:91], v[112:127]
    v_mfma_f32_16x16x32_bf16 v[220:223], v[160:163], v[216:219], v[220:223]
    ds_read_b64_tr_b16 v[172:173], v200 offset:12288
    ds_read_b64_tr_b16 v[174:175], v200 offset:13312
    buffer_load_dwordx4 v[84:87], v204, s[16:19], s78 offen
    s_waitcnt lgkmcnt(2)
    v_mfma_f32_32x32x16_bf16 v[128:143], v[164:167], v[88:91], v[128:143]
    v_mfma_f32_16x16x32_bf16 v[212:215], v[164:167], v[216:219], v[212:215]
    ds_read_b64_tr_b16 v[176:177], v201 offset:12288
    ds_read_b64_tr_b16 v[178:179], v201 offset:13312
    v_add_u32 v200, 0, v192
    v_add_u32 v201, 0, v193
    s_waitcnt lgkmcnt(2)
    v_mfma_f32_32x32x16_bf16 v[112:127], v[172:175], v[92:95], v[112:127]
    v_mfma_f32_16x16x32_bf16 v[220:223], v[172:175], v[216:219], v[220:223]
    ds_read_b64_tr_b16 v[160:161], v200 offset:0
    ds_read_b64_tr_b16 v[162:163], v200 offset:1024
    s_bfe_u32 s76, s3, 0x4001c
    s_and_b32 s29, s76, 8
    s_add_u32 s76, s76, s29
    s_lshl_b32 s76, s76, 10
    s_waitcnt lgkmcnt(2)
    v_mfma_f32_32x32x16_bf16 v[128:143], v[176:179], v[92:95], v[128:143]
    v_mfma_f32_16x16x32_bf16 v[212:215], v[176:179], v[216:219], v[212:215]
    ds_read_b64_tr_b16 v[164:165], v201 offset:0
    ds_read_b64_tr_b16 v[166:167], v201 offset:1024
    s_mul_i32 s76, s76, 14
    s_add_u32 s76, s76, s48
    s_add_u32 s78, s76, 7168
    buffer_load_dwordx4 v[88:91], v204, s[16:19], s76 offen
    s_waitcnt lgkmcnt(2)
    v_mfma_f32_32x32x16_bf16 v[112:127], v[160:163], v[96:99], v[112:127]
    v_mfma_f32_16x16x32_bf16 v[220:223], v[160:163], v[216:219], v[220:223]
    ds_read_b64_tr_b16 v[172:173], v200 offset:4096
    ds_read_b64_tr_b16 v[174:175], v200 offset:5120
    buffer_load_dwordx4 v[92:95], v204, s[16:19], s78 offen
    s_waitcnt lgkmcnt(2)
    v_mfma_f32_32x32x16_bf16 v[128:143], v[164:167], v[96:99], v[128:143]
    v_mfma_f32_16x16x32_bf16 v[212:215], v[164:167], v[216:219], v[212:215]
    ds_read_b64_tr_b16 v[176:177], v201 offset:4096
    ds_read_b64_tr_b16 v[178:179], v201 offset:5120
    s_waitcnt lgkmcnt(2)
    v_mfma_f32_32x32x16_bf16 v[112:127], v[172:175], v[100:103], v[112:127]
    v_mfma_f32_16x16x32_bf16 v[220:223], v[172:175], v[216:219], v[220:223]
    ds_read_b64_tr_b16 v[160:161], v200 offset:8192
    ds_read_b64_tr_b16 v[162:163], v200 offset:9216
    s_bfe_u32 s76, s1, 0x40000
    s_and_b32 s29, s76, 8
    s_add_u32 s76, s76, s29
    s_lshl_b32 s76, s76, 10
    s_waitcnt lgkmcnt(2)
    v_mfma_f32_32x32x16_bf16 v[128:143], v[176:179], v[100:103], v[128:143]
    v_mfma_f32_16x16x32_bf16 v[212:215], v[176:179], v[216:219], v[212:215]
    ds_read_b64_tr_b16 v[164:165], v201 offset:8192
    ds_read_b64_tr_b16 v[166:167], v201 offset:9216
    s_mul_i32 s76, s76, 14
    s_add_u32 s76, s76, s48
    s_add_u32 s78, s76, 7168
    buffer_load_dwordx4 v[96:99], v204, s[16:19], s76 offen
    s_waitcnt lgkmcnt(2)
    v_mfma_f32_32x32x16_bf16 v[112:127], v[160:163], v[104:107], v[112:127]
    v_mfma_f32_16x16x32_bf16 v[220:223], v[160:163], v[216:219], v[220:223]
    ds_read_b64_tr_b16 v[172:173], v200 offset:12288
    ds_read_b64_tr_b16 v[174:175], v200 offset:13312
    buffer_load_dwordx4 v[100:103], v204, s[16:19], s78 offen
    s_waitcnt lgkmcnt(2)
    v_mfma_f32_32x32x16_bf16 v[128:143], v[164:167], v[104:107], v[128:143]
    v_mfma_f32_16x16x32_bf16 v[212:215], v[164:167], v[216:219], v[212:215]
    ds_read_b64_tr_b16 v[176:177], v201 offset:12288
    ds_read_b64_tr_b16 v[178:179], v201 offset:13312
    s_waitcnt vmcnt(18)
    s_barrier
    v_add_u32 v200, 16384, v192
    v_add_u32 v201, 16384, v193
    s_waitcnt lgkmcnt(2)
    v_mfma_f32_32x32x16_bf16 v[112:127], v[172:175], v[108:111], v[112:127]
    v_mfma_f32_16x16x32_bf16 v[220:223], v[172:175], v[216:219], v[220:223]
    ds_read_b64_tr_b16 v[160:161], v200 offset:0
    ds_read_b64_tr_b16 v[162:163], v200 offset:1024
    s_bfe_u32 s76, s1, 0x40004
    s_and_b32 s29, s76, 8
    s_add_u32 s76, s76, s29
    s_lshl_b32 s76, s76, 10
    s_waitcnt lgkmcnt(2)
    v_mfma_f32_32x32x16_bf16 v[128:143], v[176:179], v[108:111], v[128:143]
    v_mfma_f32_16x16x32_bf16 v[212:215], v[176:179], v[216:219], v[212:215]
    ds_read_b64_tr_b16 v[164:165], v201 offset:0
    ds_read_b64_tr_b16 v[166:167], v201 offset:1024
    s_mul_i32 s76, s76, 14
    s_add_u32 s76, s76, s48
    s_add_u32 s78, s76, 7168
    buffer_load_dwordx4 v[104:107], v204, s[16:19], s76 offen
    s_waitcnt lgkmcnt(2)
    v_mfma_f32_32x32x16_bf16 v[112:127], v[160:163], v[0:3], v[112:127]
    v_mfma_f32_16x16x32_bf16 v[220:223], v[160:163], v[216:219], v[220:223]
    ds_read_b64_tr_b16 v[172:173], v200 offset:4096
    ds_read_b64_tr_b16 v[174:175], v200 offset:5120
    buffer_load_dwordx4 v[108:111], v204, s[16:19], s78 offen
    s_waitcnt lgkmcnt(2)
    v_mfma_f32_32x32x16_bf16 v[128:143], v[164:167], v[0:3], v[128:143]
    v_mfma_f32_16x16x32_bf16 v[212:215], v[164:167], v[216:219], v[212:215]
    ds_read_b64_tr_b16 v[176:177], v201 offset:4096
    ds_read_b64_tr_b16 v[178:179], v201 offset:5120
    s_waitcnt lgkmcnt(2)
    v_mfma_f32_32x32x16_bf16 v[112:127], v[172:175], v[4:7], v[112:127]
    v_mfma_f32_16x16x32_bf16 v[220:223], v[172:175], v[216:219], v[220:223]
    ds_read_b64_tr_b16 v[160:161], v200 offset:8192
    ds_read_b64_tr_b16 v[162:163], v200 offset:9216
    s_waitcnt lgkmcnt(2)
    v_mfma_f32_32x32x16_bf16 v[128:143], v[176:179], v[4:7], v[128:143]
    v_mfma_f32_16x16x32_bf16 v[212:215], v[176:179], v[216:219], v[212:215]
    ds_read_b64_tr_b16 v[164:165], v201 offset:8192
    ds_read_b64_tr_b16 v[166:167], v201 offset:9216
    s_waitcnt lgkmcnt(2)
    v_mfma_f32_32x32x16_bf16 v[112:127], v[160:163], v[8:11], v[112:127]
    v_mfma_f32_16x16x32_bf16 v[220:223], v[160:163], v[216:219], v[220:223]
    ds_read_b64_tr_b16 v[172:173], v200 offset:12288
    ds_read_b64_tr_b16 v[174:175], v200 offset:13312
    s_waitcnt lgkmcnt(2)
    v_mfma_f32_32x32x16_bf16 v[128:143], v[164:167], v[8:11], v[128:143]
    v_mfma_f32_16x16x32_bf16 v[212:215], v[164:167], v[216:219], v[212:215]
    ds_read_b64_tr_b16 v[176:177], v201 offset:12288
    ds_read_b64_tr_b16 v[178:179], v201 offset:13312
    v_add_u32 v200, 32768, v192
    v_add_u32 v201, 32768, v193
    s_waitcnt lgkmcnt(2)
    v_mfma_f32_32x32x16_bf16 v[112:127], v[172:175], v[12:15], v[112:127]
    v_mfma_f32_16x16x32_bf16 v[220:223], v[172:175], v[216:219], v[220:223]
    ds_read_b64_tr_b16 v[160:161], v200 offset:0
    ds_read_b64_tr_b16 v[162:163], v200 offset:1024
    s_waitcnt lgkmcnt(2)
    v_mfma_f32_32x32x16_bf16 v[128:143], v[176:179], v[12:15], v[128:143]
    v_mfma_f32_16x16x32_bf16 v[212:215], v[176:179], v[216:219], v[212:215]
    ds_read_b64_tr_b16 v[164:165], v201 offset:0
    ds_read_b64_tr_b16 v[166:167], v201 offset:1024
    s_waitcnt lgkmcnt(2)
    v_mfma_f32_32x32x16_bf16 v[112:127], v[160:163], v[16:19], v[112:127]
    v_mfma_f32_16x16x32_bf16 v[220:223], v[160:163], v[216:219], v[220:223]
    ds_read_b64_tr_b16 v[172:173], v200 offset:4096
    ds_read_b64_tr_b16 v[174:175], v200 offset:5120
    s_waitcnt lgkmcnt(2)
    v_mfma_f32_32x32x16_bf16 v[128:143], v[164:167], v[16:19], v[128:143]
    v_mfma_f32_16x16x32_bf16 v[212:215], v[164:167], v[216:219], v[212:215]
    ds_read_b64_tr_b16 v[176:177], v201 offset:4096
    ds_read_b64_tr_b16 v[178:179], v201 offset:5120
    s_waitcnt lgkmcnt(2)
    v_mfma_f32_32x32x16_bf16 v[112:127], v[172:175], v[20:23], v[112:127]
    v_mfma_f32_16x16x32_bf16 v[220:223], v[172:175], v[216:219], v[220:223]
    ds_read_b64_tr_b16 v[160:161], v200 offset:8192
    ds_read_b64_tr_b16 v[162:163], v200 offset:9216
    s_waitcnt lgkmcnt(2)
    v_mfma_f32_32x32x16_bf16 v[128:143], v[176:179], v[20:23], v[128:143]
    v_mfma_f32_16x16x32_bf16 v[212:215], v[176:179], v[216:219], v[212:215]
    ds_read_b64_tr_b16 v[164:165], v201 offset:8192
    ds_read_b64_tr_b16 v[166:167], v201 offset:9216
    s_waitcnt lgkmcnt(2)
    v_mfma_f32_32x32x16_bf16 v[112:127], v[160:163], v[24:27], v[112:127]
    v_mfma_f32_16x16x32_bf16 v[220:223], v[160:163], v[216:219], v[220:223]
    ds_read_b64_tr_b16 v[172:173], v200 offset:12288
    ds_read_b64_tr_b16 v[174:175], v200 offset:13312
    s_waitcnt lgkmcnt(2)
    v_mfma_f32_32x32x16_bf16 v[128:143], v[164:167], v[24:27], v[128:143]
    v_mfma_f32_16x16x32_bf16 v[212:215], v[164:167], v[216:219], v[212:215]
    ds_read_b64_tr_b16 v[176:177], v201 offset:12288
    ds_read_b64_tr_b16 v[178:179], v201 offset:13312
    s_waitcnt lgkmcnt(2)
    v_mfma_f32_32x32x16_bf16 v[112:127], v[172:175], v[28:31], v[112:127]
    v_mfma_f32_16x16x32_bf16 v[220:223], v[172:175], v[216:219], v[220:223]
    s_waitcnt lgkmcnt(0)
    v_mfma_f32_32x32x16_bf16 v[128:143], v[176:179], v[28:31], v[128:143]
    v_mfma_f32_16x16x32_bf16 v[212:215], v[176:179], v[216:219], v[212:215]
    s_lshl_b32 s26, s23, 10
    s_add_u32 s26, s26, 156672
    v_add_u32 v225, s26, v240
    s_lshl_b32 s26, s23, 7
    s_add_u32 s26, s26, 160768
    v_lshl_add_u32 v226, v243, 2, s26
    ds_read_b128 v[248:251], v225
    ds_read_b32 v242, v226
    s_lshl_b32 s28, s23, 8
    s_add_u32 s28, s28, 161792
    v_and_b32 v230, 15, v241
    v_lshrrev_b32 v231, 4, v241
    v_lshlrev_b32 v230, 6, v230
    v_lshl_add_u32 v230, v231, 4, v230
    v_add_u32 v227, s28, v230
    v_add_u32 v228, s28, v230
    s_mov_b32 exec_lo, 0x00030003
    s_mov_b32 exec_hi, 0x00030003
    ds_write_b128 v227, v[220:223] offset:0
    ds_write_b128 v228, v[212:215] offset:128
    s_mov_b64 exec, -1
    v_lshl_add_u32 v225, v243, 2, s28
    v_add_u32 v226, 128, v225
    s_mul_i32 s26, s23, 20480
    v_add_u32 v224, s26, v240
    s_waitcnt lgkmcnt(0)
    s_cmp_ge_u32 s0, 224
    s_cbranch_scc1 K1_B_NOFq
    s_barrier
    s_waitcnt vmcnt(0)
    ds_write_b128 v224, v[32:35] offset:0
    ds_write_b128 v224, v[36:39] offset:1024
    ds_write_b128 v224, v[40:43] offset:2048
    ds_write_b128 v224, v[44:47] offset:3072
    ds_write_b128 v224, v[48:51] offset:4096
    ds_write_b128 v224, v[52:55] offset:5120
    ds_write_b128 v224, v[56:59] offset:6144
    ds_write_b128 v224, v[60:63] offset:7168
    ds_write_b128 v224, v[64:67] offset:8192
    ds_write_b128 v224, v[68:71] offset:9216
    ds_write_b128 v224, v[72:75] offset:10240
    ds_write_b128 v224, v[76:79] offset:11264
    ds_write_b128 v224, v[80:83] offset:12288
    ds_write_b128 v224, v[84:87] offset:13312
    ds_write_b128 v224, v[88:91] offset:14336
    ds_write_b128 v224, v[92:95] offset:15360
    ds_write_b128 v224, v[96:99] offset:16384
    ds_write_b128 v224, v[100:103] offset:17408
    ds_write_b128 v224, v[104:107] offset:18432
    ds_write_b128 v224, v[108:111] offset:19456
    s_waitcnt lgkmcnt(0)
    s_barrier
K1_B_NOFq:
    ds_read_b32 v208, v225
    ds_read_b32 v209, v226
    v_mul_f32 v244, 0x3fb8aa3b, v242
    s_waitcnt lgkmcnt(0)
    v_cvt_pk_bf16_f32 v231, v208, v208
    v_and_b32 v231, 0xffff0000, v231
    v_sub_f32 v231, v208, v231
    v_cvt_pk_bf16_f32 v252, v208, v231
    v_cvt_pk_bf16_f32 v253, v208, 0
    v_mov_b32 v254, 0
    v_mov_b32 v255, 0
    s_nop 1
    v_mfma_f32_32x32x16_bf16 v[112:127], v[252:255], v[248:251], v[112:127]
    v_cvt_pk_bf16_f32 v231, v209, v209
    v_and_b32 v231, 0xffff0000, v231
    v_sub_f32 v231, v209, v231
    v_cvt_pk_bf16_f32 v252, v209, v231
    v_cvt_pk_bf16_f32 v253, v209, 0
    v_mov_b32 v254, 0
    v_mov_b32 v255, 0
    s_nop 1
    v_mfma_f32_32x32x16_bf16 v[128:143], v[252:255], v[248:251], v[128:143]
    s_nop 1
    s_lshl_b32 s26, s87, 4
    s_add_u32 s26, s26, s84
    s_lshl_b32 s26, s26, 11
    s_add_u32 s39, s26, 7340032
    v_fma_f32 v112, v112, v244, v245
    v_fma_f32 v113, v113, v244, v245
    v_fma_f32 v114, v114, v244, v245
    v_fma_f32 v115, v115, v244, v245
    v_fma_f32 v116, v116, v244, v245
    v_fma_f32 v117, v117, v244, v245
    v_fma_f32 v118, v118, v244, v245
    v_fma_f32 v119, v119, v244, v245
    v_fma_f32 v120, v120, v244, v245
    v_fma_f32 v121, v121, v244, v245
    v_fma_f32 v122, v122, v244, v245
    v_fma_f32 v123, v123, v244, v245
    v_fma_f32 v124, v124, v244, v245
    v_fma_f32 v125, v125, v244, v245
    v_fma_f32 v126, v126, v244, v245
    v_fma_f32 v127, v127, v244, v245
    v_exp_f32_e64 v16, v112 clamp
    v_exp_f32_e64 v17, v113 clamp
    v_exp_f32_e64 v18, v114 clamp
    v_exp_f32_e64 v19, v115 clamp
    v_exp_f32_e64 v20, v116 clamp
    v_exp_f32_e64 v21, v117 clamp
    v_exp_f32_e64 v22, v118 clamp
    v_exp_f32_e64 v23, v119 clamp
    v_exp_f32_e64 v24, v120 clamp
    v_exp_f32_e64 v25, v121 clamp
    v_exp_f32_e64 v26, v122 clamp
    v_exp_f32_e64 v27, v123 clamp
    v_exp_f32_e64 v28, v124 clamp
    v_exp_f32_e64 v29, v125 clamp
    v_exp_f32_e64 v30, v126 clamp
    v_exp_f32_e64 v31, v127 clamp
    v_max_f32 v112, s38, v112
    v_max_f32 v113, s38, v113
    v_max_f32 v114, s38, v114
    v_max_f32 v115, s38, v115
    v_max_f32 v116, s38, v116
    v_max_f32 v117, s38, v117
    v_max_f32 v118, s38, v118
    v_max_f32 v119, s38, v119
    v_max_f32 v120, s38, v120
    v_max_f32 v121, s38, v121
    v_max_f32 v122, s38, v122
    v_max_f32 v123, s38, v123
    v_max_f32 v124, s38, v124
    v_max_f32 v125, s38, v125
    v_max_f32 v126, s38, v126
    v_max_f32 v127, s38, v127
    v_fmac_f32 v16, s37, v112
    v_fmac_f32 v17, s37, v113
    v_fmac_f32 v18, s37, v114
    v_fmac_f32 v19, s37, v115
    v_fmac_f32 v20, s37, v116
    v_fmac_f32 v21, s37, v117
    v_fmac_f32 v22, s37, v118
    v_fmac_f32 v23, s37, v119
    v_fmac_f32 v24, s37, v120
    v_fmac_f32 v25, s37, v121
    v_fmac_f32 v26, s37, v122
    v_fmac_f32 v27, s37, v123
    v_fmac_f32 v28, s37, v124
    v_fmac_f32 v29, s37, v125
    v_fmac_f32 v30, s37, v126
    v_fmac_f32 v31, s37, v127
    v_cvt_pk_bf16_f32 v232, v16, v17
    v_cvt_pk_bf16_f32 v233, v18, v19
    v_cvt_pk_bf16_f32 v234, v20, v21
    v_cvt_pk_bf16_f32 v235, v22, v23
    v_cvt_pk_bf16_f32 v236, v24, v25
    v_cvt_pk_bf16_f32 v237, v26, v27
    v_cvt_pk_bf16_f32 v238, v28, v29
    v_cvt_pk_bf16_f32 v239, v30, v31
    v_cndmask_b32_e64 v238, v238, 0, s[34:35]
    v_cndmask_b32_e64 v239, v239, 0, s[34:35]
    s_setprio 3
    buffer_store_dwordx4 v[232:235], v240, s[12:15], s39 offen sc1
    buffer_store_dwordx4 v[236:239], v240, s[12:15], s39 offen offset:1024 sc1
    s_setprio 0
    s_lshl_b32 s26, s23, 2
    s_add_u32 s26, s26, 161312
    v_mov_b32 v222, s26
    s_mov_b32 s76, 0
    s_load_dwordx16 s[60:75], s[58:59], s49 offset:0 glc
    s_lshl_b32 s26, s87, 4
    s_add_u32 s26, s26, s85
    s_lshl_b32 s26, s26, 11
    s_add_u32 s39, s26, 7340032
    v_fma_f32 v128, v128, v244, v245
    v_fma_f32 v129, v129, v244, v245
    v_fma_f32 v130, v130, v244, v245
    v_fma_f32 v131, v131, v244, v245
    v_fma_f32 v132, v132, v244, v245
    v_fma_f32 v133, v133, v244, v245
    v_fma_f32 v134, v134, v244, v245
    v_fma_f32 v135, v135, v244, v245
    v_fma_f32 v136, v136, v244, v245
    v_fma_f32 v137, v137, v244, v245
    v_fma_f32 v138, v138, v244, v245
    v_fma_f32 v139, v139, v244, v245
    v_fma_f32 v140, v140, v244, v245
    v_fma_f32 v141, v141, v244, v245
    v_fma_f32 v142, v142, v244, v245
    v_fma_f32 v143, v143, v244, v245
    v_exp_f32_e64 v16, v128 clamp
    v_exp_f32_e64 v17, v129 clamp
    v_exp_f32_e64 v18, v130 clamp
    v_exp_f32_e64 v19, v131 clamp
    v_exp_f32_e64 v20, v132 clamp
    v_exp_f32_e64 v21, v133 clamp
    v_exp_f32_e64 v22, v134 clamp
    v_exp_f32_e64 v23, v135 clamp
    v_exp_f32_e64 v24, v136 clamp
    v_exp_f32_e64 v25, v137 clamp
    v_exp_f32_e64 v26, v138 clamp
    v_exp_f32_e64 v27, v139 clamp
    v_exp_f32_e64 v28, v140 clamp
    v_exp_f32_e64 v29, v141 clamp
    v_exp_f32_e64 v30, v142 clamp
    v_exp_f32_e64 v31, v143 clamp
    v_max_f32 v128, s38, v128
    v_max_f32 v129, s38, v129
    v_max_f32 v130, s38, v130
    v_max_f32 v131, s38, v131
    v_max_f32 v132, s38, v132
    v_max_f32 v133, s38, v133
    v_max_f32 v134, s38, v134
    v_max_f32 v135, s38, v135
    v_max_f32 v136, s38, v136
    v_max_f32 v137, s38, v137
    v_max_f32 v138, s38, v138
    v_max_f32 v139, s38, v139
    v_max_f32 v140, s38, v140
    v_max_f32 v141, s38, v141
    v_max_f32 v142, s38, v142
    v_max_f32 v143, s38, v143
    v_fmac_f32 v16, s37, v128
    v_fmac_f32 v17, s37, v129
    v_fmac_f32 v18, s37, v130
    v_fmac_f32 v19, s37, v131
    v_fmac_f32 v20, s37, v132
    v_fmac_f32 v21, s37, v133
    v_fmac_f32 v22, s37, v134
    v_fmac_f32 v23, s37, v135
    v_fmac_f32 v24, s37, v136
    v_fmac_f32 v25, s37, v137
    v_fmac_f32 v26, s37, v138
    v_fmac_f32 v27, s37, v139
    v_fmac_f32 v28, s37, v140
    v_fmac_f32 v29, s37, v141
    v_fmac_f32 v30, s37, v142
    v_fmac_f32 v31, s37, v143
    v_cvt_pk_bf16_f32 v232, v16, v17
    v_cvt_pk_bf16_f32 v233, v18, v19
    v_cvt_pk_bf16_f32 v234, v20, v21
    v_cvt_pk_bf16_f32 v235, v22, v23
    v_cvt_pk_bf16_f32 v236, v24, v25
    v_cvt_pk_bf16_f32 v237, v26, v27
    v_cvt_pk_bf16_f32 v238, v28, v29
    v_cvt_pk_bf16_f32 v239, v30, v31
    v_cndmask_b32_e64 v238, v238, 0, s[34:35]
    v_cndmask_b32_e64 v239, v239, 0, s[34:35]
    s_setprio 3
    buffer_store_dwordx4 v[232:235], v240, s[12:15], s39 offen sc1
    buffer_store_dwordx4 v[236:239], v240, s[12:15], s39 offen offset:1024 sc1
    s_waitcnt lgkmcnt(0)
    s_mov_b32 s78, s76
    s_xor_b32 s68, s68, s79
    s_xor_b32 s69, s69, s79
    s_xor_b32 s70, s70, s79
    s_xor_b32 s71, s71, s79
    s_or_b64 s[68:69], s[68:69], s[70:71]
    s_or_b32 s68, s68, s69
    s_cselect_b32 s26, 0, 1
    s_or_b32 s78, s78, s26
    s_load_dwordx16 s[60:75], s[58:59], s49 offset:0 glc
    v_mov_b32 v223, s78
    ds_write_b32 v222, v223
    s_mov_b32 s76, s78
    s_cmp_ge_u32 s0, 224
    s_cbranch_scc0 P2_ATTq
    s_waitcnt vmcnt(0)
    v_lshlrev_b32 v231, 2, v240
    s_mov_b64 exec, 0x7f
    buffer_store_dword v246, v231, s[12:15], s51 offen offset:0 sc1
    s_mov_b64 exec, -1
    s_endpgm
W_ATTQ:
    s_setpc_b64 s[30:31]
P2_ATTq:
    s_waitcnt lgkmcnt(0)
    s_mov_b32 s78, s76
    s_xor_b32 s68, s68, s79
    s_xor_b32 s69, s69, s79
    s_xor_b32 s70, s70, s79
    s_xor_b32 s71, s71, s79
    s_or_b64 s[68:69], s[68:69], s[70:71]
    s_or_b32 s68, s68, s69
    s_cselect_b32 s26, 0, 1
    s_or_b32 s78, s78, s26
    s_load_dwordx16 s[60:75], s[58:59], s49 offset:0 glc
    v_mov_b32 v223, s78
    ds_write_b32 v222, v223
    s_mov_b32 s76, s78
    s_waitcnt vmcnt(0)
    v_lshlrev_b32 v231, 2, v240
    s_mov_b64 exec, 0x7f
    buffer_store_dword v246, v231, s[12:15], s51 offen offset:0 sc1
    s_mov_b64 exec, -1
    s_waitcnt lgkmcnt(0)
    s_mov_b32 s78, s76
    s_xor_b32 s68, s68, s79
    s_xor_b32 s69, s69, s79
    s_xor_b32 s70, s70, s79
    s_xor_b32 s71, s71, s79
    s_or_b64 s[68:69], s[68:69], s[70:71]
    s_or_b32 s68, s68, s69
    s_cselect_b32 s26, 0, 1
    s_or_b32 s78, s78, s26
    s_load_dwordx16 s[60:75], s[58:59], s49 offset:0 glc
    v_mov_b32 v223, s78
    ds_write_b32 v222, v223
    s_mov_b32 s76, s78
    s_add_u32 m0, s46, 0
    s_add_u32 s26, s43, 0
    s_add_u32 s28, s26, 6144
    buffer_load_dwordx4 v204, s[8:11], s26 offen lds
    buffer_load_dwordx4 v204, s[8:11], s28 offen offset:1024 lds
    s_add_u32 m0, s46, 2048
    s_add_u32 s26, s43, 14336
    s_add_u32 s28, s26, 6144
    buffer_load_dwordx4 v204, s[8:11], s26 offen lds
    buffer_load_dwordx4 v204, s[8:11], s28 offen offset:1024 lds
    s_add_u32 m0, s46, 4096
    s_add_u32 s26, s43, 25088
    s_add_u32 s28, s26, 6144
    buffer_load_dwordx4 v204, s[8:11], s26 offen lds
    buffer_load_dwordx4 v204, s[8:11], s28 offen offset:1024 lds
    s_add_u32 m0, s46, 6144
    s_add_u32 s26, s43, 39424
    s_add_u32 s28, s26, 6144
    buffer_load_dwordx4 v204, s[8:11], s26 offen lds
    buffer_load_dwordx4 v204, s[8:11], s28 offen offset:1024 lds
    s_add_u32 m0, s46, 8192
    s_add_u32 s26, s43, 50176
    s_add_u32 s28, s26, 6144
    buffer_load_dwordx4 v204, s[8:11], s26 offen lds
    buffer_load_dwordx4 v204, s[8:11], s28 offen offset:1024 lds
    s_add_u32 m0, s46, 10240
    s_add_u32 s26, s43, 64512
    s_add_u32 s28, s26, 6144
    buffer_load_dwordx4 v204, s[8:11], s26 offen lds
    buffer_load_dwordx4 v204, s[8:11], s28 offen offset:1024 lds
    s_add_u32 m0, s46, 12288
    s_add_u32 s26, s43, 75264
    s_add_u32 s28, s26, 6144
    buffer_load_dwordx4 v204, s[8:11], s26 offen lds
    buffer_load_dwordx4 v204, s[8:11], s28 offen offset:1024 lds
    s_add_u32 m0, s46, 14336
    s_add_u32 s26, s43, 89600
    s_add_u32 s28, s26, 6144
    buffer_load_dwordx4 v204, s[8:11], s26 offen lds
    buffer_load_dwordx4 v204, s[8:11], s28 offen offset:1024 lds
    s_branch P2_ATT
W_ATTH:
    s_setpc_b64 s[30:31]
P2_ATTh:
    s_waitcnt lgkmcnt(0)
    s_mov_b32 s78, s76
    s_xor_b32 s68, s68, s79
    s_xor_b32 s69, s69, s79
    s_xor_b32 s70, s70, s79
    s_xor_b32 s71, s71, s79
    s_or_b64 s[68:69], s[68:69], s[70:71]
    s_or_b32 s68, s68, s69
    s_cselect_b32 s26, 0, 1
    s_or_b32 s78, s78, s26
    s_load_dwordx16 s[60:75], s[58:59], s49 offset:0 glc
    v_mov_b32 v223, s78
    ds_write_b32 v222, v223
    s_mov_b32 s76, s78
    s_waitcnt vmcnt(0)
    v_lshlrev_b32 v231, 2, v240
    s_mov_b64 exec, 0x7f
    buffer_store_dword v246, v231, s[12:15], s51 offen offset:0 sc1
    s_mov_b64 exec, -1
P2_ATT:
    s_setprio 3
    s_add_u32 s28, s50, 28672
    buffer_load_dwordx4 v[192:195], v210, s[4:7], s50 offen
    buffer_load_dwordx4 v[200:203], v210, s[4:7], s28 offen
    s_mov_b32 s27, 0
P2_AL:
    s_waitcnt lgkmcnt(0)
    s_mov_b32 s78, s76
    s_xor_b32 s68, s68, s79
    s_xor_b32 s69, s69, s79
    s_xor_b32 s70, s70, s79
    s_xor_b32 s71, s71, s79
    s_or_b64 s[68:69], s[68:69], s[70:71]
    s_or_b32 s68, s68, s69
    s_cselect_b32 s26, 0, 1
    s_or_b32 s78, s78, s26
    s_xor_b32 s64, s64, s79
    s_xor_b32 s65, s65, s79
    s_xor_b32 s66, s66, s79
    s_xor_b32 s67, s67, s79
    s_or_b64 s[64:65], s[64:65], s[66:67]
    s_or_b32 s64, s64, s65
    s_cselect_b32 s26, 0, 2
    s_or_b32 s78, s78, s26
    s_xor_b32 s72, s72, s79
    s_xor_b32 s73, s73, s79
    s_xor_b32 s74, s74, s79
    s_xor_b32 s75, s75, s79
    s_or_b64 s[72:73], s[72:73], s[74:75]
    s_or_b32 s72, s72, s73
    s_cselect_b32 s26, 0, 4
    s_or_b32 s78, s78, s26
    s_add_u32 s27, s27, 1
    s_cmp_gt_u32 s27, 131072
    s_cselect_b32 s78, 7, s78
    s_cmp_lg_u32 s78, 7
    s_cbranch_scc0 P2_AL1
    s_sleep 2
    s_load_dwordx16 s[60:75], s[58:59], s49 offset:0 glc
P2_AL1:
    v_mov_b32 v223, s78
    ds_write_b32 v222, v223
    s_andn2_b32 s26, s78, s76
    s_mov_b32 s76, s78
    s_bitcmp1_b32 s26, 2
    s_cbranch_scc0 P2_AL2
    s_add_u32 s26, s42, 32768
    s_add_u32 s28, s42, 4096
    s_add_u32 s29, s26, 4096
    buffer_load_dwordx4 v[64:67], v240, s[12:15], s42 offen offset:0 sc1
    buffer_load_dwordx4 v[68:71], v240, s[12:15], s26 offen offset:0 sc1
    buffer_load_dwordx4 v[72:75], v240, s[12:15], s42 offen offset:1024 sc1
    buffer_load_dwordx4 v[76:79], v240, s[12:15], s26 offen offset:1024 sc1
    buffer_load_dwordx4 v[80:83], v240, s[12:15], s42 offen offset:2048 sc1
    buffer_load_dwordx4 v[84:87], v240, s[12:15], s26 offen offset:2048 sc1
    buffer_load_dwordx4 v[88:91], v240, s[12:15], s42 offen offset:3072 sc1
    buffer_load_dwordx4 v[92:95], v240, s[12:15], s26 offen offset:3072 sc1
    buffer_load_dwordx4 v[96:99], v240, s[12:15], s28 offen offset:0 sc1
    buffer_load_dwordx4 v[100:103], v240, s[12:15], s29 offen offset:0 sc1
    buffer_load_dwordx4 v[104:107], v240, s[12:15], s28 offen offset:1024 sc1
    buffer_load_dwordx4 v[108:111], v240, s[12:15], s29 offen offset:1024 sc1
    buffer_load_dwordx4 v[112:115], v240, s[12:15], s28 offen offset:2048 sc1
    buffer_load_dwordx4 v[116:119], v240, s[12:15], s29 offen offset:2048 sc1
    buffer_load_dwordx4 v[120:123], v240, s[12:15], s28 offen offset:3072 sc1
    buffer_load_dwordx4 v[124:127], v240, s[12:15], s29 offen offset:3072 sc1
P2_AL2:
    s_cmp_lg_u32 s76, 7
    s_cbranch_scc1 P2_AL
    s_waitcnt lgkmcnt(0)
    s_load_dwordx8 s[60:67], s[58:59], s47 offset:0 glc
    s_mov_b32 s27, 0
POL_3:
    s_waitcnt lgkmcnt(0)
    s_xor_b32 s60, s60, s79
    s_xor_b32 s61, s61, s79
    s_xor_b32 s62, s62, s79
    s_xor_b32 s63, s63, s79
    s_xor_b32 s64, s64, s79
    s_xor_b32 s65, s65, s79
    s_xor_b32 s66, s66, s79
    s_xor_b32 s67, s67, s79
    s_or_b64 s[60:61], s[60:61], s[64:65]
    s_or_b64 s[62:63], s[62:63], s[66:67]
    s_or_b64 s[60:61], s[60:61], s[62:63]
    s_or_b32 s60, s60, s61
    s_cbranch_scc0 POK_4
    s_add_u32 s27, s27, 1
    s_cmp_gt_u32 s27, 131072
    s_cbranch_scc1 POK_4
    s_sleep 2
    s_load_dwordx8 s[60:67], s[58:59], s47 offset:0 glc
    s_branch POL_3
POK_4:
    s_lshl_b32 s26, s23, 13
    s_add_u32 s26, s26, 11534336
    s_add_u32 s28, s26, 4096
    buffer_load_dwordx4 v[128:131], v240, s[12:15], s26 offen offset:0 sc1
    buffer_load_dwordx4 v[132:135], v240, s[12:15], s26 offen offset:1024 sc1
    buffer_load_dwordx4 v[136:139], v240, s[12:15], s26 offen offset:2048 sc1
    buffer_load_dwordx4 v[140:143], v240, s[12:15], s26 offen offset:3072 sc1
    buffer_load_dwordx4 v[144:147], v240, s[12:15], s28 offen offset:0 sc1
    buffer_load_dwordx4 v[148:151], v240, s[12:15], s28 offen offset:1024 sc1
    buffer_load_dwordx4 v[152:155], v240, s[12:15], s28 offen offset:2048 sc1
    buffer_load_dwordx4 v[156:159], v240, s[12:15], s28 offen offset:3072 sc1
    s_waitcnt vmcnt(6)
    v_mfma_f32_32x32x16_bf16 v[160:175], v[128:131], v[64:67], 0
    v_mfma_f32_32x32x16_bf16 v[160:175], v[132:135], v[72:75], v[160:175]
    ds_read_b64_tr_b16 v[212:213], v206 offset:0
    ds_read_b64_tr_b16 v[214:215], v206 offset:1024
    ds_read_b64_tr_b16 v[216:217], v207 offset:0
    ds_read_b64_tr_b16 v[218:219], v207 offset:1024
    ds_read_b64_tr_b16 v[228:229], v206 offset:2048
    ds_read_b64_tr_b16 v[230:231], v206 offset:3072
    ds_read_b64_tr_b16 v[232:233], v207 offset:2048
    ds_read_b64_tr_b16 v[234:235], v207 offset:3072
    v_mfma_f32_32x32x16_bf16 v[176:191], v[128:131], v[68:71], 0
    v_mfma_f32_32x32x16_bf16 v[176:191], v[132:135], v[76:79], v[176:191]
    s_nop 3
    v_mov_b32 v220, v172
    v_mov_b32 v221, v172
    s_nop 1
    v_permlane32_swap_b32 v220, v221
    s_nop 0
    v_add_f32 v221, 0x358637bd, v221
    v_rcp_f32 v220, v221
    s_nop 0
    v_mul_f32 v160, v160, v220
    v_mul_f32 v161, v161, v220
    v_mul_f32 v162, v162, v220
    v_mul_f32 v163, v163, v220
    v_mul_f32 v164, v164, v220
    v_mul_f32 v165, v165, v220
    v_mul_f32 v166, v166, v220
    v_mul_f32 v167, v167, v220
    v_mul_f32 v168, v168, v220
    v_mul_f32 v169, v169, v220
    v_mul_f32 v170, v170, v220
    v_mul_f32 v171, v171, v220
    v_mul_f32 v172, v172, v220
    v_mul_f32 v173, v173, v220
    v_mul_f32 v174, v174, v220
    v_mul_f32 v175, v175, v220
    v_cvt_pk_bf16_f32 v248, v160, v161
    v_cvt_pk_bf16_f32 v249, v162, v163
    v_cvt_pk_bf16_f32 v250, v164, v165
    v_cvt_pk_bf16_f32 v251, v166, v167
    v_cvt_pk_bf16_f32 v252, v168, v169
    v_cvt_pk_bf16_f32 v253, v170, v171
    v_cvt_pk_bf16_f32 v254, v172, v173
    v_cvt_pk_bf16_f32 v255, v174, v175
    v_cndmask_b32_e64 v254, v254, 0, s[34:35]
    v_cndmask_b32_e64 v255, v255, 0, s[34:35]
    s_waitcnt lgkmcnt(0)
    s_nop 1
    v_mfma_f32_32x32x16_bf16 v[0:15], v[212:215], v[248:251], 0
    v_mov_b32 v220, v188
    v_mov_b32 v221, v188
    s_nop 1
    v_permlane32_swap_b32 v220, v221
    v_mfma_f32_32x32x16_bf16 v[16:31], v[216:219], v[248:251], 0
    s_nop 0
    v_add_f32 v221, 0x358637bd, v221
    v_rcp_f32 v220, v221
    s_nop 0
    v_mfma_f32_32x32x16_bf16 v[0:15], v[228:231], v[252:255], v[0:15]
    v_mul_f32 v176, v176, v220
    v_mul_f32 v177, v177, v220
    v_mul_f32 v178, v178, v220
    v_mul_f32 v179, v179, v220
    v_mfma_f32_32x32x16_bf16 v[16:31], v[232:235], v[252:255], v[16:31]
    v_mul_f32 v180, v180, v220
    v_mul_f32 v181, v181, v220
    v_mul_f32 v182, v182, v220
    v_mul_f32 v183, v183, v220
    s_waitcnt vmcnt(4)
    v_mfma_f32_32x32x16_bf16 v[160:175], v[136:139], v[80:83], 0
    v_mul_f32 v184, v184, v220
    v_mul_f32 v185, v185, v220
    v_mul_f32 v186, v186, v220
    v_mul_f32 v187, v187, v220
    v_mfma_f32_32x32x16_bf16 v[160:175], v[140:143], v[88:91], v[160:175]
    v_mul_f32 v188, v188, v220
    v_mul_f32 v189, v189, v220
    v_mul_f32 v190, v190, v220
    v_mul_f32 v191, v191, v220
    v_cvt_pk_bf16_f32 v64, v176, v177
    v_cvt_pk_bf16_f32 v65, v178, v179
    v_cvt_pk_bf16_f32 v66, v180, v181
    v_cvt_pk_bf16_f32 v67, v182, v183
    v_cvt_pk_bf16_f32 v68, v184, v185
    v_cvt_pk_bf16_f32 v69, v186, v187
    v_cvt_pk_bf16_f32 v70, v188, v189
    v_cvt_pk_bf16_f32 v71, v190, v191
    v_cndmask_b32_e64 v70, v70, 0, s[34:35]
    v_cndmask_b32_e64 v71, v71, 0, s[34:35]
    s_nop 1
    v_mfma_f32_32x32x16_bf16 v[32:47], v[212:215], v[64:67], 0
    v_mov_b32 v220, v172
    v_mov_b32 v221, v172
    s_nop 1
    v_permlane32_swap_b32 v220, v221
    v_mfma_f32_32x32x16_bf16 v[48:63], v[216:219], v[64:67], 0
    s_nop 0
    v_add_f32 v221, 0x358637bd, v221
    v_rcp_f32 v220, v221
    s_nop 0
    v_mfma_f32_32x32x16_bf16 v[32:47], v[228:231], v[68:71], v[32:47]
    v_mul_f32 v160, v160, v220
    v_mul_f32 v161, v161, v220
    v_mul_f32 v162, v162, v220
    v_mul_f32 v163, v163, v220
    v_mfma_f32_32x32x16_bf16 v[48:63], v[232:235], v[68:71], v[48:63]
    v_mul_f32 v164, v164, v220
    v_mul_f32 v165, v165, v220
    v_mul_f32 v166, v166, v220
    v_mul_f32 v167, v167, v220
    ds_read_b64_tr_b16 v[212:213], v206 offset:4096
    ds_read_b64_tr_b16 v[214:215], v206 offset:5120
    ds_read_b64_tr_b16 v[216:217], v207 offset:4096
    ds_read_b64_tr_b16 v[218:219], v207 offset:5120
    ds_read_b64_tr_b16 v[228:229], v206 offset:6144
    ds_read_b64_tr_b16 v[230:231], v206 offset:7168
    ds_read_b64_tr_b16 v[232:233], v207 offset:6144
    ds_read_b64_tr_b16 v[234:235], v207 offset:7168
    v_mfma_f32_32x32x16_bf16 v[176:191], v[136:139], v[84:87], 0
    v_mul_f32 v168, v168, v220
    v_mul_f32 v169, v169, v220
    v_mul_f32 v170, v170, v220
    v_mul_f32 v171, v171, v220
    v_mfma_f32_32x32x16_bf16 v[176:191], v[140:143], v[92:95], v[176:191]
    v_mul_f32 v172, v172, v220
    v_mul_f32 v173, v173, v220
    v_mul_f32 v174, v174, v220
    v_mul_f32 v175, v175, v220
    v_cvt_pk_bf16_f32 v248, v160, v161
    v_cvt_pk_bf16_f32 v249, v162, v163
    v_cvt_pk_bf16_f32 v250, v164, v165
    v_cvt_pk_bf16_f32 v251, v166, v167
    v_cvt_pk_bf16_f32 v252, v168, v169
    v_cvt_pk_bf16_f32 v253, v170, v171
    v_cvt_pk_bf16_f32 v254, v172, v173
    v_cvt_pk_bf16_f32 v255, v174, v175
    v_cndmask_b32_e64 v254, v254, 0, s[34:35]
    v_cndmask_b32_e64 v255, v255, 0, s[34:35]
    s_waitcnt lgkmcnt(0)
    s_nop 1
    v_mfma_f32_32x32x16_bf16 v[0:15], v[212:215], v[248:251], v[0:15]
    v_mov_b32 v220, v188
    v_mov_b32 v221, v188
    s_nop 1
    v_permlane32_swap_b32 v220, v221
    v_mfma_f32_32x32x16_bf16 v[16:31], v[216:219], v[248:251], v[16:31]
    s_nop 0
    v_add_f32 v221, 0x358637bd, v221
    v_rcp_f32 v220, v221
    s_nop 0
    v_mfma_f32_32x32x16_bf16 v[0:15], v[228:231], v[252:255], v[0:15]
    v_mul_f32 v176, v176, v220
    v_mul_f32 v177, v177, v220
    v_mul_f32 v178, v178, v220
    v_mul_f32 v179, v179, v220
    v_mfma_f32_32x32x16_bf16 v[16:31], v[232:235], v[252:255], v[16:31]
    v_mul_f32 v180, v180, v220
    v_mul_f32 v181, v181, v220
    v_mul_f32 v182, v182, v220
    v_mul_f32 v183, v183, v220
    s_waitcnt vmcnt(2)
    v_mfma_f32_32x32x16_bf16 v[160:175], v[144:147], v[96:99], 0
    v_mul_f32 v184, v184, v220
    v_mul_f32 v185, v185, v220
    v_mul_f32 v186, v186, v220
    v_mul_f32 v187, v187, v220
    v_mfma_f32_32x32x16_bf16 v[160:175], v[148:151], v[104:107], v[160:175]
    v_mul_f32 v188, v188, v220
    v_mul_f32 v189, v189, v220
    v_mul_f32 v190, v190, v220
    v_mul_f32 v191, v191, v220
    v_cvt_pk_bf16_f32 v64, v176, v177
    v_cvt_pk_bf16_f32 v65, v178, v179
    v_cvt_pk_bf16_f32 v66, v180, v181
    v_cvt_pk_bf16_f32 v67, v182, v183
    v_cvt_pk_bf16_f32 v68, v184, v185
    v_cvt_pk_bf16_f32 v69, v186, v187
    v_cvt_pk_bf16_f32 v70, v188, v189
    v_cvt_pk_bf16_f32 v71, v190, v191
    v_cndmask_b32_e64 v70, v70, 0, s[34:35]
    v_cndmask_b32_e64 v71, v71, 0, s[34:35]
    s_nop 1
    v_mfma_f32_32x32x16_bf16 v[32:47], v[212:215], v[64:67], v[32:47]
    v_mov_b32 v220, v172
    v_mov_b32 v221, v172
    s_nop 1
    v_permlane32_swap_b32 v220, v221
    v_mfma_f32_32x32x16_bf16 v[48:63], v[216:219], v[64:67], v[48:63]
    s_nop 0
    v_add_f32 v221, 0x358637bd, v221
    v_rcp_f32 v220, v221
    s_nop 0
    v_mfma_f32_32x32x16_bf16 v[32:47], v[228:231], v[68:71], v[32:47]
    v_mul_f32 v160, v160, v220
    v_mul_f32 v161, v161, v220
    v_mul_f32 v162, v162, v220
    v_mul_f32 v163, v163, v220
    v_mfma_f32_32x32x16_bf16 v[48:63], v[232:235], v[68:71], v[48:63]
    v_mul_f32 v164, v164, v220
    v_mul_f32 v165, v165, v220
    v_mul_f32 v166, v166, v220
    v_mul_f32 v167, v167, v220
    ds_read_b64_tr_b16 v[212:213], v206 offset:8192
    ds_read_b64_tr_b16 v[214:215], v206 offset:9216
    ds_read_b64_tr_b16 v[216:217], v207 offset:8192
    ds_read_b64_tr_b16 v[218:219], v207 offset:9216
    ds_read_b64_tr_b16 v[228:229], v206 offset:10240
    ds_read_b64_tr_b16 v[230:231], v206 offset:11264
    ds_read_b64_tr_b16 v[232:233], v207 offset:10240
    ds_read_b64_tr_b16 v[234:235], v207 offset:11264
    v_mfma_f32_32x32x16_bf16 v[176:191], v[144:147], v[100:103], 0
    v_mul_f32 v168, v168, v220
    v_mul_f32 v169, v169, v220
    v_mul_f32 v170, v170, v220
    v_mul_f32 v171, v171, v220
    v_mfma_f32_32x32x16_bf16 v[176:191], v[148:151], v[108:111], v[176:191]
    v_mul_f32 v172, v172, v220
    v_mul_f32 v173, v173, v220
    v_mul_f32 v174, v174, v220
    v_mul_f32 v175, v175, v220
    v_cvt_pk_bf16_f32 v248, v160, v161
    v_cvt_pk_bf16_f32 v249, v162, v163
    v_cvt_pk_bf16_f32 v250, v164, v165
    v_cvt_pk_bf16_f32 v251, v166, v167
    v_cvt_pk_bf16_f32 v252, v168, v169
    v_cvt_pk_bf16_f32 v253, v170, v171
    v_cvt_pk_bf16_f32 v254, v172, v173
    v_cvt_pk_bf16_f32 v255, v174, v175
    v_cndmask_b32_e64 v254, v254, 0, s[34:35]
    v_cndmask_b32_e64 v255, v255, 0, s[34:35]
    s_waitcnt lgkmcnt(0)
    s_nop 1
    v_mfma_f32_32x32x16_bf16 v[0:15], v[212:215], v[248:251], v[0:15]
    v_mov_b32 v220, v188
    v_mov_b32 v221, v188
    s_nop 1
    v_permlane32_swap_b32 v220, v221
    v_mfma_f32_32x32x16_bf16 v[16:31], v[216:219], v[248:251], v[16:31]
    s_nop 0
    v_add_f32 v221, 0x358637bd, v221
    v_rcp_f32 v220, v221
    s_nop 0
    v_mfma_f32_32x32x16_bf16 v[0:15], v[228:231], v[252:255], v[0:15]
    v_mul_f32 v176, v176, v220
    v_mul_f32 v177, v177, v220
    v_mul_f32 v178, v178, v220
    v_mul_f32 v179, v179, v220
    v_mfma_f32_32x32x16_bf16 v[16:31], v[232:235], v[252:255], v[16:31]
    v_mul_f32 v180, v180, v220
    v_mul_f32 v181, v181, v220
    v_mul_f32 v182, v182, v220
    v_mul_f32 v183, v183, v220
    s_waitcnt vmcnt(0)
    v_mfma_f32_32x32x16_bf16 v[160:175], v[152:155], v[112:115], 0
    v_mul_f32 v184, v184, v220
    v_mul_f32 v185, v185, v220
    v_mul_f32 v186, v186, v220
    v_mul_f32 v187, v187, v220
    v_mfma_f32_32x32x16_bf16 v[160:175], v[156:159], v[120:123], v[160:175]
    v_mul_f32 v188, v188, v220
    v_mul_f32 v189, v189, v220
    v_mul_f32 v190, v190, v220
    v_mul_f32 v191, v191, v220
    v_cvt_pk_bf16_f32 v64, v176, v177
    v_cvt_pk_bf16_f32 v65, v178, v179
    v_cvt_pk_bf16_f32 v66, v180, v181
    v_cvt_pk_bf16_f32 v67, v182, v183
    v_cvt_pk_bf16_f32 v68, v184, v185
    v_cvt_pk_bf16_f32 v69, v186, v187
    v_cvt_pk_bf16_f32 v70, v188, v189
    v_cvt_pk_bf16_f32 v71, v190, v191
    v_cndmask_b32_e64 v70, v70, 0, s[34:35]
    v_cndmask_b32_e64 v71, v71, 0, s[34:35]
    s_nop 1
    v_mfma_f32_32x32x16_bf16 v[32:47], v[212:215], v[64:67], v[32:47]
    v_mov_b32 v220, v172
    v_mov_b32 v221, v172
    s_nop 1
    v_permlane32_swap_b32 v220, v221
    v_mfma_f32_32x32x16_bf16 v[48:63], v[216:219], v[64:67], v[48:63]
    s_nop 0
    v_add_f32 v221, 0x358637bd, v221
    v_rcp_f32 v220, v221
    s_nop 0
    v_mfma_f32_32x32x16_bf16 v[32:47], v[228:231], v[68:71], v[32:47]
    v_mul_f32 v160, v160, v220
    v_mul_f32 v161, v161, v220
    v_mul_f32 v162, v162, v220
    v_mul_f32 v163, v163, v220
    v_mfma_f32_32x32x16_bf16 v[48:63], v[232:235], v[68:71], v[48:63]
    v_mul_f32 v164, v164, v220
    v_mul_f32 v165, v165, v220
    v_mul_f32 v166, v166, v220
    v_mul_f32 v167, v167, v220
    ds_read_b64_tr_b16 v[212:213], v206 offset:12288
    ds_read_b64_tr_b16 v[214:215], v206 offset:13312
    ds_read_b64_tr_b16 v[216:217], v207 offset:12288
    ds_read_b64_tr_b16 v[218:219], v207 offset:13312
    ds_read_b64_tr_b16 v[228:229], v206 offset:14336
    ds_read_b64_tr_b16 v[230:231], v206 offset:15360
    ds_read_b64_tr_b16 v[232:233], v207 offset:14336
    ds_read_b64_tr_b16 v[234:235], v207 offset:15360
    v_mfma_f32_32x32x16_bf16 v[176:191], v[152:155], v[116:119], 0
    v_mul_f32 v168, v168, v220
    v_mul_f32 v169, v169, v220
    v_mul_f32 v170, v170, v220
    v_mul_f32 v171, v171, v220
    v_mfma_f32_32x32x16_bf16 v[176:191], v[156:159], v[124:127], v[176:191]
    v_mul_f32 v172, v172, v220
    v_mul_f32 v173, v173, v220
    v_mul_f32 v174, v174, v220
    v_mul_f32 v175, v175, v220
    v_cvt_pk_bf16_f32 v248, v160, v161
    v_cvt_pk_bf16_f32 v249, v162, v163
    v_cvt_pk_bf16_f32 v250, v164, v165
    v_cvt_pk_bf16_f32 v251, v166, v167
    v_cvt_pk_bf16_f32 v252, v168, v169
    v_cvt_pk_bf16_f32 v253, v170, v171
    v_cvt_pk_bf16_f32 v254, v172, v173
    v_cvt_pk_bf16_f32 v255, v174, v175
    v_cndmask_b32_e64 v254, v254, 0, s[34:35]
    v_cndmask_b32_e64 v255, v255, 0, s[34:35]
    s_waitcnt lgkmcnt(0)
    s_nop 1
    v_mfma_f32_32x32x16_bf16 v[0:15], v[212:215], v[248:251], v[0:15]
    v_mov_b32 v220, v188
    v_mov_b32 v221, v188
    s_nop 1
    v_permlane32_swap_b32 v220, v221
    v_mfma_f32_32x32x16_bf16 v[16:31], v[216:219], v[248:251], v[16:31]
    s_nop 0
    v_add_f32 v221, 0x358637bd, v221
    v_rcp_f32 v220, v221
    s_nop 0
    v_mfma_f32_32x32x16_bf16 v[0:15], v[228:231], v[252:255], v[0:15]
    v_mul_f32 v176, v176, v220
    v_mul_f32 v177, v177, v220
    v_mul_f32 v178, v178, v220
    v_mul_f32 v179, v179, v220
    v_mfma_f32_32x32x16_bf16 v[16:31], v[232:235], v[252:255], v[16:31]
    v_mul_f32 v180, v180, v220
    v_mul_f32 v181, v181, v220
    v_mul_f32 v182, v182, v220
    v_mul_f32 v183, v183, v220
    v_mul_f32 v184, v184, v220
    v_mul_f32 v185, v185, v220
    v_mul_f32 v186, v186, v220
    v_mul_f32 v187, v187, v220
    v_mul_f32 v188, v188, v220
    v_mul_f32 v189, v189, v220
    v_mul_f32 v190, v190, v220
    v_mul_f32 v191, v191, v220
    v_cvt_pk_bf16_f32 v64, v176, v177
    v_cvt_pk_bf16_f32 v65, v178, v179
    v_cvt_pk_bf16_f32 v66, v180, v181
    v_cvt_pk_bf16_f32 v67, v182, v183
    v_cvt_pk_bf16_f32 v68, v184, v185
    v_cvt_pk_bf16_f32 v69, v186, v187
    v_cvt_pk_bf16_f32 v70, v188, v189
    v_cvt_pk_bf16_f32 v71, v190, v191
    v_cndmask_b32_e64 v70, v70, 0, s[34:35]
    v_cndmask_b32_e64 v71, v71, 0, s[34:35]
    s_nop 1
    v_mfma_f32_32x32x16_bf16 v[32:47], v[212:215], v[64:67], v[32:47]
    v_mfma_f32_32x32x16_bf16 v[48:63], v[216:219], v[64:67], v[48:63]
    v_mfma_f32_32x32x16_bf16 v[32:47], v[228:231], v[68:71], v[32:47]
    v_mfma_f32_32x32x16_bf16 v[48:63], v[232:235], v[68:71], v[48:63]
P2_ATT_SKIP:
    s_nop 9
    v_xor_b32 v237, 0, v205
    ds_write_b128 v237, v[0:3] offset:0
    ds_write_b128 v237, v[32:35] offset:8192
    v_xor_b32 v238, 32, v205
    ds_write_b128 v238, v[4:7] offset:0
    ds_write_b128 v238, v[36:39] offset:8192
    v_xor_b32 v237, 64, v205
    ds_write_b128 v237, v[8:11] offset:0
    ds_write_b128 v237, v[40:43] offset:8192
    v_xor_b32 v238, 96, v205
    ds_write_b128 v238, v[12:15] offset:0
    ds_write_b128 v238, v[44:47] offset:8192
    v_xor_b32 v237, 128, v205
    ds_write_b128 v237, v[16:19] offset:0
    ds_write_b128 v237, v[48:51] offset:8192
    v_xor_b32 v238, 160, v205
    ds_write_b128 v238, v[20:23] offset:0
    ds_write_b128 v238, v[52:55] offset:8192
    v_xor_b32 v237, 192, v205
    ds_write_b128 v237, v[24:27] offset:0
    ds_write_b128 v237, v[56:59] offset:8192
    v_xor_b32 v238, 224, v205
    ds_write_b128 v238, v[28:31] offset:0
    ds_write_b128 v238, v[60:63] offset:8192
    v_add_u32 v237, 8192, v197
    v_xor_b32 v238, 16, v237
    v_xor_b32 v232, 16, v197
    v_add_u32 v233, 81920, v197
    v_add_u32 v234, 81920, v232
    s_mov_b32 s16, s54
    s_mov_b32 s17, s55
    s_mov_b32 s18, 1835008
    s_mov_b32 s19, 0x20000
    v_mov_b32 v235, 161328
    v_mov_b32 v236, 1
    s_waitcnt lgkmcnt(0)
    s_mov_b64 exec, 1
    ds_add_u32 v235, v236
    s_mov_b64 exec, -1
    s_mov_b32 s27, 0
ACL_5:
    ds_read_b32 v236, v235
    s_waitcnt lgkmcnt(0)
    v_readfirstlane_b32 s26, v236
    s_nop 0
    s_cmp_ge_u32 s26, 4
    s_cbranch_scc1 ACK_6
    s_add_u32 s27, s27, 1
    s_cmp_gt_u32 s27, 2097152
    s_cbranch_scc1 ACK_6
    s_sleep 1
    s_branch ACL_5
ACK_6:
    ds_read_b128 v[64:67], v233 offset:0
    ds_read_b128 v[68:71], v234 offset:0
    ds_read_b128 v[72:75], v233 offset:16384
    ds_read_b128 v[76:79], v234 offset:16384
    ds_read_b128 v[80:83], v233 offset:32768
    ds_read_b128 v[84:87], v234 offset:32768
    ds_read_b128 v[88:91], v233 offset:49152
    ds_read_b128 v[92:95], v234 offset:49152
    ds_read_b128 v[96:99], v233 offset:8192
    ds_read_b128 v[100:103], v234 offset:8192
    ds_read_b128 v[104:107], v233 offset:24576
    ds_read_b128 v[108:111], v234 offset:24576
    ds_read_b128 v[112:115], v233 offset:40960
    ds_read_b128 v[116:119], v234 offset:40960
    ds_read_b128 v[120:123], v233 offset:57344
    ds_read_b128 v[124:127], v234 offset:57344
    s_waitcnt vmcnt(0)
    v_lshlrev_b32 v128, 16, v192
    v_and_b32 v129, 0xffff0000, v192
    v_lshlrev_b32 v130, 16, v193
    v_and_b32 v131, 0xffff0000, v193
    v_lshlrev_b32 v132, 16, v194
    v_and_b32 v133, 0xffff0000, v194
    v_lshlrev_b32 v134, 16, v195
    v_and_b32 v135, 0xffff0000, v195
    v_lshlrev_b32 v136, 16, v200
    v_and_b32 v137, 0xffff0000, v200
    v_lshlrev_b32 v138, 16, v201
    v_and_b32 v139, 0xffff0000, v201
    v_lshlrev_b32 v140, 16, v202
    v_and_b32 v141, 0xffff0000, v202
    v_lshlrev_b32 v142, 16, v203
    v_and_b32 v143, 0xffff0000, v203
    s_waitcnt lgkmcnt(0)
    v_pk_add_f32 v[64:65], v[64:65], v[72:73]
    v_pk_add_f32 v[66:67], v[66:67], v[74:75]
    v_pk_add_f32 v[68:69], v[68:69], v[76:77]
    v_pk_add_f32 v[70:71], v[70:71], v[78:79]
    v_pk_add_f32 v[80:81], v[80:81], v[88:89]
    v_pk_add_f32 v[82:83], v[82:83], v[90:91]
    v_pk_add_f32 v[84:85], v[84:85], v[92:93]
    v_pk_add_f32 v[86:87], v[86:87], v[94:95]
    v_pk_add_f32 v[64:65], v[64:65], v[80:81]
    v_pk_add_f32 v[66:67], v[66:67], v[82:83]
    v_pk_add_f32 v[68:69], v[68:69], v[84:85]
    v_pk_add_f32 v[70:71], v[70:71], v[86:87]
    v_pk_mul_f32 v[64:65], v[64:65], s[36:37] op_sel:[0,1] op_sel_hi:[1,1]
    v_pk_mul_f32 v[66:67], v[66:67], s[36:37] op_sel:[0,1] op_sel_hi:[1,1]
    v_pk_mul_f32 v[68:69], v[68:69], s[36:37] op_sel:[0,1] op_sel_hi:[1,1]
    v_pk_mul_f32 v[70:71], v[70:71], s[36:37] op_sel:[0,1] op_sel_hi:[1,1]
    v_pk_add_f32 v[96:97], v[96:97], v[104:105]
    v_pk_add_f32 v[98:99], v[98:99], v[106:107]
    v_pk_add_f32 v[100:101], v[100:101], v[108:109]
    v_pk_add_f32 v[102:103], v[102:103], v[110:111]
    v_pk_add_f32 v[112:113], v[112:113], v[120:121]
    v_pk_add_f32 v[114:115], v[114:115], v[122:123]
    v_pk_add_f32 v[116:117], v[116:117], v[124:125]
    v_pk_add_f32 v[118:119], v[118:119], v[126:127]
    v_pk_add_f32 v[96:97], v[96:97], v[112:113]
    v_pk_add_f32 v[98:99], v[98:99], v[114:115]
    v_pk_add_f32 v[100:101], v[100:101], v[116:117]
    v_pk_add_f32 v[102:103], v[102:103], v[118:119]
    v_pk_mul_f32 v[96:97], v[96:97], s[36:37] op_sel:[0,1] op_sel_hi:[1,1]
    v_pk_mul_f32 v[98:99], v[98:99], s[36:37] op_sel:[0,1] op_sel_hi:[1,1]
    v_pk_mul_f32 v[100:101], v[100:101], s[36:37] op_sel:[0,1] op_sel_hi:[1,1]
    v_pk_mul_f32 v[102:103], v[102:103], s[36:37] op_sel:[0,1] op_sel_hi:[1,1]
    s_add_u32 s28, s50, 28672
    s_setprio 0
    s_barrier
    ds_read_b128 v[0:3], v197 offset:0
    ds_read_b128 v[4:7], v232 offset:0
    ds_read_b128 v[8:11], v197 offset:20480
    ds_read_b128 v[12:15], v232 offset:20480
    ds_read_b128 v[16:19], v197 offset:40960
    ds_read_b128 v[20:23], v232 offset:40960
    ds_read_b128 v[24:27], v197 offset:61440
    ds_read_b128 v[28:31], v232 offset:61440
    ds_read_b128 v[32:35], v197 offset:8192
    ds_read_b128 v[36:39], v232 offset:8192
    ds_read_b128 v[40:43], v197 offset:28672
    ds_read_b128 v[44:47], v232 offset:28672
    ds_read_b128 v[48:51], v197 offset:49152
    ds_read_b128 v[52:55], v232 offset:49152
    ds_read_b128 v[56:59], v237 offset:61440
    ds_read_b128 v[60:63], v238 offset:61440
    s_waitcnt lgkmcnt(8)
    v_pk_add_f32 v[0:1], v[0:1], v[8:9]
    v_pk_add_f32 v[2:3], v[2:3], v[10:11]
    v_pk_add_f32 v[4:5], v[4:5], v[12:13]
    v_pk_add_f32 v[6:7], v[6:7], v[14:15]
    v_pk_add_f32 v[16:17], v[16:17], v[24:25]
    v_pk_add_f32 v[18:19], v[18:19], v[26:27]
    v_pk_add_f32 v[20:21], v[20:21], v[28:29]
    v_pk_add_f32 v[22:23], v[22:23], v[30:31]
    v_pk_add_f32 v[0:1], v[0:1], v[16:17]
    v_pk_add_f32 v[2:3], v[2:3], v[18:19]
    v_pk_add_f32 v[4:5], v[4:5], v[20:21]
    v_pk_add_f32 v[6:7], v[6:7], v[22:23]
    v_exp_f32_e64 v8, -v0
    v_exp_f32_e64 v9, -v1
    v_exp_f32_e64 v10, -v2
    v_exp_f32_e64 v11, -v3
    v_exp_f32_e64 v12, -v4
    v_exp_f32_e64 v13, -v5
    v_exp_f32_e64 v14, -v6
    v_exp_f32_e64 v15, -v7
    v_pk_mul_f32 v[0:1], v[0:1], v[64:65]
    v_pk_mul_f32 v[2:3], v[2:3], v[66:67]
    v_pk_mul_f32 v[4:5], v[4:5], v[68:69]
    v_pk_mul_f32 v[6:7], v[6:7], v[70:71]
    v_pk_add_f32 v[8:9], v[8:9], 1.0 op_sel_hi:[1,0]
    v_pk_add_f32 v[10:11], v[10:11], 1.0 op_sel_hi:[1,0]
    v_pk_add_f32 v[12:13], v[12:13], 1.0 op_sel_hi:[1,0]
    v_pk_add_f32 v[14:15], v[14:15], 1.0 op_sel_hi:[1,0]
    v_rcp_f32 v8, v8
    v_rcp_f32 v9, v9
    v_rcp_f32 v10, v10
    v_rcp_f32 v11, v11
    v_rcp_f32 v12, v12
    v_rcp_f32 v13, v13
    v_rcp_f32 v14, v14
    v_rcp_f32 v15, v15
    s_nop 0
    v_pk_fma_f32 v[128:129], v[0:1], v[8:9], v[128:129]
    v_pk_fma_f32 v[130:131], v[2:3], v[10:11], v[130:131]
    v_pk_fma_f32 v[132:133], v[4:5], v[12:13], v[132:133]
    v_pk_fma_f32 v[134:135], v[6:7], v[14:15], v[134:135]
    v_cvt_pk_bf16_f32 v24, v128, v129
    v_cvt_pk_bf16_f32 v25, v130, v131
    v_cvt_pk_bf16_f32 v26, v132, v133
    v_cvt_pk_bf16_f32 v27, v134, v135
    buffer_store_dwordx4 v[24:27], v210, s[16:19], s50 offen sc1
    s_waitcnt lgkmcnt(0)
    v_pk_add_f32 v[32:33], v[32:33], v[40:41]
    v_pk_add_f32 v[34:35], v[34:35], v[42:43]
    v_pk_add_f32 v[36:37], v[36:37], v[44:45]
    v_pk_add_f32 v[38:39], v[38:39], v[46:47]
    v_pk_add_f32 v[48:49], v[48:49], v[56:57]
    v_pk_add_f32 v[50:51], v[50:51], v[58:59]
    v_pk_add_f32 v[52:53], v[52:53], v[60:61]
    v_pk_add_f32 v[54:55], v[54:55], v[62:63]
    v_pk_add_f32 v[32:33], v[32:33], v[48:49]
    v_pk_add_f32 v[34:35], v[34:35], v[50:51]
    v_pk_add_f32 v[36:37], v[36:37], v[52:53]
    v_pk_add_f32 v[38:39], v[38:39], v[54:55]
    v_exp_f32_e64 v40, -v32
    v_exp_f32_e64 v41, -v33
    v_exp_f32_e64 v42, -v34
    v_exp_f32_e64 v43, -v35
    v_exp_f32_e64 v44, -v36
    v_exp_f32_e64 v45, -v37
    v_exp_f32_e64 v46, -v38
    v_exp_f32_e64 v47, -v39
    v_pk_mul_f32 v[32:33], v[32:33], v[96:97]
    v_pk_mul_f32 v[34:35], v[34:35], v[98:99]
    v_pk_mul_f32 v[36:37], v[36:37], v[100:101]
    v_pk_mul_f32 v[38:39], v[38:39], v[102:103]
    v_pk_add_f32 v[40:41], v[40:41], 1.0 op_sel_hi:[1,0]
    v_pk_add_f32 v[42:43], v[42:43], 1.0 op_sel_hi:[1,0]
    v_pk_add_f32 v[44:45], v[44:45], 1.0 op_sel_hi:[1,0]
    v_pk_add_f32 v[46:47], v[46:47], 1.0 op_sel_hi:[1,0]
    v_rcp_f32 v40, v40
    v_rcp_f32 v41, v41
    v_rcp_f32 v42, v42
    v_rcp_f32 v43, v43
    v_rcp_f32 v44, v44
    v_rcp_f32 v45, v45
    v_rcp_f32 v46, v46
    v_rcp_f32 v47, v47
    s_nop 0
    v_pk_fma_f32 v[136:137], v[32:33], v[40:41], v[136:137]
    v_pk_fma_f32 v[138:139], v[34:35], v[42:43], v[138:139]
    v_pk_fma_f32 v[140:141], v[36:37], v[44:45], v[140:141]
    v_pk_fma_f32 v[142:143], v[38:39], v[46:47], v[142:143]
    v_cvt_pk_bf16_f32 v56, v136, v137
    v_cvt_pk_bf16_f32 v57, v138, v139
    v_cvt_pk_bf16_f32 v58, v140, v141
    v_cvt_pk_bf16_f32 v59, v142, v143
    buffer_store_dwordx4 v[56:59], v210, s[16:19], s28 offen sc1
    s_endpgm
K1_A:
    s_or_b32 s26, s2, s22
    s_cbranch_scc1 K1_NONONCE
    s_memrealtime s[28:29]
    v_mov_b32 v247, 0
    s_waitcnt lgkmcnt(0)
    s_or_b32 s28, s28, 1
    v_mov_b32 v246, s28
    global_store_dword v247, v246, s[56:57] sc1
K1_NONONCE:
    s_waitcnt lgkmcnt(0)
    v_lshlrev_b32 v240, 4, v241
    v_and_b32 v243, 31, v241
    s_mov_b32 s34, 0
    s_mov_b32 s35, -1
    s_mov_b32 s36, 0x3f3504f3
    s_mov_b32 s37, 0x3f317218
    s_mov_b32 s38, 0x35c1a2a0
    v_bfe_u32 v224, v241, 4, 1
    v_and_b32 v225, 15, v241
    v_cmp_eq_u32 vcc, v224, v225
    v_mov_b32 v224, 0x3f803f80
    v_mov_b32 v247, 0
    v_cndmask_b32 v216, 0, v224, vcc
    v_mov_b32 v217, v216
    v_mov_b32 v218, v216
    v_mov_b32 v219, v216
    v_mov_b32 v220, 0
    v_mov_b32 v212, 0
    v_mov_b32 v221, 0
    v_mov_b32 v213, 0
    v_mov_b32 v222, 0
    v_mov_b32 v214, 0
    v_mov_b32 v223, 0
    v_mov_b32 v215, 0
    v_mov_b32 v245, s38
    s_lshl_b32 s87, s20, 2
    s_add_u32 s87, s87, s23
    s_mov_b32 s12, s58
    s_mov_b32 s13, s59
    s_mov_b32 s14, 268435456
    s_mov_b32 s15, 0x20000
    s_mov_b32 s16, s50
    s_mov_b32 s17, s51
    s_mov_b32 s18, 3584
    s_mov_b32 s19, 0x20000
    s_lshr_b32 s26, s2, 3
    s_lshl_b32 s26, s26, 2
    s_add_u32 s26, s26, s23
    s_lshl_b32 s26, s26, 10
    s_cmp_ge_u32 s26, K_CODE_END - recurrent_scan__linear_attn_block__dense_activation_mish__prompt_kernel
    s_cbranch_scc1 NOCP_7
    s_min_u32 s26, s26, K_CODE_END - recurrent_scan__linear_attn_block__dense_activation_mish__prompt_kernel - 1024
    s_getpc_b64 s[28:29]
.Lpc_8:
    s_sub_u32 s28, s28, .Lpc_8 - recurrent_scan__linear_attn_block__dense_activation_mish__prompt_kernel
    s_subb_u32 s29, s29, 0
    v_add_u32 v224, s26, v240
    global_load_dwordx4 v[160:163], v224, s[28:29]
NOCP_7:
    s_cmp_lt_u32 s21, 8
    s_cbranch_scc1 K1_A_H
    v_bfe_u32 v224, v241, 4, 1
    v_lshlrev_b32 v224, 5, v224
    v_and_b32 v227, 3, v241
    v_lshl_add_u32 v224, v227, 3, v224
    v_bfe_u32 v225, v241, 2, 2
    v_lshrrev_b32 v226, 5, v241
    v_lshl_add_u32 v226, v226, 3, v225
    v_lshlrev_b32 v226, 8, v226
    s_lshl_b32 s26, s23, 5
    v_add_u32 v227, s26, v243
    v_bfe_u32 v228, v227, 1, 3
    v_lshrrev_b32 v229, 5, v241
    v_xor_b32 v228, v228, v229
    v_lshlrev_b32 v228, 4, v228
    v_lshl_add_u32 v136, v227, 7, v228
    v_xor_b32 v137, 32, v136
    v_xor_b32 v138, 64, v136
    v_xor_b32 v139, 96, v136
    s_and_b32 s27, s23, 1
    s_mov_b32 s28, s27
    s_mul_i32 s28, s28, 56
    v_add_u32 v227, s28, v224
    v_lshrrev_b32 v228, 6, v227
    v_xor_b32 v228, v228, v225
    v_lshlrev_b32 v228, 6, v228
    v_and_b32 v227, 63, v227
    v_add3_u32 v140, v228, v227, v226
    s_xor_b32 s28, s27, 1
    s_mul_i32 s28, s28, 56
    v_add_u32 v227, s28, v224
    v_lshrrev_b32 v228, 6, v227
    v_xor_b32 v228, v228, v225
    v_lshlrev_b32 v228, 6, v228
    v_and_b32 v227, 63, v227
    v_add3_u32 v141, v228, v227, v226
    s_mov_b32 s28, s27
    s_mul_i32 s28, s28, 56
    s_add_u32 s28, s28, 128
    v_add_u32 v227, s28, v224
    v_lshrrev_b32 v228, 6, v227
    v_xor_b32 v228, v228, v225
    v_lshlrev_b32 v228, 6, v228
    v_and_b32 v227, 63, v227
    v_add3_u32 v142, v228, v227, v226
    s_xor_b32 s28, s27, 1
    s_mul_i32 s28, s28, 56
    s_add_u32 s28, s28, 128
    v_add_u32 v227, s28, v224
    v_lshrrev_b32 v228, 6, v227
    v_xor_b32 v228, v228, v225
    v_lshlrev_b32 v228, 6, v228
    v_and_b32 v227, 63, v227
    v_add3_u32 v143, v228, v227, v226
    s_mov_b32 s80, s27
    s_xor_b32 s81, s27, 1
    s_sub_u32 s82, s21, 8
    s_lshl_b32 s83, s82, 1
    s_mov_b32 s60, 0xf0000000
    s_mov_b32 s61, 0xf0000000
    s_mov_b32 s62, 0x10000000
    s_mov_b32 s63, 0x10000000
    s_mov_b32 s51, 0
    v_add_u32 v144, 65536, v136
    v_add_u32 v192, 65536, v140
    v_add_u32 v145, 65536, v137
    v_add_u32 v193, 65536, v141
    v_add_u32 v146, 65536, v138
    v_add_u32 v194, 65536, v142
    v_add_u32 v147, 65536, v139
    v_add_u32 v195, 65536, v143
    v_add_u32 v148, 131072, v136
    v_add_u32 v184, 131072, v140
    v_add_u32 v149, 131072, v137
    v_add_u32 v185, 131072, v141
    v_add_u32 v150, 131072, v138
    v_add_u32 v186, 131072, v142
    v_add_u32 v151, 131072, v139
    v_add_u32 v187, 131072, v143
    s_lshl_b32 s74, s80, 7
    s_add_u32 s74, s74, 155648
    s_add_u32 s28, s80, 0
    s_lshl_b32 s26, s28, 7
    s_add_u32 s26, s26, 155648
    v_lshl_add_u32 v188, v243, 2, s26
    s_add_u32 s28, s81, 0
    s_lshl_b32 s26, s28, 7
    s_add_u32 s26, s26, 155648
    v_lshl_add_u32 v189, v243, 2, s26
    s_add_u32 s28, s80, 2
    s_lshl_b32 s26, s28, 7
    s_add_u32 s26, s26, 155648
    v_lshl_add_u32 v190, v243, 2, s26
    s_add_u32 s28, s81, 2
    s_lshl_b32 s26, s28, 7
    s_add_u32 s26, s26, 155648
    v_lshl_add_u32 v191, v243, 2, s26
    v_and_b32 v230, 15, v241
    v_lshrrev_b32 v231, 4, v241
    v_lshlrev_b32 v230, 6, v230
    v_lshl_add_u32 v230, v231, 4, v230
    v_add_u32 v157, s74, v230
    s_lshl_b32 s26, s87, 9
    s_add_u32 s26, s26, 11698176
    v_lshl_add_u32 v156, v243, 4, s26
    v_mov_b32 v155, 0
    s_cmp_lg_u32 s22, 0
    s_cbranch_scc1 TKD_9
    s_mov_b32 s26, s2
    v_mov_b32 v225, s26
    v_mov_b32 v224, 161280
    ds_write_b32 v224, v247
    ds_write_b32 v224, v225 offset:16
    s_waitcnt lgkmcnt(0)
TKD_9:
    s_mul_i32 s46, s23, 20480
    v_lshrrev_b32 v224, 3, v241
    v_mul_u32_u24 v225, 896, v224
    v_bfe_u32 v226, v241, 4, 1
    v_lshlrev_b32 v226, 2, v226
    v_and_b32 v227, 7, v241
    v_xor_b32 v226, v226, v227
    v_lshl_add_u32 v204, v226, 4, v225
    v_lshl_add_u32 v210, v227, 4, v225
    v_lshlrev_b32 v227, 1, v227
    v_xor_b32 v227, v227, v224
    v_lshlrev_b32 v227, 4, v227
    v_lshl_add_u32 v197, v224, 8, v227
    s_lshl_b32 s26, s23, 11
    v_add_u32 v197, s26, v197
    v_bfe_u32 v224, v241, 2, 2
    v_lshrrev_b32 v225, 5, v241
    v_lshl_add_u32 v225, v225, 2, v224
    v_lshlrev_b32 v225, 7, v225
    v_bfe_u32 v226, v241, 4, 1
    v_lshl_add_u32 v225, v226, 5, v225
    v_and_b32 v226, 3, v241
    v_lshl_add_u32 v225, v226, 3, v225
    v_add_u32 v225, s46, v225
    v_bfe_u32 v226, v241, 3, 1
    v_lshl_add_u32 v206, v226, 6, v225
    v_xor_b32 v207, 64, v206
    v_lshrrev_b32 v224, 5, v241
    v_and_b32 v225, 7, v241
    v_xor_b32 v224, v224, v225
    v_lshlrev_b32 v224, 4, v224
    v_lshl_add_u32 v224, v243, 8, v224
    v_add_u32 v205, s46, v224
    s_mov_b32 s8, s52
    s_mov_b32 s9, s53
    s_mov_b32 s10, 1605632
    s_mov_b32 s11, 0x20000
    s_mov_b32 s4, s40
    s_mov_b32 s5, s41
    s_mov_b32 s6, 1835008
    s_mov_b32 s7, 0x20000
    v_mov_b32 v158, 161296
    s_barrier
    ds_read_b32 v159, v158
    ds_read_b128 v[96:99], v136 offset:0
    ds_read_b64_tr_b16 v[100:101], v140 offset:16384
    ds_read_b64_tr_b16 v[102:103], v140 offset:17408
    ds_read_b64_tr_b16 v[104:105], v141 offset:16384
    ds_read_b64_tr_b16 v[106:107], v141 offset:17408
    ds_read_b64_tr_b16 v[108:109], v142 offset:16384
    ds_read_b64_tr_b16 v[110:111], v142 offset:17408
    ds_read_b64_tr_b16 v[112:113], v143 offset:16384
    ds_read_b64_tr_b16 v[114:115], v143 offset:17408
    s_waitcnt lgkmcnt(6)
    v_mfma_f32_32x32x16_bf16 v[32:47], v[96:99], v[100:103], 0
    v_mfma_f32_16x16x32_bf16 v[220:223], v[100:103], v[216:219], v[220:223]
    ds_read_b128 v[116:119], v137 offset:0
    ds_read_b64_tr_b16 v[120:121], v140 offset:20480
    ds_read_b64_tr_b16 v[122:123], v140 offset:21504
    s_waitcnt lgkmcnt(7)
    v_mfma_f32_32x32x16_bf16 v[48:63], v[96:99], v[104:107], 0
    ds_read_b64_tr_b16 v[124:125], v141 offset:20480
    ds_read_b64_tr_b16 v[126:127], v141 offset:21504
    v_readfirstlane_b32 s0, v159
    s_nop 0
    s_waitcnt lgkmcnt(7)
    v_mfma_f32_32x32x16_bf16 v[64:79], v[96:99], v[108:111], 0
    v_mfma_f32_16x16x32_bf16 v[212:215], v[108:111], v[216:219], v[212:215]
    ds_read_b64_tr_b16 v[128:129], v142 offset:20480
    ds_read_b64_tr_b16 v[130:131], v142 offset:21504
    s_lshr_b32 s27, s0, 3
    s_mul_i32 s28, s27, 37
    s_waitcnt lgkmcnt(7)
    v_mfma_f32_32x32x16_bf16 v[80:95], v[96:99], v[112:115], 0
    ds_read_b64_tr_b16 v[132:133], v143 offset:20480
    ds_read_b64_tr_b16 v[134:135], v143 offset:21504
    s_lshr_b32 s28, s28, 8
    s_mul_i32 s26, s28, 7
    s_waitcnt lgkmcnt(6)
    v_mfma_f32_32x32x16_bf16 v[32:47], v[116:119], v[120:123], v[32:47]
    v_mfma_f32_16x16x32_bf16 v[220:223], v[120:123], v[216:219], v[220:223]
    ds_read_b128 v[96:99], v138 offset:0
    ds_read_b64_tr_b16 v[100:101], v140 offset:24576
    ds_read_b64_tr_b16 v[102:103], v140 offset:25600
    s_waitcnt lgkmcnt(7)
    v_mfma_f32_32x32x16_bf16 v[48:63], v[116:119], v[124:127], v[48:63]
    ds_read_b64_tr_b16 v[104:105], v141 offset:24576
    ds_read_b64_tr_b16 v[106:107], v141 offset:25600
    s_sub_u32 s25, s27, s26
    s_and_b32 s26, s0, 7
    s_waitcnt lgkmcnt(7)
    v_mfma_f32_32x32x16_bf16 v[64:79], v[116:119], v[128:131], v[64:79]
    v_mfma_f32_16x16x32_bf16 v[212:215], v[128:131], v[216:219], v[212:215]
    ds_read_b64_tr_b16 v[108:109], v142 offset:24576
    ds_read_b64_tr_b16 v[110:111], v142 offset:25600
    s_lshl_b32 s24, s26, 2
    s_add_u32 s24, s24, s28
    s_waitcnt lgkmcnt(7)
    v_mfma_f32_32x32x16_bf16 v[80:95], v[116:119], v[132:135], v[80:95]
    ds_read_b64_tr_b16 v[112:113], v143 offset:24576
    ds_read_b64_tr_b16 v[114:115], v143 offset:25600
    s_lshl_b32 s26, s24, 3
    s_add_u32 s26, s26, s23
    s_waitcnt lgkmcnt(6)
    v_mfma_f32_32x32x16_bf16 v[32:47], v[96:99], v[100:103], v[32:47]
    v_mfma_f32_16x16x32_bf16 v[220:223], v[100:103], v[216:219], v[220:223]
    ds_read_b128 v[116:119], v139 offset:0
    ds_read_b64_tr_b16 v[120:121], v140 offset:28672
    ds_read_b64_tr_b16 v[122:123], v140 offset:29696
    s_waitcnt lgkmcnt(7)
    v_mfma_f32_32x32x16_bf16 v[48:63], v[96:99], v[104:107], v[48:63]
    ds_read_b64_tr_b16 v[124:125], v141 offset:28672
    ds_read_b64_tr_b16 v[126:127], v141 offset:29696
    s_mul_i32 s50, s26, 7168
    s_lshl_b32 s43, s25, 7
    s_waitcnt lgkmcnt(7)
    v_mfma_f32_32x32x16_bf16 v[64:79], v[96:99], v[108:111], v[64:79]
    v_mfma_f32_16x16x32_bf16 v[212:215], v[108:111], v[216:219], v[212:215]
    ds_read_b64_tr_b16 v[128:129], v142 offset:28672
    ds_read_b64_tr_b16 v[130:131], v142 offset:29696
    s_add_u32 s50, s50, s43
    s_lshl_b32 s49, s24, 2
    s_waitcnt lgkmcnt(7)
    v_mfma_f32_32x32x16_bf16 v[80:95], v[96:99], v[112:115], v[80:95]
    ds_read_b64_tr_b16 v[132:133], v143 offset:28672
    ds_read_b64_tr_b16 v[134:135], v143 offset:29696
    s_add_u32 s49, s49, s23
    s_lshl_b32 s49, s49, 3
    s_waitcnt lgkmcnt(6)
    v_mfma_f32_32x32x16_bf16 v[32:47], v[116:119], v[120:123], v[32:47]
    v_mfma_f32_16x16x32_bf16 v[220:223], v[120:123], v[216:219], v[220:223]
    s_barrier
    ds_read_b128 v[96:99], v136 offset:32768
    ds_read_b64_tr_b16 v[100:101], v140 offset:49152
    ds_read_b64_tr_b16 v[102:103], v140 offset:50176
    s_waitcnt lgkmcnt(7)
    v_mfma_f32_32x32x16_bf16 v[48:63], v[116:119], v[124:127], v[48:63]
    ds_read_b64_tr_b16 v[104:105], v141 offset:49152
    ds_read_b64_tr_b16 v[106:107], v141 offset:50176
    s_add_u32 s49, s49, s25
    s_lshl_b32 s49, s49, 6
    s_waitcnt lgkmcnt(7)
    v_mfma_f32_32x32x16_bf16 v[64:79], v[116:119], v[128:131], v[64:79]
    v_mfma_f32_16x16x32_bf16 v[212:215], v[128:131], v[216:219], v[212:215]
    ds_read_b64_tr_b16 v[108:109], v142 offset:49152
    ds_read_b64_tr_b16 v[110:111], v142 offset:50176
    s_add_u32 s49, s49, 11599872
    s_mul_i32 s26, s23, 100352
    s_waitcnt lgkmcnt(7)
    v_mfma_f32_32x32x16_bf16 v[80:95], v[116:119], v[132:135], v[80:95]
    ds_read_b64_tr_b16 v[112:113], v143 offset:49152
    ds_read_b64_tr_b16 v[114:115], v143 offset:50176
    s_add_u32 s75, s43, s26
    s_mul_i32 s42, s24, 229376
    s_waitcnt lgkmcnt(6)
    v_mfma_f32_32x32x16_bf16 v[32:47], v[96:99], v[100:103], v[32:47]
    v_mfma_f32_16x16x32_bf16 v[220:223], v[100:103], v[216:219], v[220:223]
    ds_read_b128 v[116:119], v137 offset:32768
    ds_read_b64_tr_b16 v[120:121], v140 offset:53248
    ds_read_b64_tr_b16 v[122:123], v140 offset:54272
    s_waitcnt lgkmcnt(7)
    v_mfma_f32_32x32x16_bf16 v[48:63], v[96:99], v[104:107], v[48:63]
    ds_read_b64_tr_b16 v[124:125], v141 offset:53248
    ds_read_b64_tr_b16 v[126:127], v141 offset:54272
    s_mul_i32 s26, s23, 28672
    s_add_u32 s42, s42, s26
    s_waitcnt lgkmcnt(7)
    v_mfma_f32_32x32x16_bf16 v[64:79], v[96:99], v[108:111], v[64:79]
    v_mfma_f32_16x16x32_bf16 v[212:215], v[108:111], v[216:219], v[212:215]
    ds_read_b64_tr_b16 v[128:129], v142 offset:53248
    ds_read_b64_tr_b16 v[130:131], v142 offset:54272
    s_mul_i32 s26, s23, 401408
    s_add_u32 s43, s43, s26
    s_waitcnt lgkmcnt(7)
    v_mfma_f32_32x32x16_bf16 v[80:95], v[96:99], v[112:115], v[80:95]
    ds_read_b64_tr_b16 v[132:133], v143 offset:53248
    ds_read_b64_tr_b16 v[134:135], v143 offset:54272
    s_lshr_b32 s26, s24, 1
    s_lshl_b32 s26, s26, 2
    s_waitcnt lgkmcnt(6)
    v_mfma_f32_32x32x16_bf16 v[32:47], v[116:119], v[120:123], v[32:47]
    v_mfma_f32_16x16x32_bf16 v[220:223], v[120:123], v[216:219], v[220:223]
    ds_read_b128 v[96:99], v138 offset:32768
    ds_read_b64_tr_b16 v[100:101], v140 offset:57344
    ds_read_b64_tr_b16 v[102:103], v140 offset:58368
    s_waitcnt lgkmcnt(7)
    v_mfma_f32_32x32x16_bf16 v[48:63], v[116:119], v[124:127], v[48:63]
    ds_read_b64_tr_b16 v[104:105], v141 offset:57344
    ds_read_b64_tr_b16 v[106:107], v141 offset:58368
    s_add_u32 s26, s26, s25
    s_and_b32 s26, s26, 7
    s_waitcnt lgkmcnt(7)
    v_mfma_f32_32x32x16_bf16 v[64:79], v[116:119], v[128:131], v[64:79]
    v_mfma_f32_16x16x32_bf16 v[212:215], v[128:131], v[216:219], v[212:215]
    ds_read_b64_tr_b16 v[108:109], v142 offset:57344
    ds_read_b64_tr_b16 v[110:111], v142 offset:58368
    s_mul_i32 s26, s26, 0x11111111
    s_xor_b32 s26, s26, 0x76543210
    s_waitcnt lgkmcnt(7)
    v_mfma_f32_32x32x16_bf16 v[80:95], v[116:119], v[132:135], v[80:95]
    ds_read_b64_tr_b16 v[112:113], v143 offset:57344
    ds_read_b64_tr_b16 v[114:115], v143 offset:58368
    s_and_b32 s27, s26, 0x44444444
    s_lshl_b32 s27, s27, 1
    s_waitcnt lgkmcnt(6)
    v_mfma_f32_32x32x16_bf16 v[32:47], v[96:99], v[100:103], v[32:47]
    v_mfma_f32_16x16x32_bf16 v[220:223], v[100:103], v[216:219], v[220:223]
    ds_read_b128 v[116:119], v139 offset:32768
    ds_read_b64_tr_b16 v[120:121], v140 offset:61440
    ds_read_b64_tr_b16 v[122:123], v140 offset:62464
    s_waitcnt lgkmcnt(7)
    v_mfma_f32_32x32x16_bf16 v[48:63], v[96:99], v[104:107], v[48:63]
    ds_read_b64_tr_b16 v[124:125], v141 offset:61440
    ds_read_b64_tr_b16 v[126:127], v141 offset:62464
    s_and_b32 s26, s26, 0x33333333
    s_and_b32 s28, s24, 1
    s_waitcnt lgkmcnt(7)
    v_mfma_f32_32x32x16_bf16 v[64:79], v[96:99], v[108:111], v[64:79]
    v_mfma_f32_16x16x32_bf16 v[212:215], v[108:111], v[216:219], v[212:215]
    ds_read_b64_tr_b16 v[128:129], v142 offset:61440
    ds_read_b64_tr_b16 v[130:131], v142 offset:62464
    s_mul_i32 s28, s28, 0x44444444
    s_add_u32 s26, s26, s28
    s_waitcnt lgkmcnt(7)
    v_mfma_f32_32x32x16_bf16 v[80:95], v[96:99], v[112:115], v[80:95]
    ds_read_b64_tr_b16 v[132:133], v143 offset:61440
    ds_read_b64_tr_b16 v[134:135], v143 offset:62464
    s_add_u32 s26, s26, 0x22222222
    s_and_b32 s47, s26, 0x77777777
    s_waitcnt lgkmcnt(6)
    v_mfma_f32_32x32x16_bf16 v[32:47], v[116:119], v[120:123], v[32:47]
    v_mfma_f32_16x16x32_bf16 v[220:223], v[120:123], v[216:219], v[220:223]
    s_barrier
    ds_read_b128 v[96:99], v144 offset:0
    ds_read_b64_tr_b16 v[100:101], v192 offset:16384
    ds_read_b64_tr_b16 v[102:103], v192 offset:17408
    s_waitcnt lgkmcnt(7)
    v_mfma_f32_32x32x16_bf16 v[48:63], v[116:119], v[124:127], v[48:63]
    ds_read_b64_tr_b16 v[104:105], v193 offset:16384
    ds_read_b64_tr_b16 v[106:107], v193 offset:17408
    s_or_b32 s47, s47, s27
    s_xor_b32 s1, s47, 0x44444444
    s_waitcnt lgkmcnt(7)
    v_mfma_f32_32x32x16_bf16 v[64:79], v[116:119], v[128:131], v[64:79]
    v_mfma_f32_16x16x32_bf16 v[212:215], v[128:131], v[216:219], v[212:215]
    ds_read_b64_tr_b16 v[108:109], v194 offset:16384
    ds_read_b64_tr_b16 v[110:111], v194 offset:17408
    s_add_u32 s26, s24, s25
    s_and_b32 s26, s26, 3
    s_waitcnt lgkmcnt(7)
    v_mfma_f32_32x32x16_bf16 v[80:95], v[116:119], v[132:135], v[80:95]
    ds_read_b64_tr_b16 v[112:113], v195 offset:16384
    ds_read_b64_tr_b16 v[114:115], v195 offset:17408
    s_lshl_b32 s48, s26, 10
    s_waitcnt lgkmcnt(6)
    v_mfma_f32_32x32x16_bf16 v[32:47], v[96:99], v[100:103], v[32:47]
    v_mfma_f32_16x16x32_bf16 v[220:223], v[100:103], v[216:219], v[220:223]
    ds_read_b128 v[116:119], v145 offset:0
    ds_read_b64_tr_b16 v[120:121], v192 offset:20480
    ds_read_b64_tr_b16 v[122:123], v192 offset:21504
    s_waitcnt lgkmcnt(7)
    v_mfma_f32_32x32x16_bf16 v[48:63], v[96:99], v[104:107], v[48:63]
    ds_read_b64_tr_b16 v[124:125], v193 offset:20480
    ds_read_b64_tr_b16 v[126:127], v193 offset:21504
    s_waitcnt lgkmcnt(7)
    v_mfma_f32_32x32x16_bf16 v[64:79], v[96:99], v[108:111], v[64:79]
    v_mfma_f32_16x16x32_bf16 v[212:215], v[108:111], v[216:219], v[212:215]
    ds_read_b64_tr_b16 v[128:129], v194 offset:20480
    ds_read_b64_tr_b16 v[130:131], v194 offset:21504
    s_waitcnt lgkmcnt(7)
    v_mfma_f32_32x32x16_bf16 v[80:95], v[96:99], v[112:115], v[80:95]
    ds_read_b64_tr_b16 v[132:133], v195 offset:20480
    ds_read_b64_tr_b16 v[134:135], v195 offset:21504
    s_waitcnt lgkmcnt(6)
    v_mfma_f32_32x32x16_bf16 v[32:47], v[116:119], v[120:123], v[32:47]
    v_mfma_f32_16x16x32_bf16 v[220:223], v[120:123], v[216:219], v[220:223]
    ds_read_b128 v[96:99], v146 offset:0
    ds_read_b64_tr_b16 v[100:101], v192 offset:24576
    ds_read_b64_tr_b16 v[102:103], v192 offset:25600
    s_waitcnt lgkmcnt(7)
    v_mfma_f32_32x32x16_bf16 v[48:63], v[116:119], v[124:127], v[48:63]
    ds_read_b64_tr_b16 v[104:105], v193 offset:24576
    ds_read_b64_tr_b16 v[106:107], v193 offset:25600
    s_waitcnt lgkmcnt(7)
    v_mfma_f32_32x32x16_bf16 v[64:79], v[116:119], v[128:131], v[64:79]
    v_mfma_f32_16x16x32_bf16 v[212:215], v[128:131], v[216:219], v[212:215]
    ds_read_b64_tr_b16 v[108:109], v194 offset:24576
    ds_read_b64_tr_b16 v[110:111], v194 offset:25600
    s_lshl_b32 s26, s2, 2
    s_add_u32 s26, s26, s23
    s_mul_i32 s27, s26, 1568
    buffer_load_dwordx4 v[164:167], v240, s[8:11], s27 offen
    buffer_load_dwordx4 v[168:171], v240, s[8:11], s27 offen offset:1024
    s_min_u32 s26, s26, 783
    s_lshl_b32 s26, s26, 9
    v_lshrrev_b32 v224, 1, v240
    v_add_u32 v224, s26, v224
    global_load_dwordx2 v[172:173], v224, s[44:45]
    s_waitcnt lgkmcnt(7)
    v_mfma_f32_32x32x16_bf16 v[80:95], v[116:119], v[132:135], v[80:95]
    ds_read_b64_tr_b16 v[112:113], v195 offset:24576
    ds_read_b64_tr_b16 v[114:115], v195 offset:25600
    s_waitcnt lgkmcnt(6)
    v_mfma_f32_32x32x16_bf16 v[32:47], v[96:99], v[100:103], v[32:47]
    v_mfma_f32_16x16x32_bf16 v[220:223], v[100:103], v[216:219], v[220:223]
    ds_read_b128 v[116:119], v147 offset:0
    ds_read_b64_tr_b16 v[120:121], v192 offset:28672
    ds_read_b64_tr_b16 v[122:123], v192 offset:29696
    s_waitcnt lgkmcnt(7)
    v_mfma_f32_32x32x16_bf16 v[48:63], v[96:99], v[104:107], v[48:63]
    ds_read_b64_tr_b16 v[124:125], v193 offset:28672
    ds_read_b64_tr_b16 v[126:127], v193 offset:29696
    s_waitcnt lgkmcnt(7)
    v_mfma_f32_32x32x16_bf16 v[64:79], v[96:99], v[108:111], v[64:79]
    v_mfma_f32_16x16x32_bf16 v[212:215], v[108:111], v[216:219], v[212:215]
    ds_read_b64_tr_b16 v[128:129], v194 offset:28672
    ds_read_b64_tr_b16 v[130:131], v194 offset:29696
    s_waitcnt lgkmcnt(7)
    v_mfma_f32_32x32x16_bf16 v[80:95], v[96:99], v[112:115], v[80:95]
    ds_read_b64_tr_b16 v[132:133], v195 offset:28672
    ds_read_b64_tr_b16 v[134:135], v195 offset:29696
    s_waitcnt lgkmcnt(6)
    v_mfma_f32_32x32x16_bf16 v[32:47], v[116:119], v[120:123], v[32:47]
    v_mfma_f32_16x16x32_bf16 v[220:223], v[120:123], v[216:219], v[220:223]
    s_barrier
    ds_read_b128 v[96:99], v144 offset:32768
    ds_read_b64_tr_b16 v[100:101], v192 offset:49152
    ds_read_b64_tr_b16 v[102:103], v192 offset:50176
    s_waitcnt lgkmcnt(7)
    v_mfma_f32_32x32x16_bf16 v[48:63], v[116:119], v[124:127], v[48:63]
    ds_read_b64_tr_b16 v[104:105], v193 offset:49152
    ds_read_b64_tr_b16 v[106:107], v193 offset:50176
    s_waitcnt lgkmcnt(7)
    v_mfma_f32_32x32x16_bf16 v[64:79], v[116:119], v[128:131], v[64:79]
    v_mfma_f32_16x16x32_bf16 v[212:215], v[128:131], v[216:219], v[212:215]
    ds_read_b64_tr_b16 v[108:109], v194 offset:49152
    ds_read_b64_tr_b16 v[110:111], v194 offset:50176
    s_waitcnt lgkmcnt(7)
    v_mfma_f32_32x32x16_bf16 v[80:95], v[116:119], v[132:135], v[80:95]
    ds_read_b64_tr_b16 v[112:113], v195 offset:49152
    ds_read_b64_tr_b16 v[114:115], v195 offset:50176
    s_waitcnt lgkmcnt(6)
    v_mfma_f32_32x32x16_bf16 v[32:47], v[96:99], v[100:103], v[32:47]
    v_mfma_f32_16x16x32_bf16 v[220:223], v[100:103], v[216:219], v[220:223]
    ds_read_b128 v[116:119], v145 offset:32768
    ds_read_b64_tr_b16 v[120:121], v192 offset:53248
    ds_read_b64_tr_b16 v[122:123], v192 offset:54272
    s_waitcnt lgkmcnt(7)
    v_mfma_f32_32x32x16_bf16 v[48:63], v[96:99], v[104:107], v[48:63]
    ds_read_b64_tr_b16 v[124:125], v193 offset:53248
    ds_read_b64_tr_b16 v[126:127], v193 offset:54272
    s_waitcnt lgkmcnt(7)
    v_mfma_f32_32x32x16_bf16 v[64:79], v[96:99], v[108:111], v[64:79]
    v_mfma_f32_16x16x32_bf16 v[212:215], v[108:111], v[216:219], v[212:215]
    ds_read_b64_tr_b16 v[128:129], v194 offset:53248
    ds_read_b64_tr_b16 v[130:131], v194 offset:54272
    s_waitcnt lgkmcnt(7)
    v_mfma_f32_32x32x16_bf16 v[80:95], v[96:99], v[112:115], v[80:95]
    ds_read_b64_tr_b16 v[132:133], v195 offset:53248
    ds_read_b64_tr_b16 v[134:135], v195 offset:54272
    s_waitcnt lgkmcnt(6)
    v_mfma_f32_32x32x16_bf16 v[32:47], v[116:119], v[120:123], v[32:47]
    v_mfma_f32_16x16x32_bf16 v[220:223], v[120:123], v[216:219], v[220:223]
    ds_read_b128 v[96:99], v146 offset:32768
    ds_read_b64_tr_b16 v[100:101], v192 offset:57344
    ds_read_b64_tr_b16 v[102:103], v192 offset:58368
    s_waitcnt lgkmcnt(7)
    v_mfma_f32_32x32x16_bf16 v[48:63], v[116:119], v[124:127], v[48:63]
    ds_read_b64_tr_b16 v[104:105], v193 offset:57344
    ds_read_b64_tr_b16 v[106:107], v193 offset:58368
    s_waitcnt lgkmcnt(7)
    v_mfma_f32_32x32x16_bf16 v[64:79], v[116:119], v[128:131], v[64:79]
    v_mfma_f32_16x16x32_bf16 v[212:215], v[128:131], v[216:219], v[212:215]
    ds_read_b64_tr_b16 v[108:109], v194 offset:57344
    ds_read_b64_tr_b16 v[110:111], v194 offset:58368
    s_waitcnt lgkmcnt(7)
    v_mfma_f32_32x32x16_bf16 v[80:95], v[116:119], v[132:135], v[80:95]
    ds_read_b64_tr_b16 v[112:113], v195 offset:57344
    ds_read_b64_tr_b16 v[114:115], v195 offset:58368
    s_waitcnt lgkmcnt(6)
    v_mfma_f32_32x32x16_bf16 v[32:47], v[96:99], v[100:103], v[32:47]
    v_mfma_f32_16x16x32_bf16 v[220:223], v[100:103], v[216:219], v[220:223]
    ds_read_b128 v[116:119], v147 offset:32768
    ds_read_b64_tr_b16 v[120:121], v192 offset:61440
    ds_read_b64_tr_b16 v[122:123], v192 offset:62464
    s_waitcnt lgkmcnt(7)
    v_mfma_f32_32x32x16_bf16 v[48:63], v[96:99], v[104:107], v[48:63]
    ds_read_b64_tr_b16 v[124:125], v193 offset:61440
    ds_read_b64_tr_b16 v[126:127], v193 offset:62464
    s_waitcnt lgkmcnt(7)
    v_mfma_f32_32x32x16_bf16 v[64:79], v[96:99], v[108:111], v[64:79]
    v_mfma_f32_16x16x32_bf16 v[212:215], v[108:111], v[216:219], v[212:215]
    ds_read_b64_tr_b16 v[128:129], v194 offset:61440
    ds_read_b64_tr_b16 v[130:131], v194 offset:62464
    s_waitcnt lgkmcnt(7)
    v_mfma_f32_32x32x16_bf16 v[80:95], v[96:99], v[112:115], v[80:95]
    ds_read_b64_tr_b16 v[132:133], v195 offset:61440
    ds_read_b64_tr_b16 v[134:135], v195 offset:62464
    s_waitcnt lgkmcnt(6)
    v_mfma_f32_32x32x16_bf16 v[32:47], v[116:119], v[120:123], v[32:47]
    v_mfma_f32_16x16x32_bf16 v[220:223], v[120:123], v[216:219], v[220:223]
    s_barrier
    ds_read_b128 v[96:99], v148 offset:0
    ds_read_b64_tr_b16 v[100:101], v140 offset:0
    ds_read_b64_tr_b16 v[102:103], v140 offset:1024
    s_waitcnt lgkmcnt(7)
    v_mfma_f32_32x32x16_bf16 v[48:63], v[116:119], v[124:127], v[48:63]
    ds_read_b64_tr_b16 v[104:105], v141 offset:0
    ds_read_b64_tr_b16 v[106:107], v141 offset:1024
    s_waitcnt lgkmcnt(7)
    v_mfma_f32_32x32x16_bf16 v[64:79], v[116:119], v[128:131], v[64:79]
    v_mfma_f32_16x16x32_bf16 v[212:215], v[128:131], v[216:219], v[212:215]
    ds_read_b64_tr_b16 v[108:109], v142 offset:0
    ds_read_b64_tr_b16 v[110:111], v142 offset:1024
    s_waitcnt lgkmcnt(7)
    v_mfma_f32_32x32x16_bf16 v[80:95], v[116:119], v[132:135], v[80:95]
    ds_read_b64_tr_b16 v[112:113], v143 offset:0
    ds_read_b64_tr_b16 v[114:115], v143 offset:1024
    s_waitcnt lgkmcnt(6)
    v_mfma_f32_32x32x16_bf16 v[32:47], v[96:99], v[100:103], v[32:47]
    v_mfma_f32_16x16x32_bf16 v[220:223], v[100:103], v[216:219], v[220:223]
    ds_read_b128 v[116:119], v149 offset:0
    ds_read_b64_tr_b16 v[120:121], v140 offset:4096
    ds_read_b64_tr_b16 v[122:123], v140 offset:5120
    s_waitcnt lgkmcnt(7)
    v_mfma_f32_32x32x16_bf16 v[48:63], v[96:99], v[104:107], v[48:63]
    ds_read_b64_tr_b16 v[124:125], v141 offset:4096
    ds_read_b64_tr_b16 v[126:127], v141 offset:5120
    s_waitcnt lgkmcnt(7)
    v_mfma_f32_32x32x16_bf16 v[64:79], v[96:99], v[108:111], v[64:79]
    v_mfma_f32_16x16x32_bf16 v[212:215], v[108:111], v[216:219], v[212:215]
    ds_read_b64_tr_b16 v[128:129], v142 offset:4096
    ds_read_b64_tr_b16 v[130:131], v142 offset:5120
    s_waitcnt lgkmcnt(7)
    v_mfma_f32_32x32x16_bf16 v[80:95], v[96:99], v[112:115], v[80:95]
    ds_read_b64_tr_b16 v[132:133], v143 offset:4096
    ds_read_b64_tr_b16 v[134:135], v143 offset:5120
    s_waitcnt lgkmcnt(6)
    v_mfma_f32_32x32x16_bf16 v[32:47], v[116:119], v[120:123], v[32:47]
    v_mfma_f32_16x16x32_bf16 v[220:223], v[120:123], v[216:219], v[220:223]
    ds_read_b128 v[96:99], v150 offset:0
    ds_read_b64_tr_b16 v[100:101], v140 offset:8192
    ds_read_b64_tr_b16 v[102:103], v140 offset:9216
    s_waitcnt lgkmcnt(7)
    v_mfma_f32_32x32x16_bf16 v[48:63], v[116:119], v[124:127], v[48:63]
    ds_read_b64_tr_b16 v[104:105], v141 offset:8192
    ds_read_b64_tr_b16 v[106:107], v141 offset:9216
    s_waitcnt lgkmcnt(7)
    v_mfma_f32_32x32x16_bf16 v[64:79], v[116:119], v[128:131], v[64:79]
    v_mfma_f32_16x16x32_bf16 v[212:215], v[128:131], v[216:219], v[212:215]
    ds_read_b64_tr_b16 v[108:109], v142 offset:8192
    ds_read_b64_tr_b16 v[110:111], v142 offset:9216
    s_waitcnt lgkmcnt(7)
    v_mfma_f32_32x32x16_bf16 v[80:95], v[116:119], v[132:135], v[80:95]
    ds_read_b64_tr_b16 v[112:113], v143 offset:8192
    ds_read_b64_tr_b16 v[114:115], v143 offset:9216
    s_waitcnt lgkmcnt(6)
    v_mfma_f32_32x32x16_bf16 v[32:47], v[96:99], v[100:103], v[32:47]
    v_mfma_f32_16x16x32_bf16 v[220:223], v[100:103], v[216:219], v[220:223]
    ds_read_b128 v[116:119], v151 offset:0
    ds_read_b64_tr_b16 v[120:121], v140 offset:12288
    ds_read_b64_tr_b16 v[122:123], v140 offset:13312
    s_waitcnt lgkmcnt(7)
    v_mfma_f32_32x32x16_bf16 v[48:63], v[96:99], v[104:107], v[48:63]
    ds_read_b64_tr_b16 v[124:125], v141 offset:12288
    ds_read_b64_tr_b16 v[126:127], v141 offset:13312
    s_waitcnt lgkmcnt(7)
    v_mfma_f32_32x32x16_bf16 v[64:79], v[96:99], v[108:111], v[64:79]
    v_mfma_f32_16x16x32_bf16 v[212:215], v[108:111], v[216:219], v[212:215]
    ds_read_b64_tr_b16 v[128:129], v142 offset:12288
    ds_read_b64_tr_b16 v[130:131], v142 offset:13312
    s_waitcnt lgkmcnt(7)
    v_mfma_f32_32x32x16_bf16 v[80:95], v[96:99], v[112:115], v[80:95]
    ds_read_b64_tr_b16 v[132:133], v143 offset:12288
    ds_read_b64_tr_b16 v[134:135], v143 offset:13312
    s_waitcnt lgkmcnt(6)
    v_mfma_f32_32x32x16_bf16 v[32:47], v[116:119], v[120:123], v[32:47]
    v_mfma_f32_16x16x32_bf16 v[220:223], v[120:123], v[216:219], v[220:223]
    s_barrier
    ds_read_b128 v[96:99], v136 offset:16384
    ds_read_b64_tr_b16 v[100:101], v140 offset:32768
    ds_read_b64_tr_b16 v[102:103], v140 offset:33792
    s_waitcnt lgkmcnt(7)
    v_mfma_f32_32x32x16_bf16 v[48:63], v[116:119], v[124:127], v[48:63]
    ds_read_b64_tr_b16 v[104:105], v141 offset:32768
    ds_read_b64_tr_b16 v[106:107], v141 offset:33792
    s_waitcnt lgkmcnt(7)
    v_mfma_f32_32x32x16_bf16 v[64:79], v[116:119], v[128:131], v[64:79]
    v_mfma_f32_16x16x32_bf16 v[212:215], v[128:131], v[216:219], v[212:215]
    ds_read_b64_tr_b16 v[108:109], v142 offset:32768
    ds_read_b64_tr_b16 v[110:111], v142 offset:33792
    s_waitcnt lgkmcnt(7)
    v_mfma_f32_32x32x16_bf16 v[80:95], v[116:119], v[132:135], v[80:95]
    ds_read_b64_tr_b16 v[112:113], v143 offset:32768
    ds_read_b64_tr_b16 v[114:115], v143 offset:33792
    s_waitcnt lgkmcnt(6)
    v_mfma_f32_32x32x16_bf16 v[32:47], v[96:99], v[100:103], v[32:47]
    v_mfma_f32_16x16x32_bf16 v[220:223], v[100:103], v[216:219], v[220:223]
    ds_read_b128 v[116:119], v137 offset:16384
    ds_read_b64_tr_b16 v[120:121], v140 offset:36864
    ds_read_b64_tr_b16 v[122:123], v140 offset:37888
    s_waitcnt lgkmcnt(7)
    v_mfma_f32_32x32x16_bf16 v[48:63], v[96:99], v[104:107], v[48:63]
    ds_read_b64_tr_b16 v[124:125], v141 offset:36864
    ds_read_b64_tr_b16 v[126:127], v141 offset:37888
    s_waitcnt lgkmcnt(7)
    v_mfma_f32_32x32x16_bf16 v[64:79], v[96:99], v[108:111], v[64:79]
    v_mfma_f32_16x16x32_bf16 v[212:215], v[108:111], v[216:219], v[212:215]
    ds_read_b64_tr_b16 v[128:129], v142 offset:36864
    ds_read_b64_tr_b16 v[130:131], v142 offset:37888
    global_load_dword v246, v247, s[56:57] sc1
    s_waitcnt lgkmcnt(7)
    v_mfma_f32_32x32x16_bf16 v[80:95], v[96:99], v[112:115], v[80:95]
    ds_read_b64_tr_b16 v[132:133], v143 offset:36864
    ds_read_b64_tr_b16 v[134:135], v143 offset:37888
    buffer_load_dwordx4 v[152:155], v156, s[12:15], 0 offen sc1
    s_waitcnt lgkmcnt(6)
    v_mfma_f32_32x32x16_bf16 v[32:47], v[116:119], v[120:123], v[32:47]
    v_mfma_f32_16x16x32_bf16 v[220:223], v[120:123], v[216:219], v[220:223]
    ds_read_b128 v[96:99], v138 offset:16384
    ds_read_b64_tr_b16 v[100:101], v140 offset:40960
    ds_read_b64_tr_b16 v[102:103], v140 offset:41984
    s_waitcnt lgkmcnt(7)
    v_mfma_f32_32x32x16_bf16 v[48:63], v[116:119], v[124:127], v[48:63]
    ds_read_b64_tr_b16 v[104:105], v141 offset:40960
    ds_read_b64_tr_b16 v[106:107], v141 offset:41984
    s_waitcnt lgkmcnt(7)
    v_mfma_f32_32x32x16_bf16 v[64:79], v[116:119], v[128:131], v[64:79]
    v_mfma_f32_16x16x32_bf16 v[212:215], v[128:131], v[216:219], v[212:215]
    ds_read_b64_tr_b16 v[108:109], v142 offset:40960
    ds_read_b64_tr_b16 v[110:111], v142 offset:41984
    s_waitcnt lgkmcnt(7)
    v_mfma_f32_32x32x16_bf16 v[80:95], v[116:119], v[132:135], v[80:95]
    ds_read_b64_tr_b16 v[112:113], v143 offset:40960
    ds_read_b64_tr_b16 v[114:115], v143 offset:41984
    s_waitcnt lgkmcnt(6)
    v_mfma_f32_32x32x16_bf16 v[32:47], v[96:99], v[100:103], v[32:47]
    v_mfma_f32_16x16x32_bf16 v[220:223], v[100:103], v[216:219], v[220:223]
    ds_read_b128 v[116:119], v139 offset:16384
    ds_read_b64_tr_b16 v[120:121], v140 offset:45056
    ds_read_b64_tr_b16 v[122:123], v140 offset:46080
    s_waitcnt lgkmcnt(7)
    v_mfma_f32_32x32x16_bf16 v[48:63], v[96:99], v[104:107], v[48:63]
    ds_read_b64_tr_b16 v[124:125], v141 offset:45056
    ds_read_b64_tr_b16 v[126:127], v141 offset:46080
    s_waitcnt lgkmcnt(7)
    v_mfma_f32_32x32x16_bf16 v[64:79], v[96:99], v[108:111], v[64:79]
    v_mfma_f32_16x16x32_bf16 v[212:215], v[108:111], v[216:219], v[212:215]
    ds_read_b64_tr_b16 v[128:129], v142 offset:45056
    ds_read_b64_tr_b16 v[130:131], v142 offset:46080
    s_waitcnt lgkmcnt(7)
    v_mfma_f32_32x32x16_bf16 v[80:95], v[96:99], v[112:115], v[80:95]
    ds_read_b64_tr_b16 v[132:133], v143 offset:45056
    ds_read_b64_tr_b16 v[134:135], v143 offset:46080
    s_waitcnt lgkmcnt(6)
    v_mfma_f32_32x32x16_bf16 v[32:47], v[116:119], v[120:123], v[32:47]
    v_mfma_f32_16x16x32_bf16 v[220:223], v[120:123], v[216:219], v[220:223]
    s_barrier
    ds_read_b128 v[96:99], v136 offset:49152
    ds_read_b64_tr_b16 v[100:101], v192 offset:0
    ds_read_b64_tr_b16 v[102:103], v192 offset:1024
    s_waitcnt lgkmcnt(7)
    v_mfma_f32_32x32x16_bf16 v[48:63], v[116:119], v[124:127], v[48:63]
    ds_read_b64_tr_b16 v[104:105], v193 offset:0
    ds_read_b64_tr_b16 v[106:107], v193 offset:1024
    s_waitcnt lgkmcnt(7)
    v_mfma_f32_32x32x16_bf16 v[64:79], v[116:119], v[128:131], v[64:79]
    v_mfma_f32_16x16x32_bf16 v[212:215], v[128:131], v[216:219], v[212:215]
    ds_read_b64_tr_b16 v[108:109], v194 offset:0
    ds_read_b64_tr_b16 v[110:111], v194 offset:1024
    s_waitcnt lgkmcnt(7)
    v_mfma_f32_32x32x16_bf16 v[80:95], v[116:119], v[132:135], v[80:95]
    ds_read_b64_tr_b16 v[112:113], v195 offset:0
    ds_read_b64_tr_b16 v[114:115], v195 offset:1024
    s_waitcnt lgkmcnt(6)
    v_mfma_f32_32x32x16_bf16 v[32:47], v[96:99], v[100:103], v[32:47]
    v_mfma_f32_16x16x32_bf16 v[220:223], v[100:103], v[216:219], v[220:223]
    ds_read_b128 v[116:119], v137 offset:49152
    ds_read_b64_tr_b16 v[120:121], v192 offset:4096
    ds_read_b64_tr_b16 v[122:123], v192 offset:5120
    s_waitcnt lgkmcnt(7)
    v_mfma_f32_32x32x16_bf16 v[48:63], v[96:99], v[104:107], v[48:63]
    ds_read_b64_tr_b16 v[124:125], v193 offset:4096
    ds_read_b64_tr_b16 v[126:127], v193 offset:5120
    s_waitcnt lgkmcnt(7)
    v_mfma_f32_32x32x16_bf16 v[64:79], v[96:99], v[108:111], v[64:79]
    v_mfma_f32_16x16x32_bf16 v[212:215], v[108:111], v[216:219], v[212:215]
    ds_read_b64_tr_b16 v[128:129], v194 offset:4096
    ds_read_b64_tr_b16 v[130:131], v194 offset:5120
    s_waitcnt lgkmcnt(7)
    v_mfma_f32_32x32x16_bf16 v[80:95], v[96:99], v[112:115], v[80:95]
    ds_read_b64_tr_b16 v[132:133], v195 offset:4096
    ds_read_b64_tr_b16 v[134:135], v195 offset:5120
    s_waitcnt lgkmcnt(6)
    v_mfma_f32_32x32x16_bf16 v[32:47], v[116:119], v[120:123], v[32:47]
    v_mfma_f32_16x16x32_bf16 v[220:223], v[120:123], v[216:219], v[220:223]
    ds_read_b128 v[96:99], v138 offset:49152
    ds_read_b64_tr_b16 v[100:101], v192 offset:8192
    ds_read_b64_tr_b16 v[102:103], v192 offset:9216
    s_waitcnt lgkmcnt(7)
    v_mfma_f32_32x32x16_bf16 v[48:63], v[116:119], v[124:127], v[48:63]
    ds_read_b64_tr_b16 v[104:105], v193 offset:8192
    ds_read_b64_tr_b16 v[106:107], v193 offset:9216
    s_waitcnt lgkmcnt(7)
    v_mfma_f32_32x32x16_bf16 v[64:79], v[116:119], v[128:131], v[64:79]
    v_mfma_f32_16x16x32_bf16 v[212:215], v[128:131], v[216:219], v[212:215]
    ds_read_b64_tr_b16 v[108:109], v194 offset:8192
    ds_read_b64_tr_b16 v[110:111], v194 offset:9216
    s_waitcnt lgkmcnt(7)
    v_mfma_f32_32x32x16_bf16 v[80:95], v[116:119], v[132:135], v[80:95]
    ds_read_b64_tr_b16 v[112:113], v195 offset:8192
    ds_read_b64_tr_b16 v[114:115], v195 offset:9216
    s_waitcnt lgkmcnt(6)
    v_mfma_f32_32x32x16_bf16 v[32:47], v[96:99], v[100:103], v[32:47]
    v_mfma_f32_16x16x32_bf16 v[220:223], v[100:103], v[216:219], v[220:223]
    ds_read_b128 v[116:119], v139 offset:49152
    ds_read_b64_tr_b16 v[120:121], v192 offset:12288
    ds_read_b64_tr_b16 v[122:123], v192 offset:13312
    s_waitcnt lgkmcnt(7)
    v_mfma_f32_32x32x16_bf16 v[48:63], v[96:99], v[104:107], v[48:63]
    ds_read_b64_tr_b16 v[124:125], v193 offset:12288
    ds_read_b64_tr_b16 v[126:127], v193 offset:13312
    s_waitcnt lgkmcnt(7)
    v_mfma_f32_32x32x16_bf16 v[64:79], v[96:99], v[108:111], v[64:79]
    v_mfma_f32_16x16x32_bf16 v[212:215], v[108:111], v[216:219], v[212:215]
    ds_read_b64_tr_b16 v[128:129], v194 offset:12288
    ds_read_b64_tr_b16 v[130:131], v194 offset:13312
    s_waitcnt lgkmcnt(7)
    v_mfma_f32_32x32x16_bf16 v[80:95], v[96:99], v[112:115], v[80:95]
    ds_read_b64_tr_b16 v[132:133], v195 offset:12288
    ds_read_b64_tr_b16 v[134:135], v195 offset:13312
    s_waitcnt lgkmcnt(6)
    v_mfma_f32_32x32x16_bf16 v[32:47], v[116:119], v[120:123], v[32:47]
    v_mfma_f32_16x16x32_bf16 v[220:223], v[120:123], v[216:219], v[220:223]
    s_waitcnt lgkmcnt(4)
    v_mfma_f32_32x32x16_bf16 v[48:63], v[116:119], v[124:127], v[48:63]
    s_waitcnt lgkmcnt(2)
    v_mfma_f32_32x32x16_bf16 v[64:79], v[116:119], v[128:131], v[64:79]
    v_mfma_f32_16x16x32_bf16 v[212:215], v[128:131], v[216:219], v[212:215]
    s_waitcnt lgkmcnt(0)
    v_mfma_f32_32x32x16_bf16 v[80:95], v[116:119], v[132:135], v[80:95]
    s_nop 3
    s_mov_b32 exec_lo, 0x00030003
    s_mov_b32 exec_hi, 0x00030003
    ds_write_b128 v157, v[220:223]
    ds_write_b128 v157, v[212:215] offset:256
    s_mov_b64 exec, -1
    s_waitcnt lgkmcnt(0)
    s_barrier
    ds_read_b32 v200, v188
    ds_read_b32 v201, v189
    ds_read_b32 v202, v190
    ds_read_b32 v203, v191
    s_waitcnt vmcnt(1)
    s_mov_b32 s27, 0
NON_14:
    v_readfirstlane_b32 s79, v246
    s_nop 0
    s_cmp_lg_u32 s79, 0
    s_cbranch_scc1 NOK_15
    s_add_u32 s27, s27, 1
    s_cmp_gt_u32 s27, 131072
    s_cbranch_scc1 NOK_15
    global_load_dword v246, v247, s[56:57] sc1
    s_waitcnt vmcnt(0)
    s_branch NON_14
NOK_15:
    s_mov_b32 s27, 0
GRW_12:
    s_waitcnt vmcnt(0)
    v_cmp_ne_u32 vcc, s79, v155
    s_nop 0
    s_cmp_eq_u64 vcc, 0
    s_cbranch_scc1 GRK_13
    s_add_u32 s27, s27, 1
    s_cmp_gt_u32 s27, 131072
    s_cbranch_scc1 GRK_13
    buffer_load_dwordx4 v[152:155], v156, s[12:15], 0 offen sc1
    s_branch GRW_12
GRK_13:
    v_cvt_pk_bf16_f32 v248, v152, v152
    v_mov_b32 v242, v154
    v_and_b32 v224, 0xffff0000, v248
    v_sub_f32 v224, v152, v224
    v_cvt_pk_bf16_f32 v249, v224, v153
    v_and_b32 v224, 0xffff0000, v249
    v_sub_f32 v224, v153, v224
    v_cvt_pk_bf16_f32 v250, v224, 0
    v_mov_b32 v251, 0
    v_cndmask_b32_e64 v248, v248, 0, s[34:35]
    v_cndmask_b32_e64 v249, v249, 0, s[34:35]
    v_cndmask_b32_e64 v250, v250, 0, s[34:35]
    v_mul_f32 v244, 0x3fb8aa3b, v242
    s_lshl_b32 s26, s23, 10
    s_add_u32 s26, s26, 156672
    v_add_u32 v225, s26, v240
    ds_write_b128 v225, v[248:251]
    s_lshl_b32 s26, s23, 7
    s_add_u32 s26, s26, 160768
    v_lshl_add_u32 v226, v243, 2, s26
    ds_write_b32 v226, v242
    v_lshrrev_b32 v231, 5, v241
    v_lshlrev_b32 v231, 4, v231
    s_lshl_b32 s26, s23, 7
    s_add_u32 s26, s26, 160768
    v_add_u32 v230, s26, v231
    s_waitcnt lgkmcnt(0)
    ds_read_b128 v[160:163], v230 offset:0
    ds_read_b128 v[164:167], v230 offset:32
    ds_read_b128 v[168:171], v230 offset:64
    ds_read_b128 v[172:175], v230 offset:96
    v_cvt_pk_bf16_f32 v231, v200, v200
    v_and_b32 v231, 0xffff0000, v231
    v_sub_f32 v231, v200, v231
    v_cvt_pk_bf16_f32 v252, v200, v231
    v_cvt_pk_bf16_f32 v253, v200, 0
    v_mov_b32 v254, 0
    v_mov_b32 v255, 0
    s_nop 1
    v_mfma_f32_32x32x16_bf16 v[32:47], v[248:251], v[252:255], v[32:47]
    v_cvt_pk_bf16_f32 v231, v201, v201
    v_and_b32 v231, 0xffff0000, v231
    v_sub_f32 v231, v201, v231
    v_cvt_pk_bf16_f32 v252, v201, v231
    v_cvt_pk_bf16_f32 v253, v201, 0
    v_mov_b32 v254, 0
    v_mov_b32 v255, 0
    s_nop 1
    v_mfma_f32_32x32x16_bf16 v[48:63], v[248:251], v[252:255], v[48:63]
    v_cvt_pk_bf16_f32 v231, v202, v202
    v_and_b32 v231, 0xffff0000, v231
    v_sub_f32 v231, v202, v231
    v_cvt_pk_bf16_f32 v252, v202, v231
    v_cvt_pk_bf16_f32 v253, v202, 0
    v_mov_b32 v254, 0
    v_mov_b32 v255, 0
    s_nop 1
    v_mfma_f32_32x32x16_bf16 v[64:79], v[248:251], v[252:255], v[64:79]
    v_cvt_pk_bf16_f32 v231, v203, v203
    v_and_b32 v231, 0xffff0000, v231
    v_sub_f32 v231, v203, v231
    v_cvt_pk_bf16_f32 v252, v203, v231
    v_cvt_pk_bf16_f32 v253, v203, 0
    v_mov_b32 v254, 0
    v_mov_b32 v255, 0
    s_nop 1
    v_mfma_f32_32x32x16_bf16 v[80:95], v[248:251], v[252:255], v[80:95]
    s_waitcnt lgkmcnt(0)
    v_mul_f32 v176, 0x3fb8aa3b, v160
    v_mul_f32 v177, 0x3fb8aa3b, v161
    v_mul_f32 v178, 0x3fb8aa3b, v162
    v_mul_f32 v179, 0x3fb8aa3b, v163
    v_mul_f32 v180, 0x3fb8aa3b, v164
    v_mul_f32 v181, 0x3fb8aa3b, v165
    v_mul_f32 v182, 0x3fb8aa3b, v166
    v_mul_f32 v183, 0x3fb8aa3b, v167
    v_mul_f32 v184, 0x3fb8aa3b, v168
    v_mul_f32 v185, 0x3fb8aa3b, v169
    v_mul_f32 v186, 0x3fb8aa3b, v170
    v_mul_f32 v187, 0x3fb8aa3b, v171
    v_mul_f32 v188, 0x3fb8aa3b, v172
    v_mul_f32 v189, 0x3fb8aa3b, v173
    v_mul_f32 v190, 0x3fb8aa3b, v174
    v_mul_f32 v191, 0x3fb8aa3b, v175
    v_fma_f32 v32, v32, v176, v245
    v_fma_f32 v33, v33, v177, v245
    v_fma_f32 v34, v34, v178, v245
    v_fma_f32 v35, v35, v179, v245
    v_fma_f32 v36, v36, v180, v245
    v_fma_f32 v37, v37, v181, v245
    v_fma_f32 v38, v38, v182, v245
    v_fma_f32 v39, v39, v183, v245
    v_fma_f32 v40, v40, v184, v245
    v_fma_f32 v41, v41, v185, v245
    v_fma_f32 v42, v42, v186, v245
    v_fma_f32 v43, v43, v187, v245
    v_fma_f32 v44, v44, v188, v245
    v_fma_f32 v45, v45, v189, v245
    v_fma_f32 v46, v46, v190, v245
    v_fma_f32 v47, v47, v191, v245
    v_exp_f32_e64 v16, v32 clamp
    v_exp_f32_e64 v17, v33 clamp
    v_exp_f32_e64 v18, v34 clamp
    v_exp_f32_e64 v19, v35 clamp
    v_exp_f32_e64 v20, v36 clamp
    v_exp_f32_e64 v21, v37 clamp
    v_exp_f32_e64 v22, v38 clamp
    v_exp_f32_e64 v23, v39 clamp
    v_exp_f32_e64 v24, v40 clamp
    v_exp_f32_e64 v25, v41 clamp
    v_exp_f32_e64 v26, v42 clamp
    v_exp_f32_e64 v27, v43 clamp
    v_exp_f32_e64 v28, v44 clamp
    v_exp_f32_e64 v29, v45 clamp
    v_exp_f32_e64 v30, v46 clamp
    v_exp_f32_e64 v31, v47 clamp
    v_max_f32 v32, s38, v32
    v_max_f32 v33, s38, v33
    v_max_f32 v34, s38, v34
    v_max_f32 v35, s38, v35
    v_max_f32 v36, s38, v36
    v_max_f32 v37, s38, v37
    v_max_f32 v38, s38, v38
    v_max_f32 v39, s38, v39
    v_max_f32 v40, s38, v40
    v_max_f32 v41, s38, v41
    v_max_f32 v42, s38, v42
    v_max_f32 v43, s38, v43
    v_max_f32 v44, s38, v44
    v_max_f32 v45, s38, v45
    v_max_f32 v46, s38, v46
    v_max_f32 v47, s38, v47
    v_fmac_f32 v16, s37, v32
    v_fmac_f32 v17, s37, v33
    v_fmac_f32 v18, s37, v34
    v_fmac_f32 v19, s37, v35
    v_fmac_f32 v20, s37, v36
    v_fmac_f32 v21, s37, v37
    v_fmac_f32 v22, s37, v38
    v_fmac_f32 v23, s37, v39
    v_fmac_f32 v24, s37, v40
    v_fmac_f32 v25, s37, v41
    v_fmac_f32 v26, s37, v42
    v_fmac_f32 v27, s37, v43
    v_fmac_f32 v28, s37, v44
    v_fmac_f32 v29, s37, v45
    v_fmac_f32 v30, s37, v46
    v_fmac_f32 v31, s37, v47
    v_cvt_pk_bf16_f32 v124, v16, v17
    v_cvt_pk_bf16_f32 v125, v18, v19
    v_cvt_pk_bf16_f32 v126, v20, v21
    v_cvt_pk_bf16_f32 v127, v22, v23
    v_cvt_pk_bf16_f32 v128, v24, v25
    v_cvt_pk_bf16_f32 v129, v26, v27
    v_cvt_pk_bf16_f32 v130, v28, v29
    v_cvt_pk_bf16_f32 v131, v30, v31
    s_barrier
    v_fma_f32 v48, v48, v176, v245
    v_fma_f32 v49, v49, v177, v245
    v_fma_f32 v50, v50, v178, v245
    v_fma_f32 v51, v51, v179, v245
    v_fma_f32 v52, v52, v180, v245
    v_fma_f32 v53, v53, v181, v245
    v_fma_f32 v54, v54, v182, v245
    v_fma_f32 v55, v55, v183, v245
    v_fma_f32 v56, v56, v184, v245
    v_fma_f32 v57, v57, v185, v245
    v_fma_f32 v58, v58, v186, v245
    v_fma_f32 v59, v59, v187, v245
    v_fma_f32 v60, v60, v188, v245
    v_fma_f32 v61, v61, v189, v245
    v_fma_f32 v62, v62, v190, v245
    v_fma_f32 v63, v63, v191, v245
    v_exp_f32_e64 v16, v48 clamp
    v_exp_f32_e64 v17, v49 clamp
    v_exp_f32_e64 v18, v50 clamp
    v_exp_f32_e64 v19, v51 clamp
    v_exp_f32_e64 v20, v52 clamp
    v_exp_f32_e64 v21, v53 clamp
    v_exp_f32_e64 v22, v54 clamp
    v_exp_f32_e64 v23, v55 clamp
    v_exp_f32_e64 v24, v56 clamp
    v_exp_f32_e64 v25, v57 clamp
    v_exp_f32_e64 v26, v58 clamp
    v_exp_f32_e64 v27, v59 clamp
    v_exp_f32_e64 v28, v60 clamp
    v_exp_f32_e64 v29, v61 clamp
    v_exp_f32_e64 v30, v62 clamp
    v_exp_f32_e64 v31, v63 clamp
    v_max_f32 v48, s38, v48
    v_max_f32 v49, s38, v49
    v_max_f32 v50, s38, v50
    v_max_f32 v51, s38, v51
    v_max_f32 v52, s38, v52
    v_max_f32 v53, s38, v53
    v_max_f32 v54, s38, v54
    v_max_f32 v55, s38, v55
    v_max_f32 v56, s38, v56
    v_max_f32 v57, s38, v57
    v_max_f32 v58, s38, v58
    v_max_f32 v59, s38, v59
    v_max_f32 v60, s38, v60
    v_max_f32 v61, s38, v61
    v_max_f32 v62, s38, v62
    v_max_f32 v63, s38, v63
    v_fmac_f32 v16, s37, v48
    v_fmac_f32 v17, s37, v49
    v_fmac_f32 v18, s37, v50
    v_fmac_f32 v19, s37, v51
    v_fmac_f32 v20, s37, v52
    v_fmac_f32 v21, s37, v53
    v_fmac_f32 v22, s37, v54
    v_fmac_f32 v23, s37, v55
    v_fmac_f32 v24, s37, v56
    v_fmac_f32 v25, s37, v57
    v_fmac_f32 v26, s37, v58
    v_fmac_f32 v27, s37, v59
    v_fmac_f32 v28, s37, v60
    v_fmac_f32 v29, s37, v61
    v_fmac_f32 v30, s37, v62
    v_fmac_f32 v31, s37, v63
    v_cvt_pk_bf16_f32 v116, v16, v17
    v_cvt_pk_bf16_f32 v117, v18, v19
    v_cvt_pk_bf16_f32 v118, v20, v21
    v_cvt_pk_bf16_f32 v119, v22, v23
    v_cvt_pk_bf16_f32 v120, v24, v25
    v_cvt_pk_bf16_f32 v121, v26, v27
    v_cvt_pk_bf16_f32 v122, v28, v29
    v_cvt_pk_bf16_f32 v123, v30, v31
    v_mov_b32 v231, 0x3f803f80
    v_cndmask_b32_e64 v230, 0, v231, s[62:63]
    v_mul_f32 v64, v64, v160
    v_mul_f32 v65, v65, v161
    v_mul_f32 v66, v66, v162
    v_mul_f32 v67, v67, v163
    v_mul_f32 v68, v68, v164
    v_mul_f32 v69, v69, v165
    v_mul_f32 v70, v70, v166
    v_mul_f32 v71, v71, v167
    v_mul_f32 v72, v72, v168
    v_mul_f32 v73, v73, v169
    v_mul_f32 v74, v74, v170
    v_mul_f32 v75, v75, v171
    v_mul_f32 v76, v76, v172
    v_mul_f32 v77, v77, v173
    v_mul_f32 v78, v78, v174
    v_mul_f32 v79, v79, v175
    v_cvt_pk_bf16_f32 v96, v64, v65
    v_cvt_pk_bf16_f32 v97, v66, v67
    v_cvt_pk_bf16_f32 v98, v68, v69
    v_cvt_pk_bf16_f32 v99, v70, v71
    v_cvt_pk_bf16_f32 v100, v72, v73
    v_cvt_pk_bf16_f32 v101, v74, v75
    v_cvt_pk_bf16_f32 v102, v76, v77
    v_cvt_pk_bf16_f32 v103, v78, v79
    v_cndmask_b32_e64 v96, v96, v230, s[60:61]
    v_cndmask_b32_e64 v97, v97, v230, s[60:61]
    v_cndmask_b32_e64 v98, v98, v230, s[60:61]
    v_cndmask_b32_e64 v99, v99, v230, s[60:61]
    v_cndmask_b32_e64 v100, v100, v230, s[60:61]
    v_cndmask_b32_e64 v101, v101, v230, s[60:61]
    v_cndmask_b32_e64 v102, v102, v230, s[60:61]
    v_cndmask_b32_e64 v103, v103, v230, s[60:61]
    v_mul_f32 v80, v80, v160
    v_mul_f32 v81, v81, v161
    v_mul_f32 v82, v82, v162
    v_mul_f32 v83, v83, v163
    v_mul_f32 v84, v84, v164
    v_mul_f32 v85, v85, v165
    v_mul_f32 v86, v86, v166
    v_mul_f32 v87, v87, v167
    v_mul_f32 v88, v88, v168
    v_mul_f32 v89, v89, v169
    v_mul_f32 v90, v90, v170
    v_mul_f32 v91, v91, v171
    v_mul_f32 v92, v92, v172
    v_mul_f32 v93, v93, v173
    v_mul_f32 v94, v94, v174
    v_mul_f32 v95, v95, v175
    v_cvt_pk_bf16_f32 v104, v80, v81
    v_cvt_pk_bf16_f32 v105, v82, v83
    v_cvt_pk_bf16_f32 v106, v84, v85
    v_cvt_pk_bf16_f32 v107, v86, v87
    v_cvt_pk_bf16_f32 v108, v88, v89
    v_cvt_pk_bf16_f32 v109, v90, v91
    v_cvt_pk_bf16_f32 v110, v92, v93
    v_cvt_pk_bf16_f32 v111, v94, v95
    v_cndmask_b32_e64 v104, v104, v230, s[60:61]
    v_cndmask_b32_e64 v105, v105, v230, s[60:61]
    v_cndmask_b32_e64 v106, v106, v230, s[60:61]
    v_cndmask_b32_e64 v107, v107, v230, s[60:61]
    v_cndmask_b32_e64 v108, v108, v230, s[60:61]
    v_cndmask_b32_e64 v109, v109, v230, s[60:61]
    v_cndmask_b32_e64 v110, v110, v230, s[60:61]
    v_cndmask_b32_e64 v111, v111, v230, s[60:61]
    s_nop 1
    v_mfma_f32_32x32x16_bf16 v[0:15], v[124:127], v[96:99], 0
    v_mfma_f32_32x32x16_bf16 v[0:15], v[128:131], v[100:103], v[0:15]
    v_mfma_f32_32x32x16_bf16 v[16:31], v[116:119], v[104:107], 0
    v_mfma_f32_32x32x16_bf16 v[16:31], v[120:123], v[108:111], v[16:31]
    s_lshl_b32 s26, s80, 14
    s_add_u32 s26, s26, s77
    s_add_u32 s26, s26, 49152
    v_add_u32 v228, s26, v240
    s_lshl_b32 s26, s81, 14
    s_add_u32 s26, s26, s77
    s_add_u32 s26, s26, 49152
    v_add_u32 v229, s26, v240
    s_nop 7
    ds_write_b128 v228, v[0:3] offset:0
    ds_write_b128 v228, v[4:7] offset:1024
    ds_write_b128 v228, v[8:11] offset:2048
    ds_write_b128 v228, v[12:15] offset:3072
    ds_write_b128 v229, v[16:19] offset:0
    ds_write_b128 v229, v[20:23] offset:1024
    ds_write_b128 v229, v[24:27] offset:2048
    ds_write_b128 v229, v[28:31] offset:3072
    s_lshl_b32 s26, s23, 10
    s_add_u32 s26, s26, 49152
    v_add_u32 v227, s26, v240
    s_waitcnt lgkmcnt(0)
    s_barrier
    ds_read_b128 v[32:35], v227 offset:0
    ds_read_b128 v[36:39], v227 offset:4096
    ds_read_b128 v[40:43], v227 offset:8192
    ds_read_b128 v[44:47], v227 offset:12288
    ds_read_b128 v[48:51], v227 offset:16384
    ds_read_b128 v[52:55], v227 offset:20480
    ds_read_b128 v[56:59], v227 offset:24576
    ds_read_b128 v[60:63], v227 offset:28672
    s_waitcnt lgkmcnt(0)
    s_lshl_b32 s28, s82, 2
    s_add_u32 s28, s28, s23
    s_lshl_b32 s26, s28, 5
    s_add_u32 s26, s26, s20
    s_lshl_b32 s26, s26, 10
    s_add_u32 s26, s26, 9437184
    v_add_f32 v32, v32, v36
    v_add_f32 v33, v33, v37
    v_add_f32 v34, v34, v38
    v_add_f32 v35, v35, v39
    v_add_f32 v40, v40, v44
    v_add_f32 v41, v41, v45
    v_add_f32 v42, v42, v46
    v_add_f32 v43, v43, v47
    v_add_f32 v32, v32, v40
    v_add_f32 v33, v33, v41
    v_add_f32 v34, v34, v42
    v_add_f32 v35, v35, v43
    buffer_store_dwordx4 v[32:35], v240, s[12:15], s26 offen sc1
    s_add_u32 s26, s26, 16384
    v_add_f32 v48, v48, v52
    v_add_f32 v49, v49, v53
    v_add_f32 v50, v50, v54
    v_add_f32 v51, v51, v55
    v_add_f32 v56, v56, v60
    v_add_f32 v57, v57, v61
    v_add_f32 v58, v58, v62
    v_add_f32 v59, v59, v63
    v_add_f32 v48, v48, v56
    v_add_f32 v49, v49, v57
    v_add_f32 v50, v50, v58
    v_add_f32 v51, v51, v59
    buffer_store_dwordx4 v[48:51], v240, s[12:15], s26 offen sc1
    s_lshl_b32 s28, s28, 4
    s_add_u32 s28, s28, s20
    s_lshl_b32 s28, s28, 2
    s_add_u32 s28, s28, 11730944
    s_waitcnt vmcnt(0)
    buffer_store_dword v246, off, s[12:15], s28 offset:0 sc1
    s_cmp_ge_u32 s0, 224
    s_cbranch_scc1 K_RED
    s_barrier
    s_barrier
    s_branch P2_Y
W_RED:
    s_setpc_b64 s[30:31]
K_RED:
    s_and_b32 s28, s0, 7
    s_lshl_b32 s28, s28, 2
    s_lshr_b32 s29, s0, 3
    s_sub_u32 s29, s29, 28
    s_add_u32 s80, s28, s29
    s_cmp_ge_u32 s23, 2
    s_cbranch_scc1 K_REDX
    s_lshl_b32 s28, s80, 6
    s_add_u32 s28, s28, 11730944
    s_load_dwordx16 s[60:75], s[58:59], s28 offset:0 glc
    s_mov_b32 s27, 0
POL_16:
    s_waitcnt lgkmcnt(0)
    s_xor_b32 s60, s60, s79
    s_xor_b32 s61, s61, s79
    s_xor_b32 s62, s62, s79
    s_xor_b32 s63, s63, s79
    s_xor_b32 s64, s64, s79
    s_xor_b32 s65, s65, s79
    s_xor_b32 s66, s66, s79
    s_xor_b32 s67, s67, s79
    s_xor_b32 s68, s68, s79
    s_xor_b32 s69, s69, s79
    s_xor_b32 s70, s70, s79
    s_xor_b32 s71, s71, s79
    s_xor_b32 s72, s72, s79
    s_xor_b32 s73, s73, s79
    s_xor_b32 s74, s74, s79
    s_xor_b32 s75, s75, s79
    s_or_b64 s[60:61], s[60:61], s[68:69]
    s_or_b64 s[62:63], s[62:63], s[70:71]
    s_or_b64 s[64:65], s[64:65], s[72:73]
    s_or_b64 s[66:67], s[66:67], s[74:75]
    s_or_b64 s[60:61], s[60:61], s[64:65]
    s_or_b64 s[62:63], s[62:63], s[66:67]
    s_or_b64 s[60:61], s[60:61], s[62:63]
    s_or_b32 s60, s60, s61
    s_cbranch_scc0 POK_17
    s_add_u32 s27, s27, 1
    s_cmp_gt_u32 s27, 131072
    s_cbranch_scc1 POK_17
    s_sleep 2
    s_load_dwordx16 s[60:75], s[58:59], s28 offset:0 glc
    s_branch POL_16
POK_17:
    s_lshl_b32 s28, s80, 1
    s_add_u32 s28, s28, s23
    s_lshl_b32 s28, s28, 14
    s_add_u32 s81, s28, 9437184
    s_add_u32 s26, s81, 0
    buffer_load_dwordx4 v[32:35], v240, s[12:15], s26 offen offset:0 sc1
    buffer_load_dwordx4 v[36:39], v240, s[12:15], s26 offen offset:1024 sc1
    buffer_load_dwordx4 v[40:43], v240, s[12:15], s26 offen offset:2048 sc1
    buffer_load_dwordx4 v[44:47], v240, s[12:15], s26 offen offset:3072 sc1
    s_add_u32 s26, s81, 4096
    buffer_load_dwordx4 v[48:51], v240, s[12:15], s26 offen offset:0 sc1
    buffer_load_dwordx4 v[52:55], v240, s[12:15], s26 offen offset:1024 sc1
    buffer_load_dwordx4 v[56:59], v240, s[12:15], s26 offen offset:2048 sc1
    buffer_load_dwordx4 v[60:63], v240, s[12:15], s26 offen offset:3072 sc1
    s_add_u32 s26, s81, 8192
    buffer_load_dwordx4 v[64:67], v240, s[12:15], s26 offen offset:0 sc1
    buffer_load_dwordx4 v[68:71], v240, s[12:15], s26 offen offset:1024 sc1
    buffer_load_dwordx4 v[72:75], v240, s[12:15], s26 offen offset:2048 sc1
    buffer_load_dwordx4 v[76:79], v240, s[12:15], s26 offen offset:3072 sc1
    s_add_u32 s26, s81, 12288
    buffer_load_dwordx4 v[80:83], v240, s[12:15], s26 offen offset:0 sc1
    buffer_load_dwordx4 v[84:87], v240, s[12:15], s26 offen offset:1024 sc1
    buffer_load_dwordx4 v[88:91], v240, s[12:15], s26 offen offset:2048 sc1
    buffer_load_dwordx4 v[92:95], v240, s[12:15], s26 offen offset:3072 sc1
    s_waitcnt vmcnt(14)
    v_add_f32 v32, v32, v36
    v_add_f32 v33, v33, v37
    v_add_f32 v34, v34, v38
    v_add_f32 v35, v35, v39
    s_waitcnt vmcnt(13)
    v_add_f32 v32, v32, v40
    v_add_f32 v33, v33, v41
    v_add_f32 v34, v34, v42
    v_add_f32 v35, v35, v43
    s_waitcnt vmcnt(12)
    v_add_f32 v32, v32, v44
    v_add_f32 v33, v33, v45
    v_add_f32 v34, v34, v46
    v_add_f32 v35, v35, v47
    s_waitcnt vmcnt(11)
    v_add_f32 v32, v32, v48
    v_add_f32 v33, v33, v49
    v_add_f32 v34, v34, v50
    v_add_f32 v35, v35, v51
    s_waitcnt vmcnt(10)
    v_add_f32 v32, v32, v52
    v_add_f32 v33, v33, v53
    v_add_f32 v34, v34, v54
    v_add_f32 v35, v35, v55
    s_waitcnt vmcnt(9)
    v_add_f32 v32, v32, v56
    v_add_f32 v33, v33, v57
    v_add_f32 v34, v34, v58
    v_add_f32 v35, v35, v59
    s_waitcnt vmcnt(8)
    v_add_f32 v32, v32, v60
    v_add_f32 v33, v33, v61
    v_add_f32 v34, v34, v62
    v_add_f32 v35, v35, v63
    s_waitcnt vmcnt(7)
    v_add_f32 v32, v32, v64
    v_add_f32 v33, v33, v65
    v_add_f32 v34, v34, v66
    v_add_f32 v35, v35, v67
    s_waitcnt vmcnt(6)
    v_add_f32 v32, v32, v68
    v_add_f32 v33, v33, v69
    v_add_f32 v34, v34, v70
    v_add_f32 v35, v35, v71
    s_waitcnt vmcnt(5)
    v_add_f32 v32, v32, v72
    v_add_f32 v33, v33, v73
    v_add_f32 v34, v34, v74
    v_add_f32 v35, v35, v75
    s_waitcnt vmcnt(4)
    v_add_f32 v32, v32, v76
    v_add_f32 v33, v33, v77
    v_add_f32 v34, v34, v78
    v_add_f32 v35, v35, v79
    s_waitcnt vmcnt(3)
    v_add_f32 v32, v32, v80
    v_add_f32 v33, v33, v81
    v_add_f32 v34, v34, v82
    v_add_f32 v35, v35, v83
    s_waitcnt vmcnt(2)
    v_add_f32 v32, v32, v84
    v_add_f32 v33, v33, v85
    v_add_f32 v34, v34, v86
    v_add_f32 v35, v35, v87
    s_waitcnt vmcnt(1)
    v_add_f32 v32, v32, v88
    v_add_f32 v33, v33, v89
    v_add_f32 v34, v34, v90
    v_add_f32 v35, v35, v91
    s_waitcnt vmcnt(0)
    v_add_f32 v32, v32, v92
    v_add_f32 v33, v33, v93
    v_add_f32 v34, v34, v94
    v_add_f32 v35, v35, v95
    v_cvt_pk_bf16_f32 v8, v32, v33
    v_cvt_pk_bf16_f32 v9, v34, v35
    s_and_b32 s29, s80, 3
    s_cmp_eq_u32 s29, 3
    s_cselect_b32 s35, -1, 0
    v_cndmask_b32_e64 v8, v8, 0, s[34:35]
    v_cndmask_b32_e64 v9, v9, 0, s[34:35]
    s_lshr_b32 s26, s80, 2
    s_lshl_b32 s26, s26, 1
    s_add_u32 s26, s26, s23
    s_lshl_b32 s26, s26, 1
    s_lshr_b32 s27, s29, 1
    s_add_u32 s26, s26, s27
    s_lshl_b32 s26, s26, 10
    s_and_b32 s27, s29, 1
    s_lshl_b32 s27, s27, 3
    s_add_u32 s26, s26, s27
    s_add_u32 s26, s26, 11534336
    buffer_store_dwordx2 v[8:9], v240, s[12:15], s26 offen sc1
    v_mov_b32 v10, 161280
    v_mov_b32 v11, 1
    v_lshlrev_b32 v12, 7, v241
    s_lshl_b32 s28, s80, 2
    s_add_u32 s28, s28, 11665408
    s_waitcnt vmcnt(0)
    s_mov_b64 exec, 1
    ds_add_rtn_u32 v13, v10, v11
    s_waitcnt lgkmcnt(0)
    s_mov_b64 exec, -1
    v_readfirstlane_b32 s26, v13
    s_nop 0
    s_cmp_lg_u32 s26, 1
    s_cbranch_scc1 K_REDX
    buffer_store_dword v246, v12, s[12:15], s28 offen sc1
    s_add_u32 s28, s28, 8192
    buffer_store_dword v246, v12, s[12:15], s28 offen sc1
    s_add_u32 s28, s28, 8192
    buffer_store_dword v246, v12, s[12:15], s28 offen sc1
    s_add_u32 s28, s28, 8192
    buffer_store_dword v246, v12, s[12:15], s28 offen sc1
K_REDX:
    s_endpgm
K1_A_H:
    s_cmp_lg_u32 s22, 0
    s_cbranch_scc1 TKD_18
    s_mov_b32 s26, s2
    v_mov_b32 v225, s26
    v_mov_b32 v224, 161280
    ds_write_b32 v224, v247
    ds_write_b32 v224, v225 offset:16
    s_waitcnt lgkmcnt(0)
TKD_18:
    v_bfe_u32 v224, v241, 4, 1
    v_lshlrev_b32 v224, 5, v224
    v_and_b32 v227, 3, v241
    v_lshl_add_u32 v224, v227, 3, v224
    v_bfe_u32 v225, v241, 2, 2
    v_lshrrev_b32 v226, 5, v241
    v_lshl_add_u32 v226, v226, 3, v225
    v_lshlrev_b32 v226, 8, v226
    s_lshl_b32 s26, s23, 5
    v_add_u32 v227, s26, v243
    v_bfe_u32 v228, v227, 1, 3
    v_lshrrev_b32 v229, 5, v241
    v_xor_b32 v228, v228, v229
    v_lshlrev_b32 v228, 4, v228
    v_lshl_add_u32 v136, v227, 7, v228
    v_xor_b32 v137, 32, v136
    v_xor_b32 v138, 64, v136
    v_xor_b32 v139, 96, v136
    s_add_u32 s28, s23, 0
    s_and_b32 s28, s28, 3
    s_lshl_b32 s28, s28, 6
    v_add_u32 v227, s28, v224
    v_lshrrev_b32 v228, 6, v227
    v_xor_b32 v228, v228, v225
    v_lshlrev_b32 v228, 6, v228
    v_and_b32 v227, 63, v227
    v_add3_u32 v140, v228, v227, v226
    s_add_u32 s28, s23, 1
    s_and_b32 s28, s28, 3
    s_lshl_b32 s28, s28, 6
    v_add_u32 v227, s28, v224
    v_lshrrev_b32 v228, 6, v227
    v_xor_b32 v228, v228, v225
    v_lshlrev_b32 v228, 6, v228
    v_and_b32 v227, 63, v227
    v_add3_u32 v141, v228, v227, v226
    s_add_u32 s28, s23, 2
    s_and_b32 s28, s28, 3
    s_lshl_b32 s28, s28, 6
    v_add_u32 v227, s28, v224
    v_lshrrev_b32 v228, 6, v227
    v_xor_b32 v228, v228, v225
    v_lshlrev_b32 v228, 6, v228
    v_and_b32 v227, 63, v227
    v_add3_u32 v142, v228, v227, v226
    s_add_u32 s28, s23, 3
    s_and_b32 s28, s28, 3
    s_lshl_b32 s28, s28, 6
    v_add_u32 v227, s28, v224
    v_lshrrev_b32 v228, 6, v227
    v_xor_b32 v228, v228, v225
    v_lshlrev_b32 v228, 6, v228
    v_and_b32 v227, 63, v227
    v_add3_u32 v143, v228, v227, v226
    s_mul_i32 s26, s21, 7
    s_and_b32 s27, s21, 1
    s_add_u32 s28, s23, 0
    s_and_b32 s28, s28, 3
    s_add_u32 s28, s28, s27
    s_add_u32 s80, s28, s26
    s_add_u32 s28, s23, 1
    s_and_b32 s28, s28, 3
    s_add_u32 s28, s28, s27
    s_add_u32 s81, s28, s26
    s_add_u32 s28, s23, 2
    s_and_b32 s28, s28, 3
    s_add_u32 s28, s28, s27
    s_add_u32 s82, s28, s26
    s_add_u32 s28, s23, 3
    s_and_b32 s28, s28, 3
    s_add_u32 s28, s28, s27
    s_add_u32 s83, s28, s26
    s_lshl_b32 s26, s80, 6
    v_lshlrev_b32 v230, 1, v243
    buffer_load_ushort v176, v230, s[16:19], s26 offen
    s_lshl_b32 s26, s81, 6
    v_lshlrev_b32 v230, 1, v243
    buffer_load_ushort v177, v230, s[16:19], s26 offen
    s_lshl_b32 s26, s82, 6
    v_lshlrev_b32 v230, 1, v243
    buffer_load_ushort v178, v230, s[16:19], s26 offen
    s_lshl_b32 s26, s83, 6
    v_lshlrev_b32 v230, 1, v243
    buffer_load_ushort v179, v230, s[16:19], s26 offen
    s_lshr_b32 s26, s87, 1
    s_lshl_b32 s26, s26, 2
    s_lshr_b32 s27, s21, 1
    s_add_u32 s26, s26, s27
    s_lshl_b32 s26, s26, 7
    s_and_b32 s27, s87, 1
    s_lshl_b32 s27, s27, 1
    s_add_u32 s26, s26, s27
    s_and_b32 s27, s21, 1
    s_add_u32 s26, s26, s27
    s_lshl_b32 s26, s26, 2
    s_add_u32 s51, s26, 11599872
    v_add_u32 v144, 65536, v136
    v_add_u32 v192, 65536, v140
    v_add_u32 v145, 65536, v137
    v_add_u32 v193, 65536, v141
    v_add_u32 v146, 65536, v138
    v_add_u32 v194, 65536, v142
    v_add_u32 v147, 65536, v139
    v_add_u32 v195, 65536, v143
    v_add_u32 v148, 131072, v136
    v_add_u32 v184, 131072, v140
    v_add_u32 v149, 131072, v137
    v_add_u32 v185, 131072, v141
    v_add_u32 v150, 131072, v138
    v_add_u32 v186, 131072, v142
    v_add_u32 v151, 131072, v139
    v_add_u32 v187, 131072, v143
    s_lshl_b32 s74, s23, 7
    s_add_u32 s74, s74, 155648
    s_add_u32 s28, s23, 0
    s_and_b32 s28, s28, 3
    s_lshl_b32 s26, s28, 7
    s_add_u32 s26, s26, 155648
    v_lshl_add_u32 v188, v243, 2, s26
    s_add_u32 s28, s23, 1
    s_and_b32 s28, s28, 3
    s_lshl_b32 s26, s28, 7
    s_add_u32 s26, s26, 155648
    v_lshl_add_u32 v189, v243, 2, s26
    s_add_u32 s28, s23, 2
    s_and_b32 s28, s28, 3
    s_lshl_b32 s26, s28, 7
    s_add_u32 s26, s26, 155648
    v_lshl_add_u32 v190, v243, 2, s26
    s_add_u32 s28, s23, 3
    s_and_b32 s28, s28, 3
    s_lshl_b32 s26, s28, 7
    s_add_u32 s26, s26, 155648
    v_lshl_add_u32 v191, v243, 2, s26
    v_and_b32 v230, 15, v241
    v_lshrrev_b32 v231, 4, v241
    v_lshlrev_b32 v230, 6, v230
    v_lshl_add_u32 v230, v231, 4, v230
    v_add_u32 v157, s74, v230
    s_lshl_b32 s26, s87, 9
    s_add_u32 s26, s26, 11698176
    v_lshl_add_u32 v156, v243, 4, s26
    v_mov_b32 v155, 0
    s_mul_i32 s46, s23, 20480
    v_lshrrev_b32 v224, 3, v241
    v_mul_u32_u24 v225, 896, v224
    v_bfe_u32 v226, v241, 4, 1
    v_lshlrev_b32 v226, 2, v226
    v_and_b32 v227, 7, v241
    v_xor_b32 v226, v226, v227
    v_lshl_add_u32 v204, v226, 4, v225
    v_lshl_add_u32 v210, v227, 4, v225
    v_lshlrev_b32 v227, 1, v227
    v_xor_b32 v227, v227, v224
    v_lshlrev_b32 v227, 4, v227
    v_lshl_add_u32 v197, v224, 8, v227
    s_lshl_b32 s26, s23, 11
    v_add_u32 v197, s26, v197
    v_bfe_u32 v224, v241, 2, 2
    v_lshrrev_b32 v225, 5, v241
    v_lshl_add_u32 v225, v225, 2, v224
    v_lshlrev_b32 v225, 7, v225
    v_bfe_u32 v226, v241, 4, 1
    v_lshl_add_u32 v225, v226, 5, v225
    v_and_b32 v226, 3, v241
    v_lshl_add_u32 v225, v226, 3, v225
    v_add_u32 v225, s46, v225
    v_bfe_u32 v226, v241, 3, 1
    v_lshl_add_u32 v206, v226, 6, v225
    v_xor_b32 v207, 64, v206
    v_lshrrev_b32 v224, 5, v241
    v_and_b32 v225, 7, v241
    v_xor_b32 v224, v224, v225
    v_lshlrev_b32 v224, 4, v224
    v_lshl_add_u32 v224, v243, 8, v224
    v_add_u32 v205, s46, v224
    s_mov_b32 s8, s52
    s_mov_b32 s9, s53
    s_mov_b32 s10, 1605632
    s_mov_b32 s11, 0x20000
    s_mov_b32 s4, s40
    s_mov_b32 s5, s41
    s_mov_b32 s6, 1835008
    s_mov_b32 s7, 0x20000
    v_mov_b32 v158, 161296
    s_barrier
    ds_read_b32 v159, v158
    ds_read_b128 v[96:99], v136 offset:0
    ds_read_b64_tr_b16 v[100:101], v140 offset:16384
    ds_read_b64_tr_b16 v[102:103], v140 offset:17408
    ds_read_b64_tr_b16 v[104:105], v141 offset:16384
    ds_read_b64_tr_b16 v[106:107], v141 offset:17408
    ds_read_b64_tr_b16 v[108:109], v142 offset:16384
    ds_read_b64_tr_b16 v[110:111], v142 offset:17408
    ds_read_b64_tr_b16 v[112:113], v143 offset:16384
    ds_read_b64_tr_b16 v[114:115], v143 offset:17408
    s_waitcnt lgkmcnt(6)
    v_mfma_f32_32x32x16_bf16 v[32:47], v[100:103], v[96:99], 0
    v_mfma_f32_16x16x32_bf16 v[220:223], v[100:103], v[216:219], v[220:223]
    ds_read_b128 v[116:119], v137 offset:0
    ds_read_b64_tr_b16 v[120:121], v140 offset:20480
    ds_read_b64_tr_b16 v[122:123], v140 offset:21504
    s_waitcnt lgkmcnt(7)
    v_mfma_f32_32x32x16_bf16 v[48:63], v[104:107], v[96:99], 0
    ds_read_b64_tr_b16 v[124:125], v141 offset:20480
    ds_read_b64_tr_b16 v[126:127], v141 offset:21504
    v_readfirstlane_b32 s0, v159
    s_nop 0
    s_waitcnt lgkmcnt(7)
    v_mfma_f32_32x32x16_bf16 v[64:79], v[108:111], v[96:99], 0
    ds_read_b64_tr_b16 v[128:129], v142 offset:20480
    ds_read_b64_tr_b16 v[130:131], v142 offset:21504
    s_lshr_b32 s27, s0, 3
    s_mul_i32 s28, s27, 37
    s_waitcnt lgkmcnt(7)
    v_mfma_f32_32x32x16_bf16 v[80:95], v[112:115], v[96:99], 0
    ds_read_b64_tr_b16 v[132:133], v143 offset:20480
    ds_read_b64_tr_b16 v[134:135], v143 offset:21504
    s_lshr_b32 s28, s28, 8
    s_mul_i32 s26, s28, 7
    s_waitcnt lgkmcnt(6)
    v_mfma_f32_32x32x16_bf16 v[32:47], v[120:123], v[116:119], v[32:47]
    v_mfma_f32_16x16x32_bf16 v[220:223], v[120:123], v[216:219], v[220:223]
    ds_read_b128 v[96:99], v138 offset:0
    ds_read_b64_tr_b16 v[100:101], v140 offset:24576
    ds_read_b64_tr_b16 v[102:103], v140 offset:25600
    s_waitcnt lgkmcnt(7)
    v_mfma_f32_32x32x16_bf16 v[48:63], v[124:127], v[116:119], v[48:63]
    ds_read_b64_tr_b16 v[104:105], v141 offset:24576
    ds_read_b64_tr_b16 v[106:107], v141 offset:25600
    s_sub_u32 s25, s27, s26
    s_and_b32 s26, s0, 7
    s_waitcnt lgkmcnt(7)
    v_mfma_f32_32x32x16_bf16 v[64:79], v[128:131], v[116:119], v[64:79]
    ds_read_b64_tr_b16 v[108:109], v142 offset:24576
    ds_read_b64_tr_b16 v[110:111], v142 offset:25600
    s_lshl_b32 s24, s26, 2
    s_add_u32 s24, s24, s28
    s_waitcnt lgkmcnt(7)
    v_mfma_f32_32x32x16_bf16 v[80:95], v[132:135], v[116:119], v[80:95]
    ds_read_b64_tr_b16 v[112:113], v143 offset:24576
    ds_read_b64_tr_b16 v[114:115], v143 offset:25600
    s_lshl_b32 s26, s24, 3
    s_add_u32 s26, s26, s23
    s_waitcnt lgkmcnt(6)
    v_mfma_f32_32x32x16_bf16 v[32:47], v[100:103], v[96:99], v[32:47]
    v_mfma_f32_16x16x32_bf16 v[220:223], v[100:103], v[216:219], v[220:223]
    ds_read_b128 v[116:119], v139 offset:0
    ds_read_b64_tr_b16 v[120:121], v140 offset:28672
    ds_read_b64_tr_b16 v[122:123], v140 offset:29696
    s_waitcnt lgkmcnt(7)
    v_mfma_f32_32x32x16_bf16 v[48:63], v[104:107], v[96:99], v[48:63]
    ds_read_b64_tr_b16 v[124:125], v141 offset:28672
    ds_read_b64_tr_b16 v[126:127], v141 offset:29696
    s_mul_i32 s50, s26, 7168
    s_lshl_b32 s43, s25, 7
    s_waitcnt lgkmcnt(7)
    v_mfma_f32_32x32x16_bf16 v[64:79], v[108:111], v[96:99], v[64:79]
    ds_read_b64_tr_b16 v[128:129], v142 offset:28672
    ds_read_b64_tr_b16 v[130:131], v142 offset:29696
    s_add_u32 s50, s50, s43
    s_lshl_b32 s49, s24, 2
    s_waitcnt lgkmcnt(7)
    v_mfma_f32_32x32x16_bf16 v[80:95], v[112:115], v[96:99], v[80:95]
    ds_read_b64_tr_b16 v[132:133], v143 offset:28672
    ds_read_b64_tr_b16 v[134:135], v143 offset:29696
    s_add_u32 s49, s49, s23
    s_lshl_b32 s49, s49, 3
    s_waitcnt lgkmcnt(6)
    v_mfma_f32_32x32x16_bf16 v[32:47], v[120:123], v[116:119], v[32:47]
    v_mfma_f32_16x16x32_bf16 v[220:223], v[120:123], v[216:219], v[220:223]
    s_barrier
    ds_read_b128 v[96:99], v136 offset:32768
    ds_read_b64_tr_b16 v[100:101], v140 offset:49152
    ds_read_b64_tr_b16 v[102:103], v140 offset:50176
    s_waitcnt lgkmcnt(7)
    v_mfma_f32_32x32x16_bf16 v[48:63], v[124:127], v[116:119], v[48:63]
    ds_read_b64_tr_b16 v[104:105], v141 offset:49152
    ds_read_b64_tr_b16 v[106:107], v141 offset:50176
    s_add_u32 s49, s49, s25
    s_lshl_b32 s49, s49, 6
    s_waitcnt lgkmcnt(7)
    v_mfma_f32_32x32x16_bf16 v[64:79], v[128:131], v[116:119], v[64:79]
    ds_read_b64_tr_b16 v[108:109], v142 offset:49152
    ds_read_b64_tr_b16 v[110:111], v142 offset:50176
    s_add_u32 s49, s49, 11599872
    s_mul_i32 s26, s23, 100352
    s_waitcnt lgkmcnt(7)
    v_mfma_f32_32x32x16_bf16 v[80:95], v[132:135], v[116:119], v[80:95]
    ds_read_b64_tr_b16 v[112:113], v143 offset:49152
    ds_read_b64_tr_b16 v[114:115], v143 offset:50176
    s_add_u32 s75, s43, s26
    s_mul_i32 s42, s24, 229376
    s_waitcnt lgkmcnt(6)
    v_mfma_f32_32x32x16_bf16 v[32:47], v[100:103], v[96:99], v[32:47]
    v_mfma_f32_16x16x32_bf16 v[220:223], v[100:103], v[216:219], v[220:223]
    ds_read_b128 v[116:119], v137 offset:32768
    ds_read_b64_tr_b16 v[120:121], v140 offset:53248
    ds_read_b64_tr_b16 v[122:123], v140 offset:54272
    s_waitcnt lgkmcnt(7)
    v_mfma_f32_32x32x16_bf16 v[48:63], v[104:107], v[96:99], v[48:63]
    ds_read_b64_tr_b16 v[124:125], v141 offset:53248
    ds_read_b64_tr_b16 v[126:127], v141 offset:54272
    s_mul_i32 s26, s23, 28672
    s_add_u32 s42, s42, s26
    s_waitcnt lgkmcnt(7)
    v_mfma_f32_32x32x16_bf16 v[64:79], v[108:111], v[96:99], v[64:79]
    ds_read_b64_tr_b16 v[128:129], v142 offset:53248
    ds_read_b64_tr_b16 v[130:131], v142 offset:54272
    s_mul_i32 s26, s23, 401408
    s_add_u32 s43, s43, s26
    s_waitcnt lgkmcnt(7)
    v_mfma_f32_32x32x16_bf16 v[80:95], v[112:115], v[96:99], v[80:95]
    ds_read_b64_tr_b16 v[132:133], v143 offset:53248
    ds_read_b64_tr_b16 v[134:135], v143 offset:54272
    s_lshr_b32 s26, s24, 1
    s_lshl_b32 s26, s26, 2
    s_waitcnt lgkmcnt(6)
    v_mfma_f32_32x32x16_bf16 v[32:47], v[120:123], v[116:119], v[32:47]
    v_mfma_f32_16x16x32_bf16 v[220:223], v[120:123], v[216:219], v[220:223]
    ds_read_b128 v[96:99], v138 offset:32768
    ds_read_b64_tr_b16 v[100:101], v140 offset:57344
    ds_read_b64_tr_b16 v[102:103], v140 offset:58368
    s_waitcnt lgkmcnt(7)
    v_mfma_f32_32x32x16_bf16 v[48:63], v[124:127], v[116:119], v[48:63]
    ds_read_b64_tr_b16 v[104:105], v141 offset:57344
    ds_read_b64_tr_b16 v[106:107], v141 offset:58368
    s_add_u32 s26, s26, s25
    s_and_b32 s26, s26, 7
    s_waitcnt lgkmcnt(7)
    v_mfma_f32_32x32x16_bf16 v[64:79], v[128:131], v[116:119], v[64:79]
    ds_read_b64_tr_b16 v[108:109], v142 offset:57344
    ds_read_b64_tr_b16 v[110:111], v142 offset:58368
    s_mul_i32 s26, s26, 0x11111111
    s_xor_b32 s26, s26, 0x76543210
    s_waitcnt lgkmcnt(7)
    v_mfma_f32_32x32x16_bf16 v[80:95], v[132:135], v[116:119], v[80:95]
    ds_read_b64_tr_b16 v[112:113], v143 offset:57344
    ds_read_b64_tr_b16 v[114:115], v143 offset:58368
    s_and_b32 s27, s26, 0x44444444
    s_lshl_b32 s27, s27, 1
    s_waitcnt lgkmcnt(6)
    v_mfma_f32_32x32x16_bf16 v[32:47], v[100:103], v[96:99], v[32:47]
    v_mfma_f32_16x16x32_bf16 v[220:223], v[100:103], v[216:219], v[220:223]
    ds_read_b128 v[116:119], v139 offset:32768
    ds_read_b64_tr_b16 v[120:121], v140 offset:61440
    ds_read_b64_tr_b16 v[122:123], v140 offset:62464
    s_waitcnt lgkmcnt(7)
    v_mfma_f32_32x32x16_bf16 v[48:63], v[104:107], v[96:99], v[48:63]
    ds_read_b64_tr_b16 v[124:125], v141 offset:61440
    ds_read_b64_tr_b16 v[126:127], v141 offset:62464
    s_and_b32 s26, s26, 0x33333333
    s_and_b32 s28, s24, 1
    s_waitcnt lgkmcnt(7)
    v_mfma_f32_32x32x16_bf16 v[64:79], v[108:111], v[96:99], v[64:79]
    ds_read_b64_tr_b16 v[128:129], v142 offset:61440
    ds_read_b64_tr_b16 v[130:131], v142 offset:62464
    s_mul_i32 s28, s28, 0x44444444
    s_add_u32 s26, s26, s28
    s_waitcnt lgkmcnt(7)
    v_mfma_f32_32x32x16_bf16 v[80:95], v[112:115], v[96:99], v[80:95]
    ds_read_b64_tr_b16 v[132:133], v143 offset:61440
    ds_read_b64_tr_b16 v[134:135], v143 offset:62464
    s_add_u32 s26, s26, 0x22222222
    s_and_b32 s47, s26, 0x77777777
    s_waitcnt lgkmcnt(6)
    v_mfma_f32_32x32x16_bf16 v[32:47], v[120:123], v[116:119], v[32:47]
    v_mfma_f32_16x16x32_bf16 v[220:223], v[120:123], v[216:219], v[220:223]
    s_barrier
    ds_read_b128 v[96:99], v144 offset:0
    ds_read_b64_tr_b16 v[100:101], v192 offset:16384
    ds_read_b64_tr_b16 v[102:103], v192 offset:17408
    s_waitcnt lgkmcnt(7)
    v_mfma_f32_32x32x16_bf16 v[48:63], v[124:127], v[116:119], v[48:63]
    ds_read_b64_tr_b16 v[104:105], v193 offset:16384
    ds_read_b64_tr_b16 v[106:107], v193 offset:17408
    s_or_b32 s47, s47, s27
    s_xor_b32 s1, s47, 0x44444444
    s_waitcnt lgkmcnt(7)
    v_mfma_f32_32x32x16_bf16 v[64:79], v[128:131], v[116:119], v[64:79]
    ds_read_b64_tr_b16 v[108:109], v194 offset:16384
    ds_read_b64_tr_b16 v[110:111], v194 offset:17408
    s_add_u32 s26, s24, s25
    s_and_b32 s26, s26, 3
    s_waitcnt lgkmcnt(7)
    v_mfma_f32_32x32x16_bf16 v[80:95], v[132:135], v[116:119], v[80:95]
    ds_read_b64_tr_b16 v[112:113], v195 offset:16384
    ds_read_b64_tr_b16 v[114:115], v195 offset:17408
    s_lshl_b32 s48, s26, 10
    s_waitcnt lgkmcnt(6)
    v_mfma_f32_32x32x16_bf16 v[32:47], v[100:103], v[96:99], v[32:47]
    v_mfma_f32_16x16x32_bf16 v[220:223], v[100:103], v[216:219], v[220:223]
    ds_read_b128 v[116:119], v145 offset:0
    ds_read_b64_tr_b16 v[120:121], v192 offset:20480
    ds_read_b64_tr_b16 v[122:123], v192 offset:21504
    s_waitcnt lgkmcnt(7)
    v_mfma_f32_32x32x16_bf16 v[48:63], v[104:107], v[96:99], v[48:63]
    ds_read_b64_tr_b16 v[124:125], v193 offset:20480
    ds_read_b64_tr_b16 v[126:127], v193 offset:21504
    s_waitcnt lgkmcnt(7)
    v_mfma_f32_32x32x16_bf16 v[64:79], v[108:111], v[96:99], v[64:79]
    ds_read_b64_tr_b16 v[128:129], v194 offset:20480
    ds_read_b64_tr_b16 v[130:131], v194 offset:21504
    s_waitcnt lgkmcnt(7)
    v_mfma_f32_32x32x16_bf16 v[80:95], v[112:115], v[96:99], v[80:95]
    ds_read_b64_tr_b16 v[132:133], v195 offset:20480
    ds_read_b64_tr_b16 v[134:135], v195 offset:21504
    s_waitcnt lgkmcnt(6)
    v_mfma_f32_32x32x16_bf16 v[32:47], v[120:123], v[116:119], v[32:47]
    v_mfma_f32_16x16x32_bf16 v[220:223], v[120:123], v[216:219], v[220:223]
    ds_read_b128 v[96:99], v146 offset:0
    ds_read_b64_tr_b16 v[100:101], v192 offset:24576
    ds_read_b64_tr_b16 v[102:103], v192 offset:25600
    s_waitcnt lgkmcnt(7)
    v_mfma_f32_32x32x16_bf16 v[48:63], v[124:127], v[116:119], v[48:63]
    ds_read_b64_tr_b16 v[104:105], v193 offset:24576
    ds_read_b64_tr_b16 v[106:107], v193 offset:25600
    s_waitcnt lgkmcnt(7)
    v_mfma_f32_32x32x16_bf16 v[64:79], v[128:131], v[116:119], v[64:79]
    ds_read_b64_tr_b16 v[108:109], v194 offset:24576
    ds_read_b64_tr_b16 v[110:111], v194 offset:25600
    s_lshl_b32 s26, s2, 2
    s_add_u32 s26, s26, s23
    s_mul_i32 s27, s26, 1568
    buffer_load_dwordx4 v[164:167], v240, s[8:11], s27 offen
    buffer_load_dwordx4 v[168:171], v240, s[8:11], s27 offen offset:1024
    s_min_u32 s26, s26, 783
    s_lshl_b32 s26, s26, 9
    v_lshrrev_b32 v224, 1, v240
    v_add_u32 v224, s26, v224
    global_load_dwordx2 v[172:173], v224, s[44:45]
    s_waitcnt lgkmcnt(7)
    v_mfma_f32_32x32x16_bf16 v[80:95], v[132:135], v[116:119], v[80:95]
    ds_read_b64_tr_b16 v[112:113], v195 offset:24576
    ds_read_b64_tr_b16 v[114:115], v195 offset:25600
    s_waitcnt lgkmcnt(6)
    v_mfma_f32_32x32x16_bf16 v[32:47], v[100:103], v[96:99], v[32:47]
    v_mfma_f32_16x16x32_bf16 v[220:223], v[100:103], v[216:219], v[220:223]
    ds_read_b128 v[116:119], v147 offset:0
    ds_read_b64_tr_b16 v[120:121], v192 offset:28672
    ds_read_b64_tr_b16 v[122:123], v192 offset:29696
    s_waitcnt lgkmcnt(7)
    v_mfma_f32_32x32x16_bf16 v[48:63], v[104:107], v[96:99], v[48:63]
    ds_read_b64_tr_b16 v[124:125], v193 offset:28672
    ds_read_b64_tr_b16 v[126:127], v193 offset:29696
    s_waitcnt lgkmcnt(7)
    v_mfma_f32_32x32x16_bf16 v[64:79], v[108:111], v[96:99], v[64:79]
    ds_read_b64_tr_b16 v[128:129], v194 offset:28672
    ds_read_b64_tr_b16 v[130:131], v194 offset:29696
    s_waitcnt lgkmcnt(7)
    v_mfma_f32_32x32x16_bf16 v[80:95], v[112:115], v[96:99], v[80:95]
    ds_read_b64_tr_b16 v[132:133], v195 offset:28672
    ds_read_b64_tr_b16 v[134:135], v195 offset:29696
    s_waitcnt lgkmcnt(6)
    v_mfma_f32_32x32x16_bf16 v[32:47], v[120:123], v[116:119], v[32:47]
    v_mfma_f32_16x16x32_bf16 v[220:223], v[120:123], v[216:219], v[220:223]
    s_barrier
    ds_read_b128 v[96:99], v144 offset:32768
    ds_read_b64_tr_b16 v[100:101], v192 offset:49152
    ds_read_b64_tr_b16 v[102:103], v192 offset:50176
    s_waitcnt lgkmcnt(7)
    v_mfma_f32_32x32x16_bf16 v[48:63], v[124:127], v[116:119], v[48:63]
    ds_read_b64_tr_b16 v[104:105], v193 offset:49152
    ds_read_b64_tr_b16 v[106:107], v193 offset:50176
    s_waitcnt lgkmcnt(7)
    v_mfma_f32_32x32x16_bf16 v[64:79], v[128:131], v[116:119], v[64:79]
    ds_read_b64_tr_b16 v[108:109], v194 offset:49152
    ds_read_b64_tr_b16 v[110:111], v194 offset:50176
    s_waitcnt lgkmcnt(7)
    v_mfma_f32_32x32x16_bf16 v[80:95], v[132:135], v[116:119], v[80:95]
    ds_read_b64_tr_b16 v[112:113], v195 offset:49152
    ds_read_b64_tr_b16 v[114:115], v195 offset:50176
    s_waitcnt lgkmcnt(6)
    v_mfma_f32_32x32x16_bf16 v[32:47], v[100:103], v[96:99], v[32:47]
    v_mfma_f32_16x16x32_bf16 v[220:223], v[100:103], v[216:219], v[220:223]
    ds_read_b128 v[116:119], v145 offset:32768
    ds_read_b64_tr_b16 v[120:121], v192 offset:53248
    ds_read_b64_tr_b16 v[122:123], v192 offset:54272
    s_waitcnt lgkmcnt(7)
    v_mfma_f32_32x32x16_bf16 v[48:63], v[104:107], v[96:99], v[48:63]
    ds_read_b64_tr_b16 v[124:125], v193 offset:53248
    ds_read_b64_tr_b16 v[126:127], v193 offset:54272
    s_waitcnt lgkmcnt(7)
    v_mfma_f32_32x32x16_bf16 v[64:79], v[108:111], v[96:99], v[64:79]
    ds_read_b64_tr_b16 v[128:129], v194 offset:53248
    ds_read_b64_tr_b16 v[130:131], v194 offset:54272
    s_waitcnt lgkmcnt(7)
    v_mfma_f32_32x32x16_bf16 v[80:95], v[112:115], v[96:99], v[80:95]
    ds_read_b64_tr_b16 v[132:133], v195 offset:53248
    ds_read_b64_tr_b16 v[134:135], v195 offset:54272
    s_waitcnt lgkmcnt(6)
    v_mfma_f32_32x32x16_bf16 v[32:47], v[120:123], v[116:119], v[32:47]
    v_mfma_f32_16x16x32_bf16 v[220:223], v[120:123], v[216:219], v[220:223]
    ds_read_b128 v[96:99], v146 offset:32768
    ds_read_b64_tr_b16 v[100:101], v192 offset:57344
    ds_read_b64_tr_b16 v[102:103], v192 offset:58368
    s_waitcnt lgkmcnt(7)
    v_mfma_f32_32x32x16_bf16 v[48:63], v[124:127], v[116:119], v[48:63]
    ds_read_b64_tr_b16 v[104:105], v193 offset:57344
    ds_read_b64_tr_b16 v[106:107], v193 offset:58368
    s_waitcnt lgkmcnt(7)
    v_mfma_f32_32x32x16_bf16 v[64:79], v[128:131], v[116:119], v[64:79]
    ds_read_b64_tr_b16 v[108:109], v194 offset:57344
    ds_read_b64_tr_b16 v[110:111], v194 offset:58368
    s_waitcnt lgkmcnt(7)
    v_mfma_f32_32x32x16_bf16 v[80:95], v[132:135], v[116:119], v[80:95]
    ds_read_b64_tr_b16 v[112:113], v195 offset:57344
    ds_read_b64_tr_b16 v[114:115], v195 offset:58368
    s_waitcnt lgkmcnt(6)
    v_mfma_f32_32x32x16_bf16 v[32:47], v[100:103], v[96:99], v[32:47]
    v_mfma_f32_16x16x32_bf16 v[220:223], v[100:103], v[216:219], v[220:223]
    ds_read_b128 v[116:119], v147 offset:32768
    ds_read_b64_tr_b16 v[120:121], v192 offset:61440
    ds_read_b64_tr_b16 v[122:123], v192 offset:62464
    s_waitcnt lgkmcnt(7)
    v_mfma_f32_32x32x16_bf16 v[48:63], v[104:107], v[96:99], v[48:63]
    ds_read_b64_tr_b16 v[124:125], v193 offset:61440
    ds_read_b64_tr_b16 v[126:127], v193 offset:62464
    s_waitcnt lgkmcnt(7)
    v_mfma_f32_32x32x16_bf16 v[64:79], v[108:111], v[96:99], v[64:79]
    ds_read_b64_tr_b16 v[128:129], v194 offset:61440
    ds_read_b64_tr_b16 v[130:131], v194 offset:62464
    s_waitcnt lgkmcnt(7)
    v_mfma_f32_32x32x16_bf16 v[80:95], v[112:115], v[96:99], v[80:95]
    ds_read_b64_tr_b16 v[132:133], v195 offset:61440
    ds_read_b64_tr_b16 v[134:135], v195 offset:62464
    s_waitcnt lgkmcnt(6)
    v_mfma_f32_32x32x16_bf16 v[32:47], v[120:123], v[116:119], v[32:47]
    v_mfma_f32_16x16x32_bf16 v[220:223], v[120:123], v[216:219], v[220:223]
    s_barrier
    ds_read_b128 v[96:99], v148 offset:0
    ds_read_b64_tr_b16 v[100:101], v140 offset:0
    ds_read_b64_tr_b16 v[102:103], v140 offset:1024
    s_waitcnt lgkmcnt(7)
    v_mfma_f32_32x32x16_bf16 v[48:63], v[124:127], v[116:119], v[48:63]
    ds_read_b64_tr_b16 v[104:105], v141 offset:0
    ds_read_b64_tr_b16 v[106:107], v141 offset:1024
    s_waitcnt lgkmcnt(7)
    v_mfma_f32_32x32x16_bf16 v[64:79], v[128:131], v[116:119], v[64:79]
    ds_read_b64_tr_b16 v[108:109], v142 offset:0
    ds_read_b64_tr_b16 v[110:111], v142 offset:1024
    s_waitcnt lgkmcnt(7)
    v_mfma_f32_32x32x16_bf16 v[80:95], v[132:135], v[116:119], v[80:95]
    ds_read_b64_tr_b16 v[112:113], v143 offset:0
    ds_read_b64_tr_b16 v[114:115], v143 offset:1024
    s_waitcnt lgkmcnt(6)
    v_mfma_f32_32x32x16_bf16 v[32:47], v[100:103], v[96:99], v[32:47]
    v_mfma_f32_16x16x32_bf16 v[220:223], v[100:103], v[216:219], v[220:223]
    ds_read_b128 v[116:119], v149 offset:0
    ds_read_b64_tr_b16 v[120:121], v140 offset:4096
    ds_read_b64_tr_b16 v[122:123], v140 offset:5120
    s_waitcnt lgkmcnt(7)
    v_mfma_f32_32x32x16_bf16 v[48:63], v[104:107], v[96:99], v[48:63]
    ds_read_b64_tr_b16 v[124:125], v141 offset:4096
    ds_read_b64_tr_b16 v[126:127], v141 offset:5120
    s_waitcnt lgkmcnt(7)
    v_mfma_f32_32x32x16_bf16 v[64:79], v[108:111], v[96:99], v[64:79]
    ds_read_b64_tr_b16 v[128:129], v142 offset:4096
    ds_read_b64_tr_b16 v[130:131], v142 offset:5120
    s_waitcnt lgkmcnt(7)
    v_mfma_f32_32x32x16_bf16 v[80:95], v[112:115], v[96:99], v[80:95]
    ds_read_b64_tr_b16 v[132:133], v143 offset:4096
    ds_read_b64_tr_b16 v[134:135], v143 offset:5120
    s_waitcnt lgkmcnt(6)
    v_mfma_f32_32x32x16_bf16 v[32:47], v[120:123], v[116:119], v[32:47]
    v_mfma_f32_16x16x32_bf16 v[220:223], v[120:123], v[216:219], v[220:223]
    ds_read_b128 v[96:99], v150 offset:0
    ds_read_b64_tr_b16 v[100:101], v140 offset:8192
    ds_read_b64_tr_b16 v[102:103], v140 offset:9216
    s_waitcnt lgkmcnt(7)
    v_mfma_f32_32x32x16_bf16 v[48:63], v[124:127], v[116:119], v[48:63]
    ds_read_b64_tr_b16 v[104:105], v141 offset:8192
    ds_read_b64_tr_b16 v[106:107], v141 offset:9216
    s_waitcnt lgkmcnt(7)
    v_mfma_f32_32x32x16_bf16 v[64:79], v[128:131], v[116:119], v[64:79]
    ds_read_b64_tr_b16 v[108:109], v142 offset:8192
    ds_read_b64_tr_b16 v[110:111], v142 offset:9216
    s_waitcnt lgkmcnt(7)
    v_mfma_f32_32x32x16_bf16 v[80:95], v[132:135], v[116:119], v[80:95]
    ds_read_b64_tr_b16 v[112:113], v143 offset:8192
    ds_read_b64_tr_b16 v[114:115], v143 offset:9216
    s_waitcnt lgkmcnt(6)
    v_mfma_f32_32x32x16_bf16 v[32:47], v[100:103], v[96:99], v[32:47]
    v_mfma_f32_16x16x32_bf16 v[220:223], v[100:103], v[216:219], v[220:223]
    ds_read_b128 v[116:119], v151 offset:0
    ds_read_b64_tr_b16 v[120:121], v140 offset:12288
    ds_read_b64_tr_b16 v[122:123], v140 offset:13312
    s_waitcnt lgkmcnt(7)
    v_mfma_f32_32x32x16_bf16 v[48:63], v[104:107], v[96:99], v[48:63]
    ds_read_b64_tr_b16 v[124:125], v141 offset:12288
    ds_read_b64_tr_b16 v[126:127], v141 offset:13312
    s_waitcnt lgkmcnt(7)
    v_mfma_f32_32x32x16_bf16 v[64:79], v[108:111], v[96:99], v[64:79]
    ds_read_b64_tr_b16 v[128:129], v142 offset:12288
    ds_read_b64_tr_b16 v[130:131], v142 offset:13312
    s_waitcnt lgkmcnt(7)
    v_mfma_f32_32x32x16_bf16 v[80:95], v[112:115], v[96:99], v[80:95]
    ds_read_b64_tr_b16 v[132:133], v143 offset:12288
    ds_read_b64_tr_b16 v[134:135], v143 offset:13312
    s_waitcnt lgkmcnt(6)
    v_mfma_f32_32x32x16_bf16 v[32:47], v[120:123], v[116:119], v[32:47]
    v_mfma_f32_16x16x32_bf16 v[220:223], v[120:123], v[216:219], v[220:223]
    s_barrier
    ds_read_b128 v[96:99], v136 offset:16384
    ds_read_b64_tr_b16 v[100:101], v140 offset:32768
    ds_read_b64_tr_b16 v[102:103], v140 offset:33792
    s_waitcnt lgkmcnt(7)
    v_mfma_f32_32x32x16_bf16 v[48:63], v[124:127], v[116:119], v[48:63]
    ds_read_b64_tr_b16 v[104:105], v141 offset:32768
    ds_read_b64_tr_b16 v[106:107], v141 offset:33792
    s_waitcnt lgkmcnt(7)
    v_mfma_f32_32x32x16_bf16 v[64:79], v[128:131], v[116:119], v[64:79]
    ds_read_b64_tr_b16 v[108:109], v142 offset:32768
    ds_read_b64_tr_b16 v[110:111], v142 offset:33792
    s_waitcnt lgkmcnt(7)
    v_mfma_f32_32x32x16_bf16 v[80:95], v[132:135], v[116:119], v[80:95]
    ds_read_b64_tr_b16 v[112:113], v143 offset:32768
    ds_read_b64_tr_b16 v[114:115], v143 offset:33792
    s_waitcnt lgkmcnt(6)
    v_mfma_f32_32x32x16_bf16 v[32:47], v[100:103], v[96:99], v[32:47]
    v_mfma_f32_16x16x32_bf16 v[220:223], v[100:103], v[216:219], v[220:223]
    ds_read_b128 v[116:119], v137 offset:16384
    ds_read_b64_tr_b16 v[120:121], v140 offset:36864
    ds_read_b64_tr_b16 v[122:123], v140 offset:37888
    s_waitcnt lgkmcnt(7)
    v_mfma_f32_32x32x16_bf16 v[48:63], v[104:107], v[96:99], v[48:63]
    ds_read_b64_tr_b16 v[124:125], v141 offset:36864
    ds_read_b64_tr_b16 v[126:127], v141 offset:37888
    s_waitcnt lgkmcnt(7)
    v_mfma_f32_32x32x16_bf16 v[64:79], v[108:111], v[96:99], v[64:79]
    ds_read_b64_tr_b16 v[128:129], v142 offset:36864
    ds_read_b64_tr_b16 v[130:131], v142 offset:37888
    global_load_dword v246, v247, s[56:57] sc1
    s_waitcnt lgkmcnt(7)
    v_mfma_f32_32x32x16_bf16 v[80:95], v[112:115], v[96:99], v[80:95]
    ds_read_b64_tr_b16 v[132:133], v143 offset:36864
    ds_read_b64_tr_b16 v[134:135], v143 offset:37888
    buffer_load_dwordx4 v[152:155], v156, s[12:15], 0 offen sc1
    s_waitcnt lgkmcnt(6)
    v_mfma_f32_32x32x16_bf16 v[32:47], v[120:123], v[116:119], v[32:47]
    v_mfma_f32_16x16x32_bf16 v[220:223], v[120:123], v[216:219], v[220:223]
    ds_read_b128 v[96:99], v138 offset:16384
    ds_read_b64_tr_b16 v[100:101], v140 offset:40960
    ds_read_b64_tr_b16 v[102:103], v140 offset:41984
    s_waitcnt lgkmcnt(7)
    v_mfma_f32_32x32x16_bf16 v[48:63], v[124:127], v[116:119], v[48:63]
    ds_read_b64_tr_b16 v[104:105], v141 offset:40960
    ds_read_b64_tr_b16 v[106:107], v141 offset:41984
    s_waitcnt lgkmcnt(7)
    v_mfma_f32_32x32x16_bf16 v[64:79], v[128:131], v[116:119], v[64:79]
    ds_read_b64_tr_b16 v[108:109], v142 offset:40960
    ds_read_b64_tr_b16 v[110:111], v142 offset:41984
    s_waitcnt lgkmcnt(7)
    v_mfma_f32_32x32x16_bf16 v[80:95], v[132:135], v[116:119], v[80:95]
    ds_read_b64_tr_b16 v[112:113], v143 offset:40960
    ds_read_b64_tr_b16 v[114:115], v143 offset:41984
    s_waitcnt lgkmcnt(6)
    v_mfma_f32_32x32x16_bf16 v[32:47], v[100:103], v[96:99], v[32:47]
    v_mfma_f32_16x16x32_bf16 v[220:223], v[100:103], v[216:219], v[220:223]
    ds_read_b128 v[116:119], v139 offset:16384
    ds_read_b64_tr_b16 v[120:121], v140 offset:45056
    ds_read_b64_tr_b16 v[122:123], v140 offset:46080
    s_waitcnt lgkmcnt(7)
    v_mfma_f32_32x32x16_bf16 v[48:63], v[104:107], v[96:99], v[48:63]
    ds_read_b64_tr_b16 v[124:125], v141 offset:45056
    ds_read_b64_tr_b16 v[126:127], v141 offset:46080
    s_waitcnt lgkmcnt(7)
    v_mfma_f32_32x32x16_bf16 v[64:79], v[108:111], v[96:99], v[64:79]
    ds_read_b64_tr_b16 v[128:129], v142 offset:45056
    ds_read_b64_tr_b16 v[130:131], v142 offset:46080
    s_waitcnt lgkmcnt(7)
    v_mfma_f32_32x32x16_bf16 v[80:95], v[112:115], v[96:99], v[80:95]
    ds_read_b64_tr_b16 v[132:133], v143 offset:45056
    ds_read_b64_tr_b16 v[134:135], v143 offset:46080
    s_waitcnt lgkmcnt(6)
    v_mfma_f32_32x32x16_bf16 v[32:47], v[120:123], v[116:119], v[32:47]
    v_mfma_f32_16x16x32_bf16 v[220:223], v[120:123], v[216:219], v[220:223]
    s_barrier
    ds_read_b128 v[96:99], v136 offset:49152
    ds_read_b64_tr_b16 v[100:101], v192 offset:0
    ds_read_b64_tr_b16 v[102:103], v192 offset:1024
    s_waitcnt lgkmcnt(7)
    v_mfma_f32_32x32x16_bf16 v[48:63], v[124:127], v[116:119], v[48:63]
    ds_read_b64_tr_b16 v[104:105], v193 offset:0
    ds_read_b64_tr_b16 v[106:107], v193 offset:1024
    s_waitcnt lgkmcnt(7)
    v_mfma_f32_32x32x16_bf16 v[64:79], v[128:131], v[116:119], v[64:79]
    ds_read_b64_tr_b16 v[108:109], v194 offset:0
    ds_read_b64_tr_b16 v[110:111], v194 offset:1024
    s_waitcnt lgkmcnt(7)
    v_mfma_f32_32x32x16_bf16 v[80:95], v[132:135], v[116:119], v[80:95]
    ds_read_b64_tr_b16 v[112:113], v195 offset:0
    ds_read_b64_tr_b16 v[114:115], v195 offset:1024
    s_waitcnt lgkmcnt(6)
    v_mfma_f32_32x32x16_bf16 v[32:47], v[100:103], v[96:99], v[32:47]
    v_mfma_f32_16x16x32_bf16 v[220:223], v[100:103], v[216:219], v[220:223]
    ds_read_b128 v[116:119], v137 offset:49152
    ds_read_b64_tr_b16 v[120:121], v192 offset:4096
    ds_read_b64_tr_b16 v[122:123], v192 offset:5120
    s_waitcnt lgkmcnt(7)
    v_mfma_f32_32x32x16_bf16 v[48:63], v[104:107], v[96:99], v[48:63]
    ds_read_b64_tr_b16 v[124:125], v193 offset:4096
    ds_read_b64_tr_b16 v[126:127], v193 offset:5120
    s_waitcnt lgkmcnt(7)
    v_mfma_f32_32x32x16_bf16 v[64:79], v[108:111], v[96:99], v[64:79]
    ds_read_b64_tr_b16 v[128:129], v194 offset:4096
    ds_read_b64_tr_b16 v[130:131], v194 offset:5120
    s_waitcnt lgkmcnt(7)
    v_mfma_f32_32x32x16_bf16 v[80:95], v[112:115], v[96:99], v[80:95]
    ds_read_b64_tr_b16 v[132:133], v195 offset:4096
    ds_read_b64_tr_b16 v[134:135], v195 offset:5120
    s_waitcnt lgkmcnt(6)
    v_mfma_f32_32x32x16_bf16 v[32:47], v[120:123], v[116:119], v[32:47]
    v_mfma_f32_16x16x32_bf16 v[220:223], v[120:123], v[216:219], v[220:223]
    ds_read_b128 v[96:99], v138 offset:49152
    ds_read_b64_tr_b16 v[100:101], v192 offset:8192
    ds_read_b64_tr_b16 v[102:103], v192 offset:9216
    s_waitcnt lgkmcnt(7)
    v_mfma_f32_32x32x16_bf16 v[48:63], v[124:127], v[116:119], v[48:63]
    ds_read_b64_tr_b16 v[104:105], v193 offset:8192
    ds_read_b64_tr_b16 v[106:107], v193 offset:9216
    s_waitcnt lgkmcnt(7)
    v_mfma_f32_32x32x16_bf16 v[64:79], v[128:131], v[116:119], v[64:79]
    ds_read_b64_tr_b16 v[108:109], v194 offset:8192
    ds_read_b64_tr_b16 v[110:111], v194 offset:9216
    s_waitcnt lgkmcnt(7)
    v_mfma_f32_32x32x16_bf16 v[80:95], v[132:135], v[116:119], v[80:95]
    ds_read_b64_tr_b16 v[112:113], v195 offset:8192
    ds_read_b64_tr_b16 v[114:115], v195 offset:9216
    s_waitcnt lgkmcnt(6)
    v_mfma_f32_32x32x16_bf16 v[32:47], v[100:103], v[96:99], v[32:47]
    v_mfma_f32_16x16x32_bf16 v[220:223], v[100:103], v[216:219], v[220:223]
    ds_read_b128 v[116:119], v139 offset:49152
    ds_read_b64_tr_b16 v[120:121], v192 offset:12288
    ds_read_b64_tr_b16 v[122:123], v192 offset:13312
    s_waitcnt lgkmcnt(7)
    v_mfma_f32_32x32x16_bf16 v[48:63], v[104:107], v[96:99], v[48:63]
    ds_read_b64_tr_b16 v[124:125], v193 offset:12288
    ds_read_b64_tr_b16 v[126:127], v193 offset:13312
    s_waitcnt lgkmcnt(7)
    v_mfma_f32_32x32x16_bf16 v[64:79], v[108:111], v[96:99], v[64:79]
    ds_read_b64_tr_b16 v[128:129], v194 offset:12288
    ds_read_b64_tr_b16 v[130:131], v194 offset:13312
    s_waitcnt lgkmcnt(7)
    v_mfma_f32_32x32x16_bf16 v[80:95], v[112:115], v[96:99], v[80:95]
    ds_read_b64_tr_b16 v[132:133], v195 offset:12288
    ds_read_b64_tr_b16 v[134:135], v195 offset:13312
    s_waitcnt lgkmcnt(6)
    v_mfma_f32_32x32x16_bf16 v[32:47], v[120:123], v[116:119], v[32:47]
    v_mfma_f32_16x16x32_bf16 v[220:223], v[120:123], v[216:219], v[220:223]
    s_waitcnt lgkmcnt(4)
    v_mfma_f32_32x32x16_bf16 v[48:63], v[124:127], v[116:119], v[48:63]
    s_waitcnt lgkmcnt(2)
    v_mfma_f32_32x32x16_bf16 v[64:79], v[128:131], v[116:119], v[64:79]
    s_waitcnt lgkmcnt(0)
    v_mfma_f32_32x32x16_bf16 v[80:95], v[132:135], v[116:119], v[80:95]
    s_mov_b32 exec_lo, 0x00030003
    s_mov_b32 exec_hi, 0x00030003
    ds_write_b128 v157, v[220:223]
    s_mov_b64 exec, -1
    s_waitcnt lgkmcnt(0)
    s_barrier
    ds_read_b32 v200, v188
    ds_read_b32 v201, v189
    ds_read_b32 v202, v190
    ds_read_b32 v203, v191
    s_waitcnt vmcnt(1)
    s_mov_b32 s27, 0
NON_23:
    v_readfirstlane_b32 s79, v246
    s_nop 0
    s_cmp_lg_u32 s79, 0
    s_cbranch_scc1 NOK_24
    s_add_u32 s27, s27, 1
    s_cmp_gt_u32 s27, 131072
    s_cbranch_scc1 NOK_24
    global_load_dword v246, v247, s[56:57] sc1
    s_waitcnt vmcnt(0)
    s_branch NON_23
NOK_24:
    s_mov_b32 s27, 0
GRW_21:
    s_waitcnt vmcnt(0)
    v_cmp_ne_u32 vcc, s79, v155
    s_nop 0
    s_cmp_eq_u64 vcc, 0
    s_cbranch_scc1 GRK_22
    s_add_u32 s27, s27, 1
    s_cmp_gt_u32 s27, 131072
    s_cbranch_scc1 GRK_22
    buffer_load_dwordx4 v[152:155], v156, s[12:15], 0 offen sc1
    s_branch GRW_21
GRK_22:
    v_cvt_pk_bf16_f32 v248, v152, v152
    v_mov_b32 v242, v154
    v_and_b32 v224, 0xffff0000, v248
    v_sub_f32 v224, v152, v224
    v_cvt_pk_bf16_f32 v249, v224, v153
    v_and_b32 v224, 0xffff0000, v249
    v_sub_f32 v224, v153, v224
    v_cvt_pk_bf16_f32 v250, v224, 0
    v_mov_b32 v251, 0
    v_cndmask_b32_e64 v248, v248, 0, s[34:35]
    v_cndmask_b32_e64 v249, v249, 0, s[34:35]
    v_cndmask_b32_e64 v250, v250, 0, s[34:35]
    v_mul_f32 v244, 0x3fb8aa3b, v242
    s_lshl_b32 s26, s23, 10
    s_add_u32 s26, s26, 156672
    v_add_u32 v225, s26, v240
    ds_write_b128 v225, v[248:251]
    s_lshl_b32 s26, s23, 7
    s_add_u32 s26, s26, 160768
    v_lshl_add_u32 v226, v243, 2, s26
    ds_write_b32 v226, v242
    v_lshlrev_b32 v176, 16, v176
    v_lshlrev_b32 v177, 16, v177
    v_lshlrev_b32 v178, 16, v178
    v_lshlrev_b32 v179, 16, v179
    s_waitcnt lgkmcnt(0)
    v_cvt_pk_bf16_f32 v231, v200, v200
    v_and_b32 v231, 0xffff0000, v231
    v_sub_f32 v231, v200, v231
    v_cvt_pk_bf16_f32 v252, v200, v231
    v_cvt_pk_bf16_f32 v253, v200, v176
    v_cvt_pk_bf16_f32 v254, v176, 0
    v_mov_b32 v255, 0
    s_nop 1
    v_mfma_f32_32x32x16_bf16 v[32:47], v[252:255], v[248:251], v[32:47]
    v_cvt_pk_bf16_f32 v231, v201, v201
    v_and_b32 v231, 0xffff0000, v231
    v_sub_f32 v231, v201, v231
    v_cvt_pk_bf16_f32 v252, v201, v231
    v_cvt_pk_bf16_f32 v253, v201, v177
    v_cvt_pk_bf16_f32 v254, v177, 0
    v_mov_b32 v255, 0
    s_nop 1
    v_mfma_f32_32x32x16_bf16 v[48:63], v[252:255], v[248:251], v[48:63]
    v_cvt_pk_bf16_f32 v231, v202, v202
    v_and_b32 v231, 0xffff0000, v231
    v_sub_f32 v231, v202, v231
    v_cvt_pk_bf16_f32 v252, v202, v231
    v_cvt_pk_bf16_f32 v253, v202, v178
    v_cvt_pk_bf16_f32 v254, v178, 0
    v_mov_b32 v255, 0
    s_nop 1
    v_mfma_f32_32x32x16_bf16 v[64:79], v[252:255], v[248:251], v[64:79]
    v_cvt_pk_bf16_f32 v231, v203, v203
    v_and_b32 v231, 0xffff0000, v231
    v_sub_f32 v231, v203, v231
    v_cvt_pk_bf16_f32 v252, v203, v231
    v_cvt_pk_bf16_f32 v253, v203, v179
    v_cvt_pk_bf16_f32 v254, v179, 0
    v_mov_b32 v255, 0
    s_nop 1
    v_mfma_f32_32x32x16_bf16 v[80:95], v[252:255], v[248:251], v[80:95]
    s_mul_i32 s26, s87, 56
    s_add_u32 s26, s26, s80
    s_lshl_b32 s39, s26, 11
    v_mul_f32 v32, v32, v244
    v_mul_f32 v33, v33, v244
    v_mul_f32 v34, v34, v244
    v_mul_f32 v35, v35, v244
    v_mul_f32 v36, v36, v244
    v_mul_f32 v37, v37, v244
    v_mul_f32 v38, v38, v244
    v_mul_f32 v39, v39, v244
    v_mul_f32 v40, v40, v244
    v_mul_f32 v41, v41, v244
    v_mul_f32 v42, v42, v244
    v_mul_f32 v43, v43, v244
    v_mul_f32 v44, v44, v244
    v_mul_f32 v45, v45, v244
    v_mul_f32 v46, v46, v244
    v_mul_f32 v47, v47, v244
    v_exp_f32 v16, v32
    v_exp_f32 v17, v33
    v_exp_f32 v18, v34
    v_exp_f32 v19, v35
    v_exp_f32 v20, v36
    v_exp_f32 v21, v37
    v_exp_f32 v22, v38
    v_exp_f32 v23, v39
    v_exp_f32 v24, v40
    v_exp_f32 v25, v41
    v_exp_f32 v26, v42
    v_exp_f32 v27, v43
    v_exp_f32 v28, v44
    v_exp_f32 v29, v45
    v_exp_f32 v30, v46
    v_exp_f32 v31, v47
    v_fma_f32 v16, v16, s36, s36
    v_fma_f32 v17, v17, s36, s36
    v_fma_f32 v18, v18, s36, s36
    v_fma_f32 v19, v19, s36, s36
    v_fma_f32 v20, v20, s36, s36
    v_fma_f32 v21, v21, s36, s36
    v_fma_f32 v22, v22, s36, s36
    v_fma_f32 v23, v23, s36, s36
    v_fma_f32 v24, v24, s36, s36
    v_fma_f32 v25, v25, s36, s36
    v_fma_f32 v26, v26, s36, s36
    v_fma_f32 v27, v27, s36, s36
    v_fma_f32 v28, v28, s36, s36
    v_fma_f32 v29, v29, s36, s36
    v_fma_f32 v30, v30, s36, s36
    v_fma_f32 v31, v31, s36, s36
    v_fma_f32 v16, v16, v16, 0.5
    v_fma_f32 v17, v17, v17, 0.5
    v_fma_f32 v18, v18, v18, 0.5
    v_fma_f32 v19, v19, v19, 0.5
    v_fma_f32 v20, v20, v20, 0.5
    v_fma_f32 v21, v21, v21, 0.5
    v_fma_f32 v22, v22, v22, 0.5
    v_fma_f32 v23, v23, v23, 0.5
    v_fma_f32 v24, v24, v24, 0.5
    v_fma_f32 v25, v25, v25, 0.5
    v_fma_f32 v26, v26, v26, 0.5
    v_fma_f32 v27, v27, v27, 0.5
    v_fma_f32 v28, v28, v28, 0.5
    v_fma_f32 v29, v29, v29, 0.5
    v_fma_f32 v30, v30, v30, 0.5
    v_fma_f32 v31, v31, v31, 0.5
    v_rcp_f32 v16, v16
    v_rcp_f32 v17, v17
    v_rcp_f32 v18, v18
    v_rcp_f32 v19, v19
    v_rcp_f32 v20, v20
    v_rcp_f32 v21, v21
    v_rcp_f32 v22, v22
    v_rcp_f32 v23, v23
    v_rcp_f32 v24, v24
    v_rcp_f32 v25, v25
    v_rcp_f32 v26, v26
    v_rcp_f32 v27, v27
    v_rcp_f32 v28, v28
    v_rcp_f32 v29, v29
    v_rcp_f32 v30, v30
    v_rcp_f32 v31, v31
    v_fma_f32 v16, -v32, v16, v32
    v_fma_f32 v17, -v33, v17, v33
    v_fma_f32 v18, -v34, v18, v34
    v_fma_f32 v19, -v35, v19, v35
    v_fma_f32 v20, -v36, v20, v36
    v_fma_f32 v21, -v37, v21, v37
    v_fma_f32 v22, -v38, v22, v38
    v_fma_f32 v23, -v39, v23, v39
    v_fma_f32 v24, -v40, v24, v40
    v_fma_f32 v25, -v41, v25, v41
    v_fma_f32 v26, -v42, v26, v42
    v_fma_f32 v27, -v43, v27, v43
    v_fma_f32 v28, -v44, v28, v44
    v_fma_f32 v29, -v45, v29, v45
    v_fma_f32 v30, -v46, v30, v46
    v_fma_f32 v31, -v47, v31, v47
    v_cvt_pk_bf16_f32 v232, v16, v17
    v_cvt_pk_bf16_f32 v233, v18, v19
    v_cvt_pk_bf16_f32 v234, v20, v21
    v_cvt_pk_bf16_f32 v235, v22, v23
    v_cvt_pk_bf16_f32 v236, v24, v25
    v_cvt_pk_bf16_f32 v237, v26, v27
    v_cvt_pk_bf16_f32 v238, v28, v29
    v_cvt_pk_bf16_f32 v239, v30, v31
    buffer_store_dwordx4 v[232:235], v240, s[12:15], s39 offen sc1
    buffer_store_dwordx4 v[236:239], v240, s[12:15], s39 offen offset:1024 sc1
    s_barrier
    s_mul_i32 s26, s87, 56
    s_add_u32 s26, s26, s81
    s_lshl_b32 s39, s26, 11
    v_mul_f32 v48, v48, v244
    v_mul_f32 v49, v49, v244
    v_mul_f32 v50, v50, v244
    v_mul_f32 v51, v51, v244
    v_mul_f32 v52, v52, v244
    v_mul_f32 v53, v53, v244
    v_mul_f32 v54, v54, v244
    v_mul_f32 v55, v55, v244
    v_mul_f32 v56, v56, v244
    v_mul_f32 v57, v57, v244
    v_mul_f32 v58, v58, v244
    v_mul_f32 v59, v59, v244
    v_mul_f32 v60, v60, v244
    v_mul_f32 v61, v61, v244
    v_mul_f32 v62, v62, v244
    v_mul_f32 v63, v63, v244
    v_exp_f32 v16, v48
    v_exp_f32 v17, v49
    v_exp_f32 v18, v50
    v_exp_f32 v19, v51
    v_exp_f32 v20, v52
    v_exp_f32 v21, v53
    v_exp_f32 v22, v54
    v_exp_f32 v23, v55
    v_exp_f32 v24, v56
    v_exp_f32 v25, v57
    v_exp_f32 v26, v58
    v_exp_f32 v27, v59
    v_exp_f32 v28, v60
    v_exp_f32 v29, v61
    v_exp_f32 v30, v62
    v_exp_f32 v31, v63
    v_fma_f32 v16, v16, s36, s36
    v_fma_f32 v17, v17, s36, s36
    v_fma_f32 v18, v18, s36, s36
    v_fma_f32 v19, v19, s36, s36
    v_fma_f32 v20, v20, s36, s36
    v_fma_f32 v21, v21, s36, s36
    v_fma_f32 v22, v22, s36, s36
    v_fma_f32 v23, v23, s36, s36
    v_fma_f32 v24, v24, s36, s36
    v_fma_f32 v25, v25, s36, s36
    v_fma_f32 v26, v26, s36, s36
    v_fma_f32 v27, v27, s36, s36
    v_fma_f32 v28, v28, s36, s36
    v_fma_f32 v29, v29, s36, s36
    v_fma_f32 v30, v30, s36, s36
    v_fma_f32 v31, v31, s36, s36
    v_fma_f32 v16, v16, v16, 0.5
    v_fma_f32 v17, v17, v17, 0.5
    v_fma_f32 v18, v18, v18, 0.5
    v_fma_f32 v19, v19, v19, 0.5
    v_fma_f32 v20, v20, v20, 0.5
    v_fma_f32 v21, v21, v21, 0.5
    v_fma_f32 v22, v22, v22, 0.5
    v_fma_f32 v23, v23, v23, 0.5
    v_fma_f32 v24, v24, v24, 0.5
    v_fma_f32 v25, v25, v25, 0.5
    v_fma_f32 v26, v26, v26, 0.5
    v_fma_f32 v27, v27, v27, 0.5
    v_fma_f32 v28, v28, v28, 0.5
    v_fma_f32 v29, v29, v29, 0.5
    v_fma_f32 v30, v30, v30, 0.5
    v_fma_f32 v31, v31, v31, 0.5
    v_rcp_f32 v16, v16
    v_rcp_f32 v17, v17
    v_rcp_f32 v18, v18
    v_rcp_f32 v19, v19
    v_rcp_f32 v20, v20
    v_rcp_f32 v21, v21
    v_rcp_f32 v22, v22
    v_rcp_f32 v23, v23
    v_rcp_f32 v24, v24
    v_rcp_f32 v25, v25
    v_rcp_f32 v26, v26
    v_rcp_f32 v27, v27
    v_rcp_f32 v28, v28
    v_rcp_f32 v29, v29
    v_rcp_f32 v30, v30
    v_rcp_f32 v31, v31
    v_fma_f32 v16, -v48, v16, v48
    v_fma_f32 v17, -v49, v17, v49
    v_fma_f32 v18, -v50, v18, v50
    v_fma_f32 v19, -v51, v19, v51
    v_fma_f32 v20, -v52, v20, v52
    v_fma_f32 v21, -v53, v21, v53
    v_fma_f32 v22, -v54, v22, v54
    v_fma_f32 v23, -v55, v23, v55
    v_fma_f32 v24, -v56, v24, v56
    v_fma_f32 v25, -v57, v25, v57
    v_fma_f32 v26, -v58, v26, v58
    v_fma_f32 v27, -v59, v27, v59
    v_fma_f32 v28, -v60, v28, v60
    v_fma_f32 v29, -v61, v29, v61
    v_fma_f32 v30, -v62, v30, v62
    v_fma_f32 v31, -v63, v31, v63
    v_cvt_pk_bf16_f32 v232, v16, v17
    v_cvt_pk_bf16_f32 v233, v18, v19
    v_cvt_pk_bf16_f32 v234, v20, v21
    v_cvt_pk_bf16_f32 v235, v22, v23
    v_cvt_pk_bf16_f32 v236, v24, v25
    v_cvt_pk_bf16_f32 v237, v26, v27
    v_cvt_pk_bf16_f32 v238, v28, v29
    v_cvt_pk_bf16_f32 v239, v30, v31
    buffer_store_dwordx4 v[232:235], v240, s[12:15], s39 offen sc1
    buffer_store_dwordx4 v[236:239], v240, s[12:15], s39 offen offset:1024 sc1
    s_barrier
    s_mul_i32 s26, s87, 56
    s_add_u32 s26, s26, s82
    s_lshl_b32 s39, s26, 11
    v_mul_f32 v64, v64, v244
    v_mul_f32 v65, v65, v244
    v_mul_f32 v66, v66, v244
    v_mul_f32 v67, v67, v244
    v_mul_f32 v68, v68, v244
    v_mul_f32 v69, v69, v244
    v_mul_f32 v70, v70, v244
    v_mul_f32 v71, v71, v244
    v_mul_f32 v72, v72, v244
    v_mul_f32 v73, v73, v244
    v_mul_f32 v74, v74, v244
    v_mul_f32 v75, v75, v244
    v_mul_f32 v76, v76, v244
    v_mul_f32 v77, v77, v244
    v_mul_f32 v78, v78, v244
    v_mul_f32 v79, v79, v244
    v_exp_f32 v16, v64
    v_exp_f32 v17, v65
    v_exp_f32 v18, v66
    v_exp_f32 v19, v67
    v_exp_f32 v20, v68
    v_exp_f32 v21, v69
    v_exp_f32 v22, v70
    v_exp_f32 v23, v71
    v_exp_f32 v24, v72
    v_exp_f32 v25, v73
    v_exp_f32 v26, v74
    v_exp_f32 v27, v75
    v_exp_f32 v28, v76
    v_exp_f32 v29, v77
    v_exp_f32 v30, v78
    v_exp_f32 v31, v79
    v_fma_f32 v16, v16, s36, s36
    v_fma_f32 v17, v17, s36, s36
    v_fma_f32 v18, v18, s36, s36
    v_fma_f32 v19, v19, s36, s36
    v_fma_f32 v20, v20, s36, s36
    v_fma_f32 v21, v21, s36, s36
    v_fma_f32 v22, v22, s36, s36
    v_fma_f32 v23, v23, s36, s36
    v_fma_f32 v24, v24, s36, s36
    v_fma_f32 v25, v25, s36, s36
    v_fma_f32 v26, v26, s36, s36
    v_fma_f32 v27, v27, s36, s36
    v_fma_f32 v28, v28, s36, s36
    v_fma_f32 v29, v29, s36, s36
    v_fma_f32 v30, v30, s36, s36
    v_fma_f32 v31, v31, s36, s36
    v_fma_f32 v16, v16, v16, 0.5
    v_fma_f32 v17, v17, v17, 0.5
    v_fma_f32 v18, v18, v18, 0.5
    v_fma_f32 v19, v19, v19, 0.5
    v_fma_f32 v20, v20, v20, 0.5
    v_fma_f32 v21, v21, v21, 0.5
    v_fma_f32 v22, v22, v22, 0.5
    v_fma_f32 v23, v23, v23, 0.5
    v_fma_f32 v24, v24, v24, 0.5
    v_fma_f32 v25, v25, v25, 0.5
    v_fma_f32 v26, v26, v26, 0.5
    v_fma_f32 v27, v27, v27, 0.5
    v_fma_f32 v28, v28, v28, 0.5
    v_fma_f32 v29, v29, v29, 0.5
    v_fma_f32 v30, v30, v30, 0.5
    v_fma_f32 v31, v31, v31, 0.5
    v_rcp_f32 v16, v16
    v_rcp_f32 v17, v17
    v_rcp_f32 v18, v18
    v_rcp_f32 v19, v19
    v_rcp_f32 v20, v20
    v_rcp_f32 v21, v21
    v_rcp_f32 v22, v22
    v_rcp_f32 v23, v23
    v_rcp_f32 v24, v24
    v_rcp_f32 v25, v25
    v_rcp_f32 v26, v26
    v_rcp_f32 v27, v27
    v_rcp_f32 v28, v28
    v_rcp_f32 v29, v29
    v_rcp_f32 v30, v30
    v_rcp_f32 v31, v31
    v_fma_f32 v16, -v64, v16, v64
    v_fma_f32 v17, -v65, v17, v65
    v_fma_f32 v18, -v66, v18, v66
    v_fma_f32 v19, -v67, v19, v67
    v_fma_f32 v20, -v68, v20, v68
    v_fma_f32 v21, -v69, v21, v69
    v_fma_f32 v22, -v70, v22, v70
    v_fma_f32 v23, -v71, v23, v71
    v_fma_f32 v24, -v72, v24, v72
    v_fma_f32 v25, -v73, v25, v73
    v_fma_f32 v26, -v74, v26, v74
    v_fma_f32 v27, -v75, v27, v75
    v_fma_f32 v28, -v76, v28, v76
    v_fma_f32 v29, -v77, v29, v77
    v_fma_f32 v30, -v78, v30, v78
    v_fma_f32 v31, -v79, v31, v79
    v_cvt_pk_bf16_f32 v232, v16, v17
    v_cvt_pk_bf16_f32 v233, v18, v19
    v_cvt_pk_bf16_f32 v234, v20, v21
    v_cvt_pk_bf16_f32 v235, v22, v23
    v_cvt_pk_bf16_f32 v236, v24, v25
    v_cvt_pk_bf16_f32 v237, v26, v27
    v_cvt_pk_bf16_f32 v238, v28, v29
    v_cvt_pk_bf16_f32 v239, v30, v31
    buffer_store_dwordx4 v[232:235], v240, s[12:15], s39 offen sc1
    buffer_store_dwordx4 v[236:239], v240, s[12:15], s39 offen offset:1024 sc1
    s_barrier
    s_mul_i32 s26, s87, 56
    s_add_u32 s26, s26, s83
    s_lshl_b32 s39, s26, 11
    v_pk_mul_f32 v[80:81], v[80:81], v[244:245] op_sel_hi:[1,0]
    v_pk_mul_f32 v[82:83], v[82:83], v[244:245] op_sel_hi:[1,0]
    v_pk_mul_f32 v[84:85], v[84:85], v[244:245] op_sel_hi:[1,0]
    v_pk_mul_f32 v[86:87], v[86:87], v[244:245] op_sel_hi:[1,0]
    v_pk_mul_f32 v[88:89], v[88:89], v[244:245] op_sel_hi:[1,0]
    v_pk_mul_f32 v[90:91], v[90:91], v[244:245] op_sel_hi:[1,0]
    v_pk_mul_f32 v[92:93], v[92:93], v[244:245] op_sel_hi:[1,0]
    v_pk_mul_f32 v[94:95], v[94:95], v[244:245] op_sel_hi:[1,0]
    v_exp_f32 v16, v80
    v_exp_f32 v17, v81
    v_exp_f32 v18, v82
    v_exp_f32 v19, v83
    v_exp_f32 v20, v84
    v_exp_f32 v21, v85
    v_exp_f32 v22, v86
    v_exp_f32 v23, v87
    v_exp_f32 v24, v88
    v_exp_f32 v25, v89
    v_exp_f32 v26, v90
    v_exp_f32 v27, v91
    v_exp_f32 v28, v92
    v_exp_f32 v29, v93
    v_exp_f32 v30, v94
    v_exp_f32 v31, v95
    v_pk_fma_f32 v[16:17], v[16:17], s[36:37], s[36:37] op_sel_hi:[1,0,0]
    v_pk_fma_f32 v[18:19], v[18:19], s[36:37], s[36:37] op_sel_hi:[1,0,0]
    v_pk_fma_f32 v[20:21], v[20:21], s[36:37], s[36:37] op_sel_hi:[1,0,0]
    v_pk_fma_f32 v[22:23], v[22:23], s[36:37], s[36:37] op_sel_hi:[1,0,0]
    v_pk_fma_f32 v[24:25], v[24:25], s[36:37], s[36:37] op_sel_hi:[1,0,0]
    v_pk_fma_f32 v[26:27], v[26:27], s[36:37], s[36:37] op_sel_hi:[1,0,0]
    v_pk_fma_f32 v[28:29], v[28:29], s[36:37], s[36:37] op_sel_hi:[1,0,0]
    v_pk_fma_f32 v[30:31], v[30:31], s[36:37], s[36:37] op_sel_hi:[1,0,0]
    v_pk_fma_f32 v[16:17], v[16:17], v[16:17], 0.5 op_sel_hi:[1,1,0]
    v_pk_fma_f32 v[18:19], v[18:19], v[18:19], 0.5 op_sel_hi:[1,1,0]
    v_pk_fma_f32 v[20:21], v[20:21], v[20:21], 0.5 op_sel_hi:[1,1,0]
    v_pk_fma_f32 v[22:23], v[22:23], v[22:23], 0.5 op_sel_hi:[1,1,0]
    v_pk_fma_f32 v[24:25], v[24:25], v[24:25], 0.5 op_sel_hi:[1,1,0]
    v_pk_fma_f32 v[26:27], v[26:27], v[26:27], 0.5 op_sel_hi:[1,1,0]
    v_pk_fma_f32 v[28:29], v[28:29], v[28:29], 0.5 op_sel_hi:[1,1,0]
    v_pk_fma_f32 v[30:31], v[30:31], v[30:31], 0.5 op_sel_hi:[1,1,0]
    v_rcp_f32 v16, v16
    v_rcp_f32 v17, v17
    v_rcp_f32 v18, v18
    v_rcp_f32 v19, v19
    v_rcp_f32 v20, v20
    v_rcp_f32 v21, v21
    v_rcp_f32 v22, v22
    v_rcp_f32 v23, v23
    v_rcp_f32 v24, v24
    v_rcp_f32 v25, v25
    v_rcp_f32 v26, v26
    v_rcp_f32 v27, v27
    v_rcp_f32 v28, v28
    v_rcp_f32 v29, v29
    v_rcp_f32 v30, v30
    v_rcp_f32 v31, v31
    v_pk_fma_f32 v[16:17], v[80:81], v[16:17], v[80:81] neg_lo:[1,0,0] neg_hi:[1,0,0]
    v_pk_fma_f32 v[18:19], v[82:83], v[18:19], v[82:83] neg_lo:[1,0,0] neg_hi:[1,0,0]
    v_pk_fma_f32 v[20:21], v[84:85], v[20:21], v[84:85] neg_lo:[1,0,0] neg_hi:[1,0,0]
    v_pk_fma_f32 v[22:23], v[86:87], v[22:23], v[86:87] neg_lo:[1,0,0] neg_hi:[1,0,0]
    v_pk_fma_f32 v[24:25], v[88:89], v[24:25], v[88:89] neg_lo:[1,0,0] neg_hi:[1,0,0]
    v_pk_fma_f32 v[26:27], v[90:91], v[26:27], v[90:91] neg_lo:[1,0,0] neg_hi:[1,0,0]
    v_pk_fma_f32 v[28:29], v[92:93], v[28:29], v[92:93] neg_lo:[1,0,0] neg_hi:[1,0,0]
    v_pk_fma_f32 v[30:31], v[94:95], v[30:31], v[94:95] neg_lo:[1,0,0] neg_hi:[1,0,0]
    v_cvt_pk_bf16_f32 v232, v16, v17
    v_cvt_pk_bf16_f32 v233, v18, v19
    v_cvt_pk_bf16_f32 v234, v20, v21
    v_cvt_pk_bf16_f32 v235, v22, v23
    v_cvt_pk_bf16_f32 v236, v24, v25
    v_cvt_pk_bf16_f32 v237, v26, v27
    v_cvt_pk_bf16_f32 v238, v28, v29
    v_cvt_pk_bf16_f32 v239, v30, v31
    s_waitcnt vmcnt(0)
    v_lshlrev_b32 v231, 2, v240
    s_mov_b64 exec, 0x7f
    buffer_store_dword v246, v231, s[12:15], s51 offen offset:0 sc1
    s_mov_b64 exec, -1
    buffer_store_dwordx4 v[232:235], v240, s[12:15], s39 offen sc1
    buffer_store_dwordx4 v[236:239], v240, s[12:15], s39 offen offset:1024 sc1
    s_cmp_ge_u32 s0, 224
    s_cbranch_scc0 K1_AH_T
    s_waitcnt vmcnt(0)
    v_lshlrev_b32 v231, 2, v240
    s_mov_b64 exec, 0x7f
    buffer_store_dword v246, v231, s[12:15], s51 offen offset:32 sc1
    s_mov_b64 exec, -1
    s_branch K_RED
W_Y:
    s_setpc_b64 s[30:31]
K1_AH_T:
    s_barrier
P2_Y:
    s_lshl_b32 s26, s23, 2
    s_add_u32 s26, s26, 161312
    v_mov_b32 v219, s26
    s_lshl_b32 s26, s23, 11
    s_add_u32 s26, s26, 147456
    v_add_u32 v221, s26, v240
    s_sub_u32 s26, s26, s46
    v_add_u32 v222, s26, v206
    v_add_u32 v223, s26, v207
    v_add_u32 v220, s46, v240
    s_load_dwordx4 s[60:63], s[58:59], s49 offset:0 glc
    s_bfe_u32 s26, s1, 0x40008
    s_and_b32 s29, s26, 8
    s_add_u32 s26, s26, s29
    s_lshl_b32 s26, s26, 10
    s_lshl_b32 s29, s23, 11
    s_add_u32 m0, s29, 147456
    s_mul_i32 s26, s26, 14
    s_add_u32 s26, s26, s43
    s_add_u32 s28, s26, 6144
    buffer_load_dwordx4 v204, s[8:11], s26 offen lds
    buffer_load_dwordx4 v204, s[8:11], s28 offen offset:1024 lds
    s_mov_b32 s27, 0
POL_25:
    s_waitcnt lgkmcnt(0)
    s_xor_b32 s60, s60, s79
    s_xor_b32 s61, s61, s79
    s_xor_b32 s62, s62, s79
    s_xor_b32 s63, s63, s79
    s_or_b64 s[60:61], s[60:61], s[62:63]
    s_or_b32 s60, s60, s61
    s_cbranch_scc0 POK_26
    s_add_u32 s27, s27, 1
    s_cmp_gt_u32 s27, 131072
    s_cbranch_scc1 POK_26
    s_sleep 2
    s_load_dwordx4 s[60:63], s[58:59], s49 offset:0 glc
    s_branch POL_25
POK_26:
    s_bfe_u32 s76, s47, 0x40000
    s_and_b32 s29, s76, 8
    s_add_u32 s76, s76, s29
    s_lshl_b32 s76, s76, 10
    s_add_u32 s76, s76, s42
    s_add_u32 s78, s76, 114688
    buffer_load_dwordx4 v[80:83], v240, s[12:15], s76 offen sc1
    buffer_load_dwordx4 v[84:87], v240, s[12:15], s78 offen sc1
    s_bfe_u32 s76, s47, 0x40004
    s_and_b32 s29, s76, 8
    s_add_u32 s76, s76, s29
    s_lshl_b32 s76, s76, 10
    s_add_u32 s76, s76, s42
    s_add_u32 s78, s76, 114688
    buffer_load_dwordx4 v[88:91], v240, s[12:15], s76 offen sc1
    buffer_load_dwordx4 v[92:95], v240, s[12:15], s78 offen sc1
    s_bfe_u32 s76, s47, 0x40008
    s_and_b32 s29, s76, 8
    s_add_u32 s76, s76, s29
    s_lshl_b32 s76, s76, 10
    s_add_u32 s76, s76, s42
    s_add_u32 s78, s76, 114688
    buffer_load_dwordx4 v[96:99], v240, s[12:15], s76 offen sc1
    buffer_load_dwordx4 v[100:103], v240, s[12:15], s78 offen sc1
    s_bfe_u32 s76, s47, 0x4000c
    s_and_b32 s29, s76, 8
    s_add_u32 s76, s76, s29
    s_lshl_b32 s76, s76, 10
    s_add_u32 s76, s76, s42
    s_add_u32 s78, s76, 114688
    buffer_load_dwordx4 v[104:107], v240, s[12:15], s76 offen sc1
    buffer_load_dwordx4 v[108:111], v240, s[12:15], s78 offen sc1
    s_waitcnt vmcnt(10)
    s_cmp_ge_u32 s21, 8
    s_cbranch_scc1 P2_Y_NOFA
    v_lshlrev_b32 v231, 2, v240
    s_mov_b64 exec, 0x7f
    buffer_store_dword v246, v231, s[12:15], s51 offen offset:32 sc1
    s_mov_b64 exec, -1
P2_Y_NOFA:
    ds_read_b64_tr_b16 v[64:65], v206 offset:0
    ds_read_b64_tr_b16 v[66:67], v206 offset:1024
    ds_read_b64_tr_b16 v[68:69], v207 offset:0
    ds_read_b64_tr_b16 v[70:71], v207 offset:1024
    s_waitcnt vmcnt(6)
    s_waitcnt lgkmcnt(0)
    v_mfma_f32_32x32x16_bf16 v[0:15], v[64:67], v[80:83], 0
    ds_read_b64_tr_b16 v[72:73], v206 offset:2048
    ds_read_b64_tr_b16 v[74:75], v206 offset:3072
    s_bfe_u32 s76, s47, 0x40010
    s_and_b32 s29, s76, 8
    s_add_u32 s76, s76, s29
    s_lshl_b32 s76, s76, 10
    s_add_u32 s76, s76, s42
    s_add_u32 s78, s76, 114688
    v_mfma_f32_32x32x16_bf16 v[16:31], v[68:71], v[80:83], 0
    ds_read_b64_tr_b16 v[76:77], v207 offset:2048
    ds_read_b64_tr_b16 v[78:79], v207 offset:3072
    buffer_load_dwordx4 v[80:83], v240, s[12:15], s76 offen sc1
    v_mfma_f32_32x32x16_bf16 v[32:47], v[64:67], v[84:87], 0
    v_mfma_f32_32x32x16_bf16 v[48:63], v[68:71], v[84:87], 0
    buffer_load_dwordx4 v[84:87], v240, s[12:15], s78 offen sc1
    s_waitcnt vmcnt(6)
    s_waitcnt lgkmcnt(0)
    v_mfma_f32_32x32x16_bf16 v[0:15], v[72:75], v[88:91], v[0:15]
    ds_read_b64_tr_b16 v[64:65], v206 offset:4096
    ds_read_b64_tr_b16 v[66:67], v206 offset:5120
    s_bfe_u32 s76, s47, 0x40014
    s_and_b32 s29, s76, 8
    s_add_u32 s76, s76, s29
    s_lshl_b32 s76, s76, 10
    s_add_u32 s76, s76, s42
    s_add_u32 s78, s76, 114688
    v_mfma_f32_32x32x16_bf16 v[16:31], v[76:79], v[88:91], v[16:31]
    ds_read_b64_tr_b16 v[68:69], v207 offset:4096
    ds_read_b64_tr_b16 v[70:71], v207 offset:5120
    buffer_load_dwordx4 v[88:91], v240, s[12:15], s76 offen sc1
    v_mfma_f32_32x32x16_bf16 v[32:47], v[72:75], v[92:95], v[32:47]
    v_mfma_f32_32x32x16_bf16 v[48:63], v[76:79], v[92:95], v[48:63]
    buffer_load_dwordx4 v[92:95], v240, s[12:15], s78 offen sc1
    s_waitcnt vmcnt(6)
    s_waitcnt lgkmcnt(0)
    v_mfma_f32_32x32x16_bf16 v[0:15], v[64:67], v[96:99], v[0:15]
    ds_read_b64_tr_b16 v[72:73], v206 offset:6144
    ds_read_b64_tr_b16 v[74:75], v206 offset:7168
    s_bfe_u32 s76, s47, 0x40018
    s_and_b32 s29, s76, 8
    s_add_u32 s76, s76, s29
    s_lshl_b32 s76, s76, 10
    s_add_u32 s76, s76, s42
    s_add_u32 s78, s76, 114688
    v_mfma_f32_32x32x16_bf16 v[16:31], v[68:71], v[96:99], v[16:31]
    ds_read_b64_tr_b16 v[76:77], v207 offset:6144
    ds_read_b64_tr_b16 v[78:79], v207 offset:7168
    buffer_load_dwordx4 v[96:99], v240, s[12:15], s76 offen sc1
    v_mfma_f32_32x32x16_bf16 v[32:47], v[64:67], v[100:103], v[32:47]
    v_mfma_f32_32x32x16_bf16 v[48:63], v[68:71], v[100:103], v[48:63]
    buffer_load_dwordx4 v[100:103], v240, s[12:15], s78 offen sc1
    s_waitcnt vmcnt(6)
    s_waitcnt lgkmcnt(0)
    v_mfma_f32_32x32x16_bf16 v[0:15], v[72:75], v[104:107], v[0:15]
    ds_read_b64_tr_b16 v[64:65], v206 offset:8192
    ds_read_b64_tr_b16 v[66:67], v206 offset:9216
    s_bfe_u32 s76, s47, 0x4001c
    s_and_b32 s29, s76, 8
    s_add_u32 s76, s76, s29
    s_lshl_b32 s76, s76, 10
    s_add_u32 s76, s76, s42
    s_add_u32 s78, s76, 114688
    v_mfma_f32_32x32x16_bf16 v[16:31], v[76:79], v[104:107], v[16:31]
    ds_read_b64_tr_b16 v[68:69], v207 offset:8192
    ds_read_b64_tr_b16 v[70:71], v207 offset:9216
    buffer_load_dwordx4 v[104:107], v240, s[12:15], s76 offen sc1
    v_mfma_f32_32x32x16_bf16 v[32:47], v[72:75], v[108:111], v[32:47]
    v_mfma_f32_32x32x16_bf16 v[48:63], v[76:79], v[108:111], v[48:63]
    buffer_load_dwordx4 v[108:111], v240, s[12:15], s78 offen sc1
    ds_read_b32 v218, v219
    s_mov_b32 s27, 0
STL_27:
    s_waitcnt lgkmcnt(0)
    v_readfirstlane_b32 s26, v218
    s_nop 0
    s_bitcmp1_b32 s26, 0
    s_cbranch_scc1 STK_28
    s_add_u32 s27, s27, 1
    s_cmp_gt_u32 s27, 2097152
    s_cbranch_scc1 STK_28
    s_sleep 1
    ds_read_b32 v218, v219
    s_branch STL_27
STK_28:
    s_waitcnt vmcnt(6)
    s_waitcnt lgkmcnt(0)
    v_mfma_f32_32x32x16_bf16 v[0:15], v[64:67], v[80:83], v[0:15]
    ds_read_b64_tr_b16 v[72:73], v206 offset:10240
    ds_read_b64_tr_b16 v[74:75], v206 offset:11264
    s_bfe_u32 s76, s1, 0x40000
    s_and_b32 s29, s76, 8
    s_add_u32 s76, s76, s29
    s_lshl_b32 s76, s76, 10
    s_add_u32 s76, s76, s42
    s_add_u32 s78, s76, 114688
    v_mfma_f32_32x32x16_bf16 v[16:31], v[68:71], v[80:83], v[16:31]
    ds_read_b64_tr_b16 v[76:77], v207 offset:10240
    ds_read_b64_tr_b16 v[78:79], v207 offset:11264
    buffer_load_dwordx4 v[80:83], v240, s[12:15], s76 offen sc1
    v_mfma_f32_32x32x16_bf16 v[32:47], v[64:67], v[84:87], v[32:47]
    v_mfma_f32_32x32x16_bf16 v[48:63], v[68:71], v[84:87], v[48:63]
    buffer_load_dwordx4 v[84:87], v240, s[12:15], s78 offen sc1
    s_waitcnt vmcnt(6)
    s_waitcnt lgkmcnt(0)
    v_mfma_f32_32x32x16_bf16 v[0:15], v[72:75], v[88:91], v[0:15]
    ds_read_b64_tr_b16 v[64:65], v206 offset:12288
    ds_read_b64_tr_b16 v[66:67], v206 offset:13312
    s_bfe_u32 s76, s1, 0x40004
    s_and_b32 s29, s76, 8
    s_add_u32 s76, s76, s29
    s_lshl_b32 s76, s76, 10
    s_add_u32 s76, s76, s42
    s_add_u32 s78, s76, 114688
    v_mfma_f32_32x32x16_bf16 v[16:31], v[76:79], v[88:91], v[16:31]
    ds_read_b64_tr_b16 v[68:69], v207 offset:12288
    ds_read_b64_tr_b16 v[70:71], v207 offset:13312
    buffer_load_dwordx4 v[88:91], v240, s[12:15], s76 offen sc1
    v_mfma_f32_32x32x16_bf16 v[32:47], v[72:75], v[92:95], v[32:47]
    v_mfma_f32_32x32x16_bf16 v[48:63], v[76:79], v[92:95], v[48:63]
    buffer_load_dwordx4 v[92:95], v240, s[12:15], s78 offen sc1
    s_waitcnt vmcnt(6)
    s_waitcnt lgkmcnt(0)
    v_mfma_f32_32x32x16_bf16 v[0:15], v[64:67], v[96:99], v[0:15]
    ds_read_b64_tr_b16 v[72:73], v206 offset:14336
    ds_read_b64_tr_b16 v[74:75], v206 offset:15360
    s_bfe_u32 s76, s1, 0x40008
    s_and_b32 s29, s76, 8
    s_add_u32 s76, s76, s29
    s_lshl_b32 s76, s76, 10
    s_add_u32 s76, s76, s42
    s_add_u32 s78, s76, 114688
    v_mfma_f32_32x32x16_bf16 v[16:31], v[68:71], v[96:99], v[16:31]
    ds_read_b64_tr_b16 v[76:77], v207 offset:14336
    ds_read_b64_tr_b16 v[78:79], v207 offset:15360
    buffer_load_dwordx4 v[96:99], v240, s[12:15], s76 offen sc1
    v_mfma_f32_32x32x16_bf16 v[32:47], v[64:67], v[100:103], v[32:47]
    s_bfe_u32 s26, s1, 0x4000c
    s_and_b32 s29, s26, 8
    s_add_u32 s26, s26, s29
    s_lshl_b32 s26, s26, 10
    s_add_u32 m0, s46, 0
    s_mul_i32 s26, s26, 14
    s_add_u32 s26, s26, s43
    s_add_u32 s28, s26, 6144
    buffer_load_dwordx4 v204, s[8:11], s26 offen lds
    v_mfma_f32_32x32x16_bf16 v[48:63], v[68:71], v[100:103], v[48:63]
    buffer_load_dwordx4 v[100:103], v240, s[12:15], s78 offen sc1
    buffer_load_dwordx4 v204, s[8:11], s28 offen offset:1024 lds
    s_waitcnt vmcnt(8)
    s_waitcnt lgkmcnt(0)
    v_mfma_f32_32x32x16_bf16 v[0:15], v[72:75], v[104:107], v[0:15]
    ds_read_b64_tr_b16 v[64:65], v206 offset:16384
    ds_read_b64_tr_b16 v[66:67], v206 offset:17408
    s_bfe_u32 s76, s1, 0x4000c
    s_and_b32 s29, s76, 8
    s_add_u32 s76, s76, s29
    s_lshl_b32 s76, s76, 10
    s_add_u32 s76, s76, s42
    s_add_u32 s78, s76, 114688
    v_mfma_f32_32x32x16_bf16 v[16:31], v[76:79], v[104:107], v[16:31]
    ds_read_b64_tr_b16 v[68:69], v207 offset:16384
    ds_read_b64_tr_b16 v[70:71], v207 offset:17408
    buffer_load_dwordx4 v[104:107], v240, s[12:15], s76 offen sc1
    v_mfma_f32_32x32x16_bf16 v[32:47], v[72:75], v[108:111], v[32:47]
    s_bfe_u32 s26, s1, 0x40010
    s_and_b32 s29, s26, 8
    s_add_u32 s26, s26, s29
    s_lshl_b32 s26, s26, 10
    s_add_u32 m0, s46, 2048
    s_mul_i32 s26, s26, 14
    s_add_u32 s26, s26, s43
    s_add_u32 s28, s26, 6144
    buffer_load_dwordx4 v204, s[8:11], s26 offen lds
    v_mfma_f32_32x32x16_bf16 v[48:63], v[76:79], v[108:111], v[48:63]
    buffer_load_dwordx4 v[108:111], v240, s[12:15], s78 offen sc1
    buffer_load_dwordx4 v204, s[8:11], s28 offen offset:1024 lds
    s_waitcnt vmcnt(10)
    s_waitcnt lgkmcnt(0)
    v_mfma_f32_32x32x16_bf16 v[0:15], v[64:67], v[80:83], v[0:15]
    ds_read_b64_tr_b16 v[72:73], v206 offset:18432
    ds_read_b64_tr_b16 v[74:75], v206 offset:19456
    s_bfe_u32 s76, s1, 0x40010
    s_and_b32 s29, s76, 8
    s_add_u32 s76, s76, s29
    s_lshl_b32 s76, s76, 10
    s_add_u32 s76, s76, s42
    s_add_u32 s78, s76, 114688
    v_mfma_f32_32x32x16_bf16 v[16:31], v[68:71], v[80:83], v[16:31]
    ds_read_b64_tr_b16 v[76:77], v207 offset:18432
    ds_read_b64_tr_b16 v[78:79], v207 offset:19456
    buffer_load_dwordx4 v[80:83], v240, s[12:15], s76 offen sc1
    v_mfma_f32_32x32x16_bf16 v[32:47], v[64:67], v[84:87], v[32:47]
    s_bfe_u32 s26, s1, 0x40014
    s_and_b32 s29, s26, 8
    s_add_u32 s26, s26, s29
    s_lshl_b32 s26, s26, 10
    s_add_u32 m0, s46, 4096
    s_mul_i32 s26, s26, 14
    s_add_u32 s26, s26, s43
    s_add_u32 s28, s26, 6144
    buffer_load_dwordx4 v204, s[8:11], s26 offen lds
    v_mfma_f32_32x32x16_bf16 v[48:63], v[68:71], v[84:87], v[48:63]
    buffer_load_dwordx4 v[84:87], v240, s[12:15], s78 offen sc1
    buffer_load_dwordx4 v204, s[8:11], s28 offen offset:1024 lds
    s_waitcnt vmcnt(12)
    s_waitcnt lgkmcnt(0)
    v_mfma_f32_32x32x16_bf16 v[0:15], v[72:75], v[88:91], v[0:15]
    ds_read_b64_tr_b16 v[64:65], v222 offset:0
    ds_read_b64_tr_b16 v[66:67], v222 offset:1024
    s_bfe_u32 s76, s1, 0x40014
    s_and_b32 s29, s76, 8
    s_add_u32 s76, s76, s29
    s_lshl_b32 s76, s76, 10
    s_add_u32 s76, s76, s42
    s_add_u32 s78, s76, 114688
    v_mfma_f32_32x32x16_bf16 v[16:31], v[76:79], v[88:91], v[16:31]
    ds_read_b64_tr_b16 v[68:69], v223 offset:0
    ds_read_b64_tr_b16 v[70:71], v223 offset:1024
    buffer_load_dwordx4 v[88:91], v240, s[12:15], s76 offen sc1
    v_mfma_f32_32x32x16_bf16 v[32:47], v[72:75], v[92:95], v[32:47]
    s_bfe_u32 s26, s1, 0x40018
    s_and_b32 s29, s26, 8
    s_add_u32 s26, s26, s29
    s_lshl_b32 s26, s26, 10
    s_add_u32 m0, s46, 6144
    s_mul_i32 s26, s26, 14
    s_add_u32 s26, s26, s43
    s_add_u32 s28, s26, 6144
    buffer_load_dwordx4 v204, s[8:11], s26 offen lds
    v_mfma_f32_32x32x16_bf16 v[48:63], v[76:79], v[92:95], v[48:63]
    buffer_load_dwordx4 v[92:95], v240, s[12:15], s78 offen sc1
    buffer_load_dwordx4 v204, s[8:11], s28 offen offset:1024 lds
    s_waitcnt vmcnt(12)
    s_waitcnt lgkmcnt(0)
    v_mfma_f32_32x32x16_bf16 v[0:15], v[64:67], v[96:99], v[0:15]
    ds_read_b64_tr_b16 v[72:73], v206 offset:0
    ds_read_b64_tr_b16 v[74:75], v206 offset:1024
    s_bfe_u32 s76, s1, 0x40018
    s_and_b32 s29, s76, 8
    s_add_u32 s76, s76, s29
    s_lshl_b32 s76, s76, 10
    s_add_u32 s76, s76, s42
    s_add_u32 s78, s76, 114688
    v_mfma_f32_32x32x16_bf16 v[16:31], v[68:71], v[96:99], v[16:31]
    ds_read_b64_tr_b16 v[76:77], v207 offset:0
    ds_read_b64_tr_b16 v[78:79], v207 offset:1024
    buffer_load_dwordx4 v[96:99], v240, s[12:15], s76 offen sc1
    v_mfma_f32_32x32x16_bf16 v[32:47], v[64:67], v[100:103], v[32:47]
    s_bfe_u32 s26, s1, 0x4001c
    s_and_b32 s29, s26, 8
    s_add_u32 s26, s26, s29
    s_lshl_b32 s26, s26, 10
    s_add_u32 m0, s46, 8192
    s_mul_i32 s26, s26, 14
    s_add_u32 s26, s26, s43
    s_add_u32 s28, s26, 6144
    buffer_load_dwordx4 v204, s[8:11], s26 offen lds
    v_mfma_f32_32x32x16_bf16 v[48:63], v[68:71], v[100:103], v[48:63]
    buffer_load_dwordx4 v[100:103], v240, s[12:15], s78 offen sc1
    buffer_load_dwordx4 v204, s[8:11], s28 offen offset:1024 lds
    s_waitcnt vmcnt(12)
    s_waitcnt lgkmcnt(0)
    v_mfma_f32_32x32x16_bf16 v[0:15], v[72:75], v[104:107], v[0:15]
    ds_read_b64_tr_b16 v[64:65], v206 offset:2048
    ds_read_b64_tr_b16 v[66:67], v206 offset:3072
    s_bfe_u32 s76, s1, 0x4001c
    s_and_b32 s29, s76, 8
    s_add_u32 s76, s76, s29
    s_lshl_b32 s76, s76, 10
    s_add_u32 s76, s76, s42
    s_add_u32 s78, s76, 114688
    v_mfma_f32_32x32x16_bf16 v[16:31], v[76:79], v[104:107], v[16:31]
    ds_read_b64_tr_b16 v[68:69], v207 offset:2048
    ds_read_b64_tr_b16 v[70:71], v207 offset:3072
    buffer_load_dwordx4 v[104:107], v240, s[12:15], s76 offen sc1
    v_mfma_f32_32x32x16_bf16 v[32:47], v[72:75], v[108:111], v[32:47]
    s_xor_b32 s26, s48, 8192
    s_add_u32 m0, s46, 10240
    s_mul_i32 s26, s26, 14
    s_add_u32 s26, s26, s43
    s_add_u32 s28, s26, 6144
    buffer_load_dwordx4 v204, s[8:11], s26 offen lds
    v_mfma_f32_32x32x16_bf16 v[48:63], v[76:79], v[108:111], v[48:63]
    buffer_load_dwordx4 v[108:111], v240, s[12:15], s78 offen sc1
    buffer_load_dwordx4 v204, s[8:11], s28 offen offset:1024 lds
    ds_read_b32 v218, v219
    s_mov_b32 s27, 0
STL_29:
    s_waitcnt lgkmcnt(0)
    v_readfirstlane_b32 s26, v218
    s_nop 0
    s_bitcmp1_b32 s26, 1
    s_cbranch_scc1 STK_30
    s_add_u32 s27, s27, 1
    s_cmp_gt_u32 s27, 2097152
    s_cbranch_scc1 STK_30
    s_sleep 1
    ds_read_b32 v218, v219
    s_branch STL_29
STK_30:
    s_waitcnt vmcnt(12)
    s_waitcnt lgkmcnt(0)
    v_mfma_f32_32x32x16_bf16 v[0:15], v[64:67], v[80:83], v[0:15]
    ds_read_b64_tr_b16 v[72:73], v206 offset:4096
    ds_read_b64_tr_b16 v[74:75], v206 offset:5120
    s_xor_b32 s76, s48, 8192
    s_add_u32 s76, s76, s42
    s_add_u32 s78, s76, 114688
    v_mfma_f32_32x32x16_bf16 v[16:31], v[68:71], v[80:83], v[16:31]
    ds_read_b64_tr_b16 v[76:77], v207 offset:4096
    ds_read_b64_tr_b16 v[78:79], v207 offset:5120
    buffer_load_dwordx4 v[80:83], v240, s[12:15], s76 offen sc1
    v_mfma_f32_32x32x16_bf16 v[32:47], v[64:67], v[84:87], v[32:47]
    s_xor_b32 s26, s48, 9216
    s_add_u32 m0, s46, 12288
    s_mul_i32 s26, s26, 14
    s_add_u32 s26, s26, s43
    s_add_u32 s28, s26, 6144
    buffer_load_dwordx4 v204, s[8:11], s26 offen lds
    v_mfma_f32_32x32x16_bf16 v[48:63], v[68:71], v[84:87], v[48:63]
    buffer_load_dwordx4 v[84:87], v240, s[12:15], s78 offen sc1
    buffer_load_dwordx4 v204, s[8:11], s28 offen offset:1024 lds
    s_waitcnt vmcnt(12)
    s_waitcnt lgkmcnt(0)
    v_mfma_f32_32x32x16_bf16 v[0:15], v[72:75], v[88:91], v[0:15]
    ds_read_b64_tr_b16 v[64:65], v206 offset:6144
    ds_read_b64_tr_b16 v[66:67], v206 offset:7168
    s_xor_b32 s76, s48, 9216
    s_add_u32 s76, s76, s42
    s_add_u32 s78, s76, 114688
    v_mfma_f32_32x32x16_bf16 v[16:31], v[76:79], v[88:91], v[16:31]
    ds_read_b64_tr_b16 v[68:69], v207 offset:6144
    ds_read_b64_tr_b16 v[70:71], v207 offset:7168
    buffer_load_dwordx4 v[88:91], v240, s[12:15], s76 offen sc1
    v_mfma_f32_32x32x16_bf16 v[32:47], v[72:75], v[92:95], v[32:47]
    s_xor_b32 s26, s48, 10240
    s_add_u32 m0, s46, 14336
    s_mul_i32 s26, s26, 14
    s_add_u32 s26, s26, s43
    s_add_u32 s28, s26, 6144
    buffer_load_dwordx4 v204, s[8:11], s26 offen lds
    v_mfma_f32_32x32x16_bf16 v[48:63], v[76:79], v[92:95], v[48:63]
    buffer_load_dwordx4 v[92:95], v240, s[12:15], s78 offen sc1
    buffer_load_dwordx4 v204, s[8:11], s28 offen offset:1024 lds
    s_waitcnt vmcnt(12)
    s_waitcnt lgkmcnt(0)
    v_mfma_f32_32x32x16_bf16 v[0:15], v[64:67], v[96:99], v[0:15]
    ds_read_b64_tr_b16 v[72:73], v206 offset:8192
    ds_read_b64_tr_b16 v[74:75], v206 offset:9216
    s_xor_b32 s76, s48, 10240
    s_add_u32 s76, s76, s42
    s_add_u32 s78, s76, 114688
    v_mfma_f32_32x32x16_bf16 v[16:31], v[68:71], v[96:99], v[16:31]
    ds_read_b64_tr_b16 v[76:77], v207 offset:8192
    ds_read_b64_tr_b16 v[78:79], v207 offset:9216
    buffer_load_dwordx4 v[96:99], v240, s[12:15], s76 offen sc1
    v_mfma_f32_32x32x16_bf16 v[32:47], v[64:67], v[100:103], v[32:47]
    s_xor_b32 s26, s48, 11264
    s_add_u32 m0, s46, 16384
    s_mul_i32 s26, s26, 14
    s_add_u32 s26, s26, s43
    s_add_u32 s28, s26, 6144
    buffer_load_dwordx4 v204, s[8:11], s26 offen lds
    v_mfma_f32_32x32x16_bf16 v[48:63], v[68:71], v[100:103], v[48:63]
    buffer_load_dwordx4 v[100:103], v240, s[12:15], s78 offen sc1
    buffer_load_dwordx4 v204, s[8:11], s28 offen offset:1024 lds
    s_waitcnt vmcnt(12)
    s_waitcnt lgkmcnt(0)
    v_mfma_f32_32x32x16_bf16 v[0:15], v[72:75], v[104:107], v[0:15]
    ds_read_b64_tr_b16 v[64:65], v206 offset:10240
    ds_read_b64_tr_b16 v[66:67], v206 offset:11264
    s_xor_b32 s76, s48, 11264
    s_add_u32 s76, s76, s42
    s_add_u32 s78, s76, 114688
    v_mfma_f32_32x32x16_bf16 v[16:31], v[76:79], v[104:107], v[16:31]
    ds_read_b64_tr_b16 v[68:69], v207 offset:10240
    ds_read_b64_tr_b16 v[70:71], v207 offset:11264
    buffer_load_dwordx4 v[104:107], v240, s[12:15], s76 offen sc1
    v_mfma_f32_32x32x16_bf16 v[32:47], v[72:75], v[108:111], v[32:47]
    s_xor_b32 s26, s48, 12288
    s_add_u32 m0, s46, 18432
    s_mul_i32 s26, s26, 14
    s_add_u32 s26, s26, s43
    s_add_u32 s28, s26, 6144
    buffer_load_dwordx4 v204, s[8:11], s26 offen lds
    v_mfma_f32_32x32x16_bf16 v[48:63], v[76:79], v[108:111], v[48:63]
    buffer_load_dwordx4 v[108:111], v240, s[12:15], s78 offen sc1
    buffer_load_dwordx4 v204, s[8:11], s28 offen offset:1024 lds
    s_waitcnt vmcnt(12)
    s_waitcnt lgkmcnt(0)
    v_mfma_f32_32x32x16_bf16 v[0:15], v[64:67], v[80:83], v[0:15]
    ds_read_b64_tr_b16 v[72:73], v206 offset:12288
    ds_read_b64_tr_b16 v[74:75], v206 offset:13312
    s_xor_b32 s76, s48, 12288
    s_add_u32 s76, s76, s42
    s_add_u32 s78, s76, 114688
    v_mfma_f32_32x32x16_bf16 v[16:31], v[68:71], v[80:83], v[16:31]
    ds_read_b64_tr_b16 v[76:77], v207 offset:12288
    ds_read_b64_tr_b16 v[78:79], v207 offset:13312
    buffer_load_dwordx4 v[80:83], v240, s[12:15], s76 offen sc1
    v_mfma_f32_32x32x16_bf16 v[32:47], v[64:67], v[84:87], v[32:47]
    s_xor_b32 s26, s48, 13312
    s_lshl_b32 s29, s23, 11
    s_add_u32 m0, s29, 147456
    s_mul_i32 s26, s26, 14
    s_add_u32 s26, s26, s43
    s_add_u32 s28, s26, 6144
    buffer_load_dwordx4 v204, s[8:11], s26 offen lds
    v_mfma_f32_32x32x16_bf16 v[48:63], v[68:71], v[84:87], v[48:63]
    buffer_load_dwordx4 v[84:87], v240, s[12:15], s78 offen sc1
    buffer_load_dwordx4 v204, s[8:11], s28 offen offset:1024 lds
    s_waitcnt vmcnt(12)
    s_waitcnt lgkmcnt(0)
    v_mfma_f32_32x32x16_bf16 v[0:15], v[72:75], v[88:91], v[0:15]
    ds_read_b64_tr_b16 v[64:65], v206 offset:14336
    ds_read_b64_tr_b16 v[66:67], v206 offset:15360
    s_xor_b32 s76, s48, 13312
    s_add_u32 s76, s76, s42
    s_add_u32 s78, s76, 114688
    v_mfma_f32_32x32x16_bf16 v[16:31], v[76:79], v[88:91], v[16:31]
    ds_read_b64_tr_b16 v[68:69], v207 offset:14336
    ds_read_b64_tr_b16 v[70:71], v207 offset:15360
    buffer_load_dwordx4 v[88:91], v240, s[12:15], s76 offen sc1
    v_mfma_f32_32x32x16_bf16 v[32:47], v[72:75], v[92:95], v[32:47]
    s_xor_b32 s26, s48, 14336
    s_add_u32 m0, s46, 0
    s_mul_i32 s26, s26, 14
    s_add_u32 s26, s26, s43
    s_add_u32 s28, s26, 6144
    buffer_load_dwordx4 v204, s[8:11], s26 offen lds
    v_mfma_f32_32x32x16_bf16 v[48:63], v[76:79], v[92:95], v[48:63]
    buffer_load_dwordx4 v[92:95], v240, s[12:15], s78 offen sc1
    buffer_load_dwordx4 v204, s[8:11], s28 offen offset:1024 lds
    s_waitcnt vmcnt(12)
    s_waitcnt lgkmcnt(0)
    v_mfma_f32_32x32x16_bf16 v[0:15], v[64:67], v[96:99], v[0:15]
    ds_read_b64_tr_b16 v[72:73], v206 offset:16384
    ds_read_b64_tr_b16 v[74:75], v206 offset:17408
    s_xor_b32 s76, s48, 14336
    s_add_u32 s76, s76, s42
    s_add_u32 s78, s76, 114688
    v_mfma_f32_32x32x16_bf16 v[16:31], v[68:71], v[96:99], v[16:31]
    ds_read_b64_tr_b16 v[76:77], v207 offset:16384
    ds_read_b64_tr_b16 v[78:79], v207 offset:17408
    buffer_load_dwordx4 v[96:99], v240, s[12:15], s76 offen sc1
    v_mfma_f32_32x32x16_bf16 v[32:47], v[64:67], v[100:103], v[32:47]
    s_xor_b32 s26, s48, 15360
    s_add_u32 m0, s46, 2048
    s_mul_i32 s26, s26, 14
    s_add_u32 s26, s26, s43
    s_add_u32 s28, s26, 6144
    buffer_load_dwordx4 v204, s[8:11], s26 offen lds
    v_mfma_f32_32x32x16_bf16 v[48:63], v[68:71], v[100:103], v[48:63]
    buffer_load_dwordx4 v[100:103], v240, s[12:15], s78 offen sc1
    buffer_load_dwordx4 v204, s[8:11], s28 offen offset:1024 lds
    s_waitcnt vmcnt(12)
    s_waitcnt lgkmcnt(0)
    v_mfma_f32_32x32x16_bf16 v[0:15], v[72:75], v[104:107], v[0:15]
    ds_read_b64_tr_b16 v[64:65], v206 offset:18432
    ds_read_b64_tr_b16 v[66:67], v206 offset:19456
    s_xor_b32 s76, s48, 15360
    s_add_u32 s76, s76, s42
    s_add_u32 s78, s76, 114688
    v_mfma_f32_32x32x16_bf16 v[16:31], v[76:79], v[104:107], v[16:31]
    ds_read_b64_tr_b16 v[68:69], v207 offset:18432
    ds_read_b64_tr_b16 v[70:71], v207 offset:19456
    buffer_load_dwordx4 v[104:107], v240, s[12:15], s76 offen sc1
    v_mfma_f32_32x32x16_bf16 v[32:47], v[72:75], v[108:111], v[32:47]
    s_xor_b32 s26, s48, 24576
    s_add_u32 m0, s46, 4096
    s_mul_i32 s26, s26, 14
    s_add_u32 s26, s26, s43
    s_add_u32 s28, s26, 6144
    buffer_load_dwordx4 v204, s[8:11], s26 offen lds
    v_mfma_f32_32x32x16_bf16 v[48:63], v[76:79], v[108:111], v[48:63]
    buffer_load_dwordx4 v[108:111], v240, s[12:15], s78 offen sc1
    buffer_load_dwordx4 v204, s[8:11], s28 offen offset:1024 lds
    s_waitcnt vmcnt(12)
    s_waitcnt lgkmcnt(0)
    v_mfma_f32_32x32x16_bf16 v[0:15], v[64:67], v[80:83], v[0:15]
    ds_read_b64_tr_b16 v[72:73], v222 offset:0
    ds_read_b64_tr_b16 v[74:75], v222 offset:1024
    s_xor_b32 s76, s48, 24576
    s_add_u32 s76, s76, s42
    s_add_u32 s78, s76, 114688
    v_mfma_f32_32x32x16_bf16 v[16:31], v[68:71], v[80:83], v[16:31]
    ds_read_b64_tr_b16 v[76:77], v223 offset:0
    ds_read_b64_tr_b16 v[78:79], v223 offset:1024
    buffer_load_dwordx4 v[80:83], v240, s[12:15], s76 offen sc1
    v_mfma_f32_32x32x16_bf16 v[32:47], v[64:67], v[84:87], v[32:47]
    s_xor_b32 s26, s48, 25600
    s_add_u32 m0, s46, 6144
    s_mul_i32 s26, s26, 14
    s_add_u32 s26, s26, s43
    s_add_u32 s28, s26, 6144
    buffer_load_dwordx4 v204, s[8:11], s26 offen lds
    v_mfma_f32_32x32x16_bf16 v[48:63], v[68:71], v[84:87], v[48:63]
    buffer_load_dwordx4 v[84:87], v240, s[12:15], s78 offen sc1
    buffer_load_dwordx4 v204, s[8:11], s28 offen offset:1024 lds
    s_waitcnt vmcnt(12)
    s_waitcnt lgkmcnt(0)
    v_mfma_f32_32x32x16_bf16 v[0:15], v[72:75], v[88:91], v[0:15]
    ds_read_b64_tr_b16 v[64:65], v206 offset:0
    ds_read_b64_tr_b16 v[66:67], v206 offset:1024
    s_xor_b32 s76, s48, 25600
    s_add_u32 s76, s76, s42
    s_add_u32 s78, s76, 114688
    v_mfma_f32_32x32x16_bf16 v[16:31], v[76:79], v[88:91], v[16:31]
    ds_read_b64_tr_b16 v[68:69], v207 offset:0
    ds_read_b64_tr_b16 v[70:71], v207 offset:1024
    buffer_load_dwordx4 v[88:91], v240, s[12:15], s76 offen sc1
    v_mfma_f32_32x32x16_bf16 v[32:47], v[72:75], v[92:95], v[32:47]
    s_xor_b32 s26, s48, 26624
    s_add_u32 m0, s46, 8192
    s_mul_i32 s26, s26, 14
    s_add_u32 s26, s26, s43
    s_add_u32 s28, s26, 6144
    buffer_load_dwordx4 v204, s[8:11], s26 offen lds
    v_mfma_f32_32x32x16_bf16 v[48:63], v[76:79], v[92:95], v[48:63]
    buffer_load_dwordx4 v[92:95], v240, s[12:15], s78 offen sc1
    buffer_load_dwordx4 v204, s[8:11], s28 offen offset:1024 lds
    s_waitcnt vmcnt(12)
    s_waitcnt lgkmcnt(0)
    v_mfma_f32_32x32x16_bf16 v[0:15], v[64:67], v[96:99], v[0:15]
    ds_read_b64_tr_b16 v[72:73], v206 offset:2048
    ds_read_b64_tr_b16 v[74:75], v206 offset:3072
    s_xor_b32 s76, s48, 26624
    s_add_u32 s76, s76, s42
    s_add_u32 s78, s76, 114688
    v_mfma_f32_32x32x16_bf16 v[16:31], v[68:71], v[96:99], v[16:31]
    ds_read_b64_tr_b16 v[76:77], v207 offset:2048
    ds_read_b64_tr_b16 v[78:79], v207 offset:3072
    buffer_load_dwordx4 v[96:99], v240, s[12:15], s76 offen sc1
    v_mfma_f32_32x32x16_bf16 v[32:47], v[64:67], v[100:103], v[32:47]
    s_xor_b32 s26, s48, 27648
    s_add_u32 m0, s46, 10240
    s_mul_i32 s26, s26, 14
    s_add_u32 s26, s26, s43
    s_add_u32 s28, s26, 6144
    buffer_load_dwordx4 v204, s[8:11], s26 offen lds
    v_mfma_f32_32x32x16_bf16 v[48:63], v[68:71], v[100:103], v[48:63]
    buffer_load_dwordx4 v[100:103], v240, s[12:15], s78 offen sc1
    buffer_load_dwordx4 v204, s[8:11], s28 offen offset:1024 lds
    s_waitcnt vmcnt(12)
    s_waitcnt lgkmcnt(0)
    v_mfma_f32_32x32x16_bf16 v[0:15], v[72:75], v[104:107], v[0:15]
    ds_read_b64_tr_b16 v[64:65], v206 offset:4096
    ds_read_b64_tr_b16 v[66:67], v206 offset:5120
    s_xor_b32 s76, s48, 27648
    s_add_u32 s76, s76, s42
    s_add_u32 s78, s76, 114688
    v_mfma_f32_32x32x16_bf16 v[16:31], v[76:79], v[104:107], v[16:31]
    ds_read_b64_tr_b16 v[68:69], v207 offset:4096
    ds_read_b64_tr_b16 v[70:71], v207 offset:5120
    buffer_load_dwordx4 v[104:107], v240, s[12:15], s76 offen sc1
    v_mfma_f32_32x32x16_bf16 v[32:47], v[72:75], v[108:111], v[32:47]
    v_mfma_f32_32x32x16_bf16 v[48:63], v[76:79], v[108:111], v[48:63]
    buffer_load_dwordx4 v[108:111], v240, s[12:15], s78 offen sc1
    s_waitcnt vmcnt(10)
    s_waitcnt lgkmcnt(0)
    v_mfma_f32_32x32x16_bf16 v[0:15], v[64:67], v[80:83], v[0:15]
    ds_read_b64_tr_b16 v[72:73], v206 offset:6144
    ds_read_b64_tr_b16 v[74:75], v206 offset:7168
    v_mfma_f32_32x32x16_bf16 v[16:31], v[68:71], v[80:83], v[16:31]
    ds_read_b64_tr_b16 v[76:77], v207 offset:6144
    ds_read_b64_tr_b16 v[78:79], v207 offset:7168
    v_mfma_f32_32x32x16_bf16 v[32:47], v[64:67], v[84:87], v[32:47]
    v_mfma_f32_32x32x16_bf16 v[48:63], v[68:71], v[84:87], v[48:63]
    s_waitcnt vmcnt(2)
    ds_read_b64_tr_b16 v[168:169], v206 offset:8192
    ds_read_b64_tr_b16 v[170:171], v206 offset:9216
    ds_read_b64_tr_b16 v[172:173], v207 offset:8192
    ds_read_b64_tr_b16 v[174:175], v207 offset:9216
    ds_read_b64_tr_b16 v[176:177], v206 offset:10240
    ds_read_b64_tr_b16 v[178:179], v206 offset:11264
    ds_read_b64_tr_b16 v[180:181], v207 offset:10240
    ds_read_b64_tr_b16 v[182:183], v207 offset:11264
    v_xor_b32 v192, 0, v205
    v_xor_b32 v193, 32, v205
    v_xor_b32 v194, 64, v205
    v_xor_b32 v195, 96, v205
    v_xor_b32 v212, 128, v205
    v_xor_b32 v213, 160, v205
    v_xor_b32 v214, 192, v205
    v_xor_b32 v215, 224, v205
    s_waitcnt vmcnt(7)
    s_waitcnt lgkmcnt(8)
    v_mfma_f32_32x32x16_bf16 v[0:15], v[72:75], v[88:91], v[0:15]
    v_mfma_f32_32x32x16_bf16 v[16:31], v[76:79], v[88:91], v[16:31]
    s_waitcnt vmcnt(3)
    s_waitcnt lgkmcnt(4)
    v_mfma_f32_32x32x16_bf16 v[0:15], v[168:171], v[96:99], v[0:15]
    v_mfma_f32_32x32x16_bf16 v[16:31], v[172:175], v[96:99], v[16:31]
    s_waitcnt vmcnt(0)
    s_waitcnt lgkmcnt(0)
    v_mfma_f32_32x32x16_bf16 v[0:15], v[176:179], v[104:107], v[0:15]
    v_mfma_f32_32x32x16_bf16 v[16:31], v[180:183], v[104:107], v[16:31]
    v_mfma_f32_32x32x16_bf16 v[32:47], v[72:75], v[92:95], v[32:47]
    v_mfma_f32_32x32x16_bf16 v[48:63], v[76:79], v[92:95], v[48:63]
    s_nop 9
    ds_write_b128 v192, v[0:3]
    ds_write_b128 v193, v[4:7]
    v_mfma_f32_32x32x16_bf16 v[32:47], v[168:171], v[100:103], v[32:47]
    ds_write_b128 v194, v[8:11]
    ds_write_b128 v195, v[12:15]
    v_mfma_f32_32x32x16_bf16 v[48:63], v[172:175], v[100:103], v[48:63]
    ds_write_b128 v212, v[16:19]
    ds_write_b128 v213, v[20:23]
    v_mfma_f32_32x32x16_bf16 v[32:47], v[176:179], v[108:111], v[32:47]
    ds_write_b128 v214, v[24:27]
    ds_write_b128 v215, v[28:31]
    v_mfma_f32_32x32x16_bf16 v[48:63], v[180:183], v[108:111], v[48:63]
    s_nop 9
    ds_write_b128 v192, v[32:35] offset:8192
    ds_write_b128 v193, v[36:39] offset:8192
    ds_write_b128 v194, v[40:43] offset:8192
    ds_write_b128 v195, v[44:47] offset:8192
    ds_write_b128 v212, v[48:51] offset:8192
    ds_write_b128 v213, v[52:55] offset:8192
    ds_write_b128 v214, v[56:59] offset:8192
    ds_write_b128 v215, v[60:63] offset:8192
    s_waitcnt lgkmcnt(0)
    s_barrier
    s_endpgm
K_END:
    s_endpgm
K_CODE_END:
.section .rodata,"a"
.p2align 6
.amdhsa_kernel recurrent_scan__linear_attn_block__dense_activation_mish__prompt_kernel
  .amdhsa_next_free_vgpr 256
  .amdhsa_next_free_sgpr 102
  .amdhsa_accum_offset 256
  .amdhsa_group_segment_fixed_size 0
  .amdhsa_kernarg_size 80
  .amdhsa_user_sgpr_count 2
  .amdhsa_user_sgpr_kernarg_segment_ptr 1
  .amdhsa_system_sgpr_workgroup_id_x 1
.end_amdhsa_kernel
```
